```python
import torch

def _softmax(x, axis=-1):
    return torch.softmax(x, dim=axis)
def _gelu(x):
    return torch.nn.functional.gelu(x, approximate="tanh")
def _silu(x):
    return torch.nn.functional.silu(x)
def _sigmoid(x):
    return torch.sigmoid(x)
def _layernorm(x, axis=-1, eps=1e-5):
    m = x.mean(dim=axis, keepdim=True)
    v = x.var(dim=axis, keepdim=True, unbiased=False)
    return (x - m) / torch.sqrt(v + eps)
def _scatter_add(tgt, idx, src, axis=0):
    return tgt.clone().index_add_(axis, idx, src)
def _segment_sum(src, seg, n):
    out = torch.zeros((n,) + src.shape[1:], dtype=src.dtype)
    return out.index_add_(0, seg, src)
def _pad(x, pw):
    flat = tuple(v for pair in reversed(pw) for v in pair)
    return torch.nn.functional.pad(x, flat)

kernel_name = 'sequential_preLN__linear_kernel_hedgehog__dense_activation_relu__prompt'

def setup_inputs():

    _w = (lambda a: (lambda t: t.to(torch.bfloat16) if t.is_floating_point() else t)(torch.as_tensor(a)))
    def _A_setup():
        B, S, D, H = 1, 2048, 1024, 32
        Dh = D // H
        return {
            "x": _w((lambda *s: torch.randn(*s, dtype=torch.bfloat16) * 0.05)(B, S, D)),
            "wqkv": _w((lambda *s: torch.randn(*s, dtype=torch.bfloat16) * 0.2)(D, 3 * D)),
            "w_phi": _w((lambda *s: torch.randn(*s, dtype=torch.bfloat16) * 0.2)(H, Dh, Dh) * (Dh ** -0.5)),
            "wo": _w((lambda *s: torch.randn(*s, dtype=torch.bfloat16) * 0.05)(D, D)),
        }
    _A_in = _A_setup()

    def _B_setup():
        B, S, D, Dff = 1, 2048, 1024, 3584
        return {
            "x": _w((lambda *s: torch.randn(*s, dtype=torch.bfloat16) * 0.05)(B, S, D)),
            "w1": _w((lambda *s: torch.randn(*s, dtype=torch.bfloat16) * 0.05)(D, Dff)),
            "w2": _w((lambda *s: torch.randn(*s, dtype=torch.bfloat16) * 0.05)(Dff, D)),
        }
    _B_in = _B_setup()

    return {
        "A_x": _A_in["x"],
        "A_wqkv": _A_in["wqkv"],
        "A_w_phi": _A_in["w_phi"],
        "A_wo": _A_in["wo"],
        "B_x": _B_in["x"],
        "B_w1": _B_in["w1"],
        "B_w2": _B_in["w2"],
    }

def reference(A_x, A_wqkv, A_w_phi, A_wo, B_x, B_w1, B_w2):
    def _A_ref(x, wqkv, w_phi, wo):
        B, S, D = x.shape
        H = 32; Dh = D // H
        qkv = (lambda x, *d: x.permute(*d))((x @ wqkv).reshape(B, S, 3, H, Dh), 2, 0, 3, 1, 4)
        q, k, v = qkv[0], qkv[1], qkv[2]
        pq = torch.einsum("bhsd,hdf->bhsf", q, w_phi)
        pk = torch.einsum("bhsd,hdf->bhsf", k, w_phi)
        phi_q = torch.concatenate([_softmax(pq, axis=-1), _softmax(-pq, axis=-1)], axis=-1)
        phi_k = torch.concatenate([_softmax(pk, axis=-1), _softmax(-pk, axis=-1)], axis=-1)
        kv = torch.einsum("bhsf,bhsd->bhfd", phi_k, v)
        z  = torch.einsum("bhsf->bhf", phi_k)
        num = torch.einsum("bhqf,bhfd->bhqd", phi_q, kv)
        den = torch.einsum("bhqf,bhf->bhq", phi_q, z)[..., None] + 1e-6
        o = num / den
        return (lambda x, *d: x.permute(*d))(o, 0, 2, 1, 3).reshape(B, S, D) @ wo

    def _B_ref(x, w1, w2):
        h = torch.einsum("bsd,df->bsf", x, w1)
        zero = torch.zeros_like(h)
        h = torch.maximum(h, zero)
        return torch.einsum("bsf,fd->bsd", h, w2)

    x = A_x
    h = x + _A_ref(_layernorm(x, axis=-1), A_wqkv, A_w_phi, A_wo)
    h2 = h + _B_ref(_layernorm(h, axis=-1), B_w1, B_w2)
    return h2
```

```asm
; @launch kernel=sequential_preLN__linear_kernel_hedgehog__dense_activation_relu__prompt_kernel grid=(256,1,1) block=(512,1,1) lds=161856
.amdgcn_target "amdgcn-amd-amdhsa--gfx950"
.text
.globl sequential_preLN__linear_kernel_hedgehog__dense_activation_relu__prompt_kernel
.p2align 8
.type sequential_preLN__linear_kernel_hedgehog__dense_activation_relu__prompt_kernel,@function
sequential_preLN__linear_kernel_hedgehog__dense_activation_relu__prompt_kernel:
    s_cmp_ge_u32 s2, 256
    s_cbranch_scc1 sequential_preLN__linear_kernel_hedgehog__dense_activation_relu__prompt_kernel_done
    s_load_dwordx16 s[44:59], s[0:1], 0
    s_load_dwordx4 s[60:63], s[0:1], 64
    v_lshrrev_b32 v1, 6, v0
    v_and_b32 v0, 63, v0
    v_readfirstlane_b32 s28, v1
    s_waitcnt lgkmcnt(0)
    s_mov_b32 s24, s62
    s_mov_b32 s25, s63
    s_mov_b32 s26, 67108864
    s_mov_b32 s27, 0x20000
    s_cmp_ge_u32 s28, 4
    s_cbranch_scc1 sequential_preLN__linear_kernel_hedgehog__dense_activation_relu__prompt_kernel_loader
    s_and_b32 s31, s2, 7
    s_lshr_b32 s32, s2, 3
    s_lshr_b32 s33, s31, 2
    s_and_b32 s34, s31, 3
    s_mul_i32 s29, s32, 8193
    s_lshr_b32 s29, s29, 16
    s_mul_i32 s30, s29, 8
    s_sub_u32 s30, s32, s30
    s_mul_i32 s33, s33, 4
    s_add_u32 s29, s29, s33
    s_mul_i32 s34, s34, 8
    s_add_u32 s30, s30, s34
    s_mul_i32 s35, s29, 524288
    s_add_u32 s4, s44, s35
    s_addc_u32 s5, s45, 0
    s_sub_u32 s6, 4194304, s35
    s_mov_b32 s7, 0x20000
    s_lshl_b32 s35, s30, 6
    s_add_u32 s8, s46, s35
    s_addc_u32 s9, s47, 0
    s_sub_u32 s10, 6291456, s35
    s_mov_b32 s11, 0x20000
    s_and_b32 s67, s30, 7
    s_lshl_b32 s67, s67, 1
    s_and_b32 s35, s29, 3
    s_lshl_b32 s35, s35, 2
    s_add_u32 s67, s67, s35
    s_and_b32 s67, s67, 15
    s_mov_b32 s64, 0x3fb8aa3b
    s_lshr_b32 s42, s28, 0
    s_and_b32 s43, s28, 0
    v_and_b32 v100, 15, v0
    v_lshrrev_b32 v101, 4, v0
    v_bfe_u32 v102, v0, 1, 3
    v_xor_b32 v102, v102, v101
    v_lshlrev_b32 v102, 4, v102
    v_lshl_add_u32 v102, v100, 7, v102
    s_mul_i32 s31, s42, 8192
    v_add_u32 v180, s31, v102
    v_xor_b32 v181, 64, v180
    v_add_u32 v182, 45056, v180
    v_add_u32 v183, 45056, v181
    v_add_u32 v184, 90112, v180
    v_add_u32 v185, 90112, v181
    v_bfe_u32 v102, v0, 1, 1
    v_and_b32 v103, 1, v101
    v_lshlrev_b32 v103, 1, v103
    v_xor_b32 v102, v102, v103
    v_lshlrev_b32 v102, 4, v102
    v_bfe_u32 v103, v0, 2, 2
    v_lshl_add_u32 v102, v103, 6, v102
    v_lshl_add_u32 v102, v101, 9, v102
    v_and_b32 v103, 1, v0
    v_lshl_add_u32 v186, v103, 3, v102
    v_add_u32 v187, 45056, v186
    v_add_u32 v188, 90112, v186
    v_bfe_u32 v102, v0, 1, 1
    v_add_u32 v102, 2, v102
    v_and_b32 v103, 1, v101
    v_lshlrev_b32 v103, 1, v103
    v_xor_b32 v102, v102, v103
    v_lshlrev_b32 v102, 4, v102
    v_bfe_u32 v103, v0, 2, 2
    v_lshl_add_u32 v102, v103, 6, v102
    v_lshl_add_u32 v102, v101, 9, v102
    v_and_b32 v103, 1, v0
    v_lshl_add_u32 v189, v103, 3, v102
    v_add_u32 v190, 45056, v189
    v_add_u32 v191, 90112, v189
    v_mov_b32 v4, 0
    v_mov_b32 v5, 0
    v_mov_b32 v6, 0
    v_mov_b32 v7, 0
    v_mov_b32 v8, 0
    v_mov_b32 v9, 0
    v_mov_b32 v10, 0
    v_mov_b32 v11, 0
    v_mov_b32 v12, 0
    v_mov_b32 v13, 0
    v_mov_b32 v14, 0
    v_mov_b32 v15, 0
    v_mov_b32 v16, 0
    v_mov_b32 v17, 0
    v_mov_b32 v18, 0
    v_mov_b32 v19, 0
    v_mov_b32 v20, 0
    v_mov_b32 v21, 0
    v_mov_b32 v22, 0
    v_mov_b32 v23, 0
    v_mov_b32 v24, 0
    v_mov_b32 v25, 0
    v_mov_b32 v26, 0
    v_mov_b32 v27, 0
    v_mov_b32 v28, 0
    v_mov_b32 v29, 0
    v_mov_b32 v30, 0
    v_mov_b32 v31, 0
    v_mov_b32 v32, 0
    v_mov_b32 v33, 0
    v_mov_b32 v34, 0
    v_mov_b32 v35, 0
    v_mov_b32 v36, 0
    v_mov_b32 v37, 0
    v_mov_b32 v38, 0
    v_mov_b32 v39, 0
    v_mov_b32 v40, 0
    v_mov_b32 v41, 0
    v_mov_b32 v42, 0
    v_mov_b32 v43, 0
    v_mov_b32 v44, 0
    v_mov_b32 v45, 0
    v_mov_b32 v46, 0
    v_mov_b32 v47, 0
    v_mov_b32 v48, 0
    v_mov_b32 v49, 0
    v_mov_b32 v50, 0
    v_mov_b32 v51, 0
    v_mov_b32 v52, 0
    v_mov_b32 v53, 0
    v_mov_b32 v54, 0
    v_mov_b32 v55, 0
    v_mov_b32 v56, 0
    v_mov_b32 v57, 0
    v_mov_b32 v58, 0
    v_mov_b32 v59, 0
    v_mov_b32 v60, 0
    v_mov_b32 v61, 0
    v_mov_b32 v62, 0
    v_mov_b32 v63, 0
    v_mov_b32 v64, 0
    v_mov_b32 v65, 0
    v_mov_b32 v66, 0
    v_mov_b32 v67, 0
    v_mov_b32 v68, 0
    v_mov_b32 v69, 0
    v_mov_b32 v70, 0
    v_mov_b32 v71, 0
    v_mov_b32 v72, 0
    v_mov_b32 v73, 0
    v_mov_b32 v74, 0
    v_mov_b32 v75, 0
    v_mov_b32 v76, 0
    v_mov_b32 v77, 0
    v_mov_b32 v78, 0
    v_mov_b32 v79, 0
    v_mov_b32 v80, 0
    v_mov_b32 v81, 0
    v_mov_b32 v82, 0
    v_mov_b32 v83, 0
    v_mov_b32 v84, 0
    v_mov_b32 v85, 0
    v_mov_b32 v86, 0
    v_mov_b32 v87, 0
    v_mov_b32 v88, 0
    v_mov_b32 v89, 0
    v_mov_b32 v90, 0
    v_mov_b32 v91, 0
    v_mov_b32 v92, 0
    v_mov_b32 v93, 0
    v_mov_b32 v94, 0
    v_mov_b32 v95, 0
    v_mov_b32 v96, 0
    v_mov_b32 v97, 0
    v_mov_b32 v98, 0
    v_mov_b32 v99, 0
    v_lshrrev_b32 v192, 4, v0
    v_and_b32 v193, 15, v0
    v_bfe_u32 v194, v0, 2, 2
    v_and_b32 v195, 3, v0
    s_mov_b32 s16, s44
    s_mov_b32 s17, s45
    s_mov_b32 s18, 4194304
    s_mov_b32 s19, 0x20000
    s_lshl_b32 s31, s29, 8
    s_lshl_b32 s32, s30, 3
    s_add_u32 s31, s31, s32
    s_lshl_b32 s32, s28, 1
    s_add_u32 s69, s31, s32
    s_lshl_b32 s32, s69, 11
    v_lshl_add_u32 v208, v0, 4, s32
    s_mov_b32 s33, 0
    buffer_load_dwordx4 v[228:231], v208, s[16:19], s33 offen
    s_mov_b32 s33, 1024
    buffer_load_dwordx4 v[232:235], v208, s[16:19], s33 offen
    s_mov_b32 s33, 2048
    buffer_load_dwordx4 v[236:239], v208, s[16:19], s33 offen
    s_mov_b32 s33, 3072
    buffer_load_dwordx4 v[240:243], v208, s[16:19], s33 offen
    s_mov_b32 s12, s48
    s_mov_b32 s13, s49
    s_mov_b32 s14, 65536
    s_mov_b32 s15, 0x20000
    s_lshl_b32 s31, s30, 11
    s_lshl_b32 s32, s28, 9
    s_add_u32 s31, s31, s32
    v_lshl_add_u32 v210, v0, 4, s31
    v_mov_b32 v211, 0x80000000
    v_cmp_gt_u32 vcc, 32, v0
    s_nop 1
    v_cndmask_b32 v210, v211, v210, vcc
    buffer_load_dwordx4 v[244:247], v210, s[12:15], 0 offen
    s_mov_b32 s65, 0
    s_cmp_lg_u32 s2, 0
    s_cbranch_scc1 nonce_1001_x
    s_cmp_lg_u32 s28, 0
    s_cbranch_scc1 nonce_1001_x
    s_memrealtime s[76:77]
    s_waitcnt lgkmcnt(0)
    s_or_b32 s65, s76, 1
    v_mov_b32 v248, 0
    v_mov_b32 v249, s65
    s_mov_b64 exec, 1
    global_store_dword v248, v249, s[60:61] sc0 sc1
    s_mov_b64 exec, -1
nonce_1001_x:
    v_mov_b32 v212, 0
    v_mov_b32 v213, 0
    v_mov_b32 v214, 0
    v_mov_b32 v215, 0
    v_mov_b32 v216, 0
    v_mov_b32 v217, 0
    v_mov_b32 v218, 0
    v_mov_b32 v219, 0
    v_mov_b32 v220, 0
    v_mov_b32 v221, 0
    v_mov_b32 v222, 0
    v_mov_b32 v223, 0
    v_mov_b32 v224, 0x3f803f80
    v_mov_b32 v225, 0x3f803f80
    v_mov_b32 v226, 0x3f803f80
    v_mov_b32 v227, 0x3f803f80
    s_barrier
    ds_read_b128 v[100:103], v180 offset:0
    ds_read_b64_tr_b16 v[132:133], v186 offset:32768
    ds_read_b64_tr_b16 v[134:135], v186 offset:33024
    ds_read_b128 v[104:107], v180 offset:2048
    ds_read_b64_tr_b16 v[136:137], v189 offset:32768
    ds_read_b64_tr_b16 v[138:139], v189 offset:33024
    ds_read_b128 v[108:111], v180 offset:4096
    ds_read_b64_tr_b16 v[140:141], v186 offset:36864
    ds_read_b64_tr_b16 v[142:143], v186 offset:37120
    ds_read_b128 v[112:115], v180 offset:6144
    ds_read_b64_tr_b16 v[144:145], v189 offset:36864
    ds_read_b64_tr_b16 v[146:147], v189 offset:37120
    ds_read_b64_tr_b16 v[148:149], v186 offset:40960
    ds_read_b64_tr_b16 v[150:151], v186 offset:41216
    ds_read_b64_tr_b16 v[152:153], v189 offset:40960
    ds_read_b64_tr_b16 v[154:155], v189 offset:41216
    s_mov_b32 s38, 5
p1_cloop:
    s_cmp_eq_u32 s38, 4
    s_cbranch_scc0 lh_1002_a
    v_mov_b32 v248, 0
    s_cmp_lg_u32 s65, 0
    s_cbranch_scc1 lh_1002_n
    s_mov_b32 s79, 40000
lh_1002_np:
    global_load_dword v249, v248, s[60:61] sc0 sc1
    s_waitcnt vmcnt(0)
    v_readfirstlane_b32 s65, v249
    s_nop 2
    s_cmp_lg_u32 s65, 0
    s_cbranch_scc1 lh_1002_n
    s_sleep 4
    s_sub_u32 s79, s79, 1
    s_cmp_lg_u32 s79, 0
    s_cbranch_scc1 lh_1002_np
lh_1002_n:
    s_waitcnt vmcnt(0)
    v_mov_b32 v248, 161852
    v_mov_b32 v249, s65
    ds_write_b32 v248, v249
    s_lshl_b32 s32, s28, 9
    s_add_u32 s32, s32, 135168
    v_lshl_add_u32 v210, v0, 4, s32
    s_mov_b64 exec, 0xffffffff
    ds_write_b128 v210, v[244:247]
    s_mov_b64 exec, -1
    v_mov_b32 v200, 0
    v_dot2_f32_bf16 v200, v228, v224, v200
    v_dot2_f32_bf16 v200, v229, v224, v200
    v_dot2_f32_bf16 v200, v230, v224, v200
    v_dot2_f32_bf16 v200, v231, v224, v200
    v_dot2_f32_bf16 v200, v232, v224, v200
    v_dot2_f32_bf16 v200, v233, v224, v200
    v_dot2_f32_bf16 v200, v234, v224, v200
    v_dot2_f32_bf16 v200, v235, v224, v200
    s_nop 3
    v_add_f32_dpp v200, v200, v200 quad_perm:[1,0,3,2] row_mask:0xf bank_mask:0xf
    s_nop 1
    v_add_f32_dpp v200, v200, v200 quad_perm:[2,3,0,1] row_mask:0xf bank_mask:0xf
    s_nop 1
    v_add_f32_dpp v200, v200, v200 row_half_mirror row_mask:0xf bank_mask:0xf
    s_nop 1
    v_add_f32_dpp v200, v200, v200 row_mirror row_mask:0xf bank_mask:0xf
    v_mov_b32 v201, v200
    s_nop 1
    v_permlane16_swap_b32 v200, v201
    v_add_f32 v200, v200, v201
    v_mov_b32 v201, v200
    s_nop 1
    v_permlane32_swap_b32 v200, v201
    v_add_f32 v200, v200, v201
    v_mul_f32 v200, 0x3a800000, v200
    v_mov_b32 v202, 0
    v_lshlrev_b32 v250, 16, v228
    v_and_b32 v251, 0xffff0000, v228
    v_sub_f32 v250, v250, v200
    v_sub_f32 v251, v251, v200
    v_fmac_f32 v202, v250, v250
    v_fmac_f32 v202, v251, v251
    v_lshlrev_b32 v250, 16, v229
    v_and_b32 v251, 0xffff0000, v229
    v_sub_f32 v250, v250, v200
    v_sub_f32 v251, v251, v200
    v_fmac_f32 v202, v250, v250
    v_fmac_f32 v202, v251, v251
    v_lshlrev_b32 v250, 16, v230
    v_and_b32 v251, 0xffff0000, v230
    v_sub_f32 v250, v250, v200
    v_sub_f32 v251, v251, v200
    v_fmac_f32 v202, v250, v250
    v_fmac_f32 v202, v251, v251
    v_lshlrev_b32 v250, 16, v231
    v_and_b32 v251, 0xffff0000, v231
    v_sub_f32 v250, v250, v200
    v_sub_f32 v251, v251, v200
    v_fmac_f32 v202, v250, v250
    v_fmac_f32 v202, v251, v251
    v_lshlrev_b32 v250, 16, v232
    v_and_b32 v251, 0xffff0000, v232
    v_sub_f32 v250, v250, v200
    v_sub_f32 v251, v251, v200
    v_fmac_f32 v202, v250, v250
    v_fmac_f32 v202, v251, v251
    v_lshlrev_b32 v250, 16, v233
    v_and_b32 v251, 0xffff0000, v233
    v_sub_f32 v250, v250, v200
    v_sub_f32 v251, v251, v200
    v_fmac_f32 v202, v250, v250
    v_fmac_f32 v202, v251, v251
    v_lshlrev_b32 v250, 16, v234
    v_and_b32 v251, 0xffff0000, v234
    v_sub_f32 v250, v250, v200
    v_sub_f32 v251, v251, v200
    v_fmac_f32 v202, v250, v250
    v_fmac_f32 v202, v251, v251
    v_lshlrev_b32 v250, 16, v235
    v_and_b32 v251, 0xffff0000, v235
    v_sub_f32 v250, v250, v200
    v_sub_f32 v251, v251, v200
    v_fmac_f32 v202, v250, v250
    v_fmac_f32 v202, v251, v251
    s_nop 1
    v_add_f32_dpp v202, v202, v202 quad_perm:[1,0,3,2] row_mask:0xf bank_mask:0xf
    s_nop 1
    v_add_f32_dpp v202, v202, v202 quad_perm:[2,3,0,1] row_mask:0xf bank_mask:0xf
    s_nop 1
    v_add_f32_dpp v202, v202, v202 row_half_mirror row_mask:0xf bank_mask:0xf
    s_nop 1
    v_add_f32_dpp v202, v202, v202 row_mirror row_mask:0xf bank_mask:0xf
    v_mov_b32 v203, v202
    s_nop 1
    v_permlane16_swap_b32 v202, v203
    v_add_f32 v202, v202, v203
    v_mov_b32 v203, v202
    s_nop 1
    v_permlane32_swap_b32 v202, v203
    v_add_f32 v202, v202, v203
    v_mul_f32 v202, 0x3a800000, v202
    v_cvt_pk_bf16_f32 v200, v200, v200
    v_lshlrev_b32 v200, 16, v200
    v_cvt_pk_bf16_f32 v202, v202, v202
    v_lshlrev_b32 v202, 16, v202
    v_add_f32 v202, 0x3727c5ac, v202
    v_cvt_pk_bf16_f32 v202, v202, v202
    v_lshlrev_b32 v202, 16, v202
    v_sqrt_f32 v202, v202
    s_nop 0
    v_cvt_pk_bf16_f32 v202, v202, v202
    v_lshlrev_b32 v202, 16, v202
    v_rcp_f32 v202, v202
    v_mov_b32 v248, v200
    v_mov_b32 v249, v202
    s_add_u32 s32, s69, 0
    s_lshl_b32 s32, s32, 3
    s_add_u32 s32, s32, 32915456
    v_mov_b32 v208, s32
    v_mov_b32 v209, 0x80000000
    v_cmp_eq_u32 vcc, 0, v0
    s_nop 1
    v_cndmask_b32 v208, v209, v208, vcc
    buffer_store_dwordx2 v[248:249], v208, s[24:27], 0 offen sc0 sc1
    s_nop 1
    v_mov_b32 v200, 0
    v_dot2_f32_bf16 v200, v236, v224, v200
    v_dot2_f32_bf16 v200, v237, v224, v200
    v_dot2_f32_bf16 v200, v238, v224, v200
    v_dot2_f32_bf16 v200, v239, v224, v200
    v_dot2_f32_bf16 v200, v240, v224, v200
    v_dot2_f32_bf16 v200, v241, v224, v200
    v_dot2_f32_bf16 v200, v242, v224, v200
    v_dot2_f32_bf16 v200, v243, v224, v200
    s_nop 3
    v_add_f32_dpp v200, v200, v200 quad_perm:[1,0,3,2] row_mask:0xf bank_mask:0xf
    s_nop 1
    v_add_f32_dpp v200, v200, v200 quad_perm:[2,3,0,1] row_mask:0xf bank_mask:0xf
    s_nop 1
    v_add_f32_dpp v200, v200, v200 row_half_mirror row_mask:0xf bank_mask:0xf
    s_nop 1
    v_add_f32_dpp v200, v200, v200 row_mirror row_mask:0xf bank_mask:0xf
    v_mov_b32 v201, v200
    s_nop 1
    v_permlane16_swap_b32 v200, v201
    v_add_f32 v200, v200, v201
    v_mov_b32 v201, v200
    s_nop 1
    v_permlane32_swap_b32 v200, v201
    v_add_f32 v200, v200, v201
    v_mul_f32 v200, 0x3a800000, v200
    v_mov_b32 v202, 0
    v_lshlrev_b32 v250, 16, v236
    v_and_b32 v251, 0xffff0000, v236
    v_sub_f32 v250, v250, v200
    v_sub_f32 v251, v251, v200
    v_fmac_f32 v202, v250, v250
    v_fmac_f32 v202, v251, v251
    v_lshlrev_b32 v250, 16, v237
    v_and_b32 v251, 0xffff0000, v237
    v_sub_f32 v250, v250, v200
    v_sub_f32 v251, v251, v200
    v_fmac_f32 v202, v250, v250
    v_fmac_f32 v202, v251, v251
    v_lshlrev_b32 v250, 16, v238
    v_and_b32 v251, 0xffff0000, v238
    v_sub_f32 v250, v250, v200
    v_sub_f32 v251, v251, v200
    v_fmac_f32 v202, v250, v250
    v_fmac_f32 v202, v251, v251
    v_lshlrev_b32 v250, 16, v239
    v_and_b32 v251, 0xffff0000, v239
    v_sub_f32 v250, v250, v200
    v_sub_f32 v251, v251, v200
    v_fmac_f32 v202, v250, v250
    v_fmac_f32 v202, v251, v251
    v_lshlrev_b32 v250, 16, v240
    v_and_b32 v251, 0xffff0000, v240
    v_sub_f32 v250, v250, v200
    v_sub_f32 v251, v251, v200
    v_fmac_f32 v202, v250, v250
    v_fmac_f32 v202, v251, v251
    v_lshlrev_b32 v250, 16, v241
    v_and_b32 v251, 0xffff0000, v241
    v_sub_f32 v250, v250, v200
    v_sub_f32 v251, v251, v200
    v_fmac_f32 v202, v250, v250
    v_fmac_f32 v202, v251, v251
    v_lshlrev_b32 v250, 16, v242
    v_and_b32 v251, 0xffff0000, v242
    v_sub_f32 v250, v250, v200
    v_sub_f32 v251, v251, v200
    v_fmac_f32 v202, v250, v250
    v_fmac_f32 v202, v251, v251
    v_lshlrev_b32 v250, 16, v243
    v_and_b32 v251, 0xffff0000, v243
    v_sub_f32 v250, v250, v200
    v_sub_f32 v251, v251, v200
    v_fmac_f32 v202, v250, v250
    v_fmac_f32 v202, v251, v251
    s_nop 1
    v_add_f32_dpp v202, v202, v202 quad_perm:[1,0,3,2] row_mask:0xf bank_mask:0xf
    s_nop 1
    v_add_f32_dpp v202, v202, v202 quad_perm:[2,3,0,1] row_mask:0xf bank_mask:0xf
    s_nop 1
    v_add_f32_dpp v202, v202, v202 row_half_mirror row_mask:0xf bank_mask:0xf
    s_nop 1
    v_add_f32_dpp v202, v202, v202 row_mirror row_mask:0xf bank_mask:0xf
    v_mov_b32 v203, v202
    s_nop 1
    v_permlane16_swap_b32 v202, v203
    v_add_f32 v202, v202, v203
    v_mov_b32 v203, v202
    s_nop 1
    v_permlane32_swap_b32 v202, v203
    v_add_f32 v202, v202, v203
    v_mul_f32 v202, 0x3a800000, v202
    v_cvt_pk_bf16_f32 v200, v200, v200
    v_lshlrev_b32 v200, 16, v200
    v_cvt_pk_bf16_f32 v202, v202, v202
    v_lshlrev_b32 v202, 16, v202
    v_add_f32 v202, 0x3727c5ac, v202
    v_cvt_pk_bf16_f32 v202, v202, v202
    v_lshlrev_b32 v202, 16, v202
    v_sqrt_f32 v202, v202
    s_nop 0
    v_cvt_pk_bf16_f32 v202, v202, v202
    v_lshlrev_b32 v202, 16, v202
    v_rcp_f32 v202, v202
    v_mov_b32 v248, v200
    v_mov_b32 v249, v202
    s_add_u32 s32, s69, 1
    s_lshl_b32 s32, s32, 3
    s_add_u32 s32, s32, 32915456
    v_mov_b32 v208, s32
    v_mov_b32 v209, 0x80000000
    v_cmp_eq_u32 vcc, 0, v0
    s_nop 1
    v_cndmask_b32 v208, v209, v208, vcc
    buffer_store_dwordx2 v[248:249], v208, s[24:27], 0 offen sc0 sc1
    s_nop 1
lh_1002_a:
    s_cmp_eq_u32 s38, 3
    s_cbranch_scc0 lh_1002_b
    s_lshl_b32 s32, s29, 9
    s_lshl_b32 s33, s30, 4
    s_add_u32 s32, s32, s33
    s_lshl_b32 s33, s28, 2
    s_add_u32 s32, s32, s33
    s_add_u32 s32, s32, 32591872
    v_mov_b32 v208, 0x80000000
    v_mov_b32 v210, s32
    v_cmp_eq_u32 vcc, 0, v0
    s_nop 1
    v_cndmask_b32 v208, v208, v210, vcc
    v_mov_b32 v210, s65
    s_waitcnt vmcnt(0)
    buffer_store_dword v210, v208, s[24:27], 0 offen sc0 sc1
lh_1002_b:
    s_cmp_eq_u32 s38, 1
    s_cbranch_scc0 lh_1002_c
    s_lshl_b32 s32, s29, 9
    s_add_u32 s32, s32, 32591872
    s_mov_b32 s79, 40000
    v_lshl_add_u32 v208, v0, 3, s32
poll_1003:
    buffer_load_dwordx2 v[210:211], v208, s[24:27], 0 offen sc0 sc1
    s_waitcnt vmcnt(0)
    v_xor_b32 v210, s65, v210
    v_xor_b32 v211, s65, v211
    v_or_b32 v210, v210, v211
    v_cmp_ne_u32 vcc, 0, v210
    s_nop 2
    s_cmp_eq_u64 vcc, 0
    s_cbranch_scc1 poll_1003_ok
    s_sleep 6
    s_sub_u32 s79, s79, 1
    s_cmp_lg_u32 s79, 0
    s_cbranch_scc1 poll_1003
poll_1003_ok:
    s_lshl_b32 s32, s29, 8
    s_lshl_b32 s33, s28, 6
    s_add_u32 s32, s32, s33
    v_add_u32 v208, s32, v193
    v_lshlrev_b32 v208, 3, v208
    v_add_u32 v208, 32915456, v208
    buffer_load_dwordx2 v[200:201], v208, s[24:27], 0 offen offset:0 sc0 sc1
    buffer_load_dwordx2 v[202:203], v208, s[24:27], 0 offen offset:128 sc0 sc1
    buffer_load_dwordx2 v[204:205], v208, s[24:27], 0 offen offset:256 sc0 sc1
    buffer_load_dwordx2 v[206:207], v208, s[24:27], 0 offen offset:384 sc0 sc1
lh_1002_c:
    s_waitcnt lgkmcnt(13)
    v_mfma_f32_16x16x32_bf16 v[4:7], v[132:135], v[100:103], v[4:7]
    ds_read_b128 v[116:119], v181 offset:0
    s_waitcnt lgkmcnt(11)
    v_mfma_f32_16x16x32_bf16 v[8:11], v[136:139], v[100:103], v[8:11]
    ds_read_b64_tr_b16 v[156:157], v186 offset:34816
    v_mfma_f32_16x16x32_bf16 v[28:31], v[132:135], v[104:107], v[28:31]
    ds_read_b64_tr_b16 v[158:159], v186 offset:35072
    v_mfma_f32_16x16x32_bf16 v[32:35], v[136:139], v[104:107], v[32:35]
    ds_read_b128 v[120:123], v181 offset:2048
    s_waitcnt lgkmcnt(11)
    v_mfma_f32_16x16x32_bf16 v[12:15], v[140:143], v[100:103], v[12:15]
    ds_read_b64_tr_b16 v[160:161], v189 offset:34816
    v_mfma_f32_16x16x32_bf16 v[52:55], v[132:135], v[108:111], v[52:55]
    ds_read_b64_tr_b16 v[162:163], v189 offset:35072
    v_mfma_f32_16x16x32_bf16 v[36:39], v[140:143], v[104:107], v[36:39]
    ds_read_b128 v[124:127], v181 offset:4096
    v_mfma_f32_16x16x32_bf16 v[56:59], v[136:139], v[108:111], v[56:59]
    ds_read_b64_tr_b16 v[164:165], v186 offset:38912
    v_mfma_f32_16x16x32_bf16 v[60:63], v[140:143], v[108:111], v[60:63]
    ds_read_b64_tr_b16 v[166:167], v186 offset:39168
    s_waitcnt lgkmcnt(13)
    v_mfma_f32_16x16x32_bf16 v[16:19], v[144:147], v[100:103], v[16:19]
    ds_read_b128 v[128:131], v181 offset:6144
    v_mfma_f32_16x16x32_bf16 v[76:79], v[132:135], v[112:115], v[76:79]
    ds_read_b64_tr_b16 v[168:169], v189 offset:38912
    v_mfma_f32_16x16x32_bf16 v[40:43], v[144:147], v[104:107], v[40:43]
    ds_read_b64_tr_b16 v[170:171], v189 offset:39168
    v_mfma_f32_16x16x32_bf16 v[80:83], v[136:139], v[112:115], v[80:83]
    ds_read_b64_tr_b16 v[172:173], v186 offset:43008
    v_mfma_f32_16x16x32_bf16 v[64:67], v[144:147], v[108:111], v[64:67]
    ds_read_b64_tr_b16 v[174:175], v186 offset:43264
    v_mfma_f32_16x16x32_bf16 v[84:87], v[140:143], v[112:115], v[84:87]
    ds_read_b64_tr_b16 v[176:177], v189 offset:43008
    v_mfma_f32_16x16x32_bf16 v[88:91], v[144:147], v[112:115], v[88:91]
    ds_read_b64_tr_b16 v[178:179], v189 offset:43264
    s_waitcnt lgkmcnt(15)
    v_mfma_f32_16x16x32_bf16 v[20:23], v[148:151], v[100:103], v[20:23]
    v_mfma_f32_16x16x32_bf16 v[44:47], v[148:151], v[104:107], v[44:47]
    v_mfma_f32_16x16x32_bf16 v[68:71], v[148:151], v[108:111], v[68:71]
    v_mfma_f32_16x16x32_bf16 v[92:95], v[148:151], v[112:115], v[92:95]
    v_mfma_f32_16x16x32_bf16 v[24:27], v[152:155], v[100:103], v[24:27]
    v_mfma_f32_16x16x32_bf16 v[48:51], v[152:155], v[104:107], v[48:51]
    v_mfma_f32_16x16x32_bf16 v[72:75], v[152:155], v[108:111], v[72:75]
    v_mfma_f32_16x16x32_bf16 v[96:99], v[152:155], v[112:115], v[96:99]
    s_bitcmp1_b32 s28, 0
    s_cbranch_scc1 cs_1004_x
    s_bitcmp1_b32 s28, 1
    s_cbranch_scc1 cs_1004_h
    v_mfma_f32_16x16x32_bf16 v[212:215], v[132:135], v[224:227], v[212:215]
    v_mfma_f32_16x16x32_bf16 v[216:219], v[136:139], v[224:227], v[216:219]
    v_mfma_f32_16x16x32_bf16 v[220:223], v[140:143], v[224:227], v[220:223]
    s_branch cs_1004_x
cs_1004_h:
    v_mfma_f32_16x16x32_bf16 v[212:215], v[144:147], v[224:227], v[212:215]
    v_mfma_f32_16x16x32_bf16 v[216:219], v[148:151], v[224:227], v[216:219]
    v_mfma_f32_16x16x32_bf16 v[220:223], v[152:155], v[224:227], v[220:223]
cs_1004_x:
    s_waitcnt lgkmcnt(13)
    v_mfma_f32_16x16x32_bf16 v[4:7], v[156:159], v[116:119], v[4:7]
    s_waitcnt lgkmcnt(0)
    s_barrier
    ds_read_b128 v[100:103], v182 offset:0
    v_mfma_f32_16x16x32_bf16 v[8:11], v[160:163], v[116:119], v[8:11]
    ds_read_b64_tr_b16 v[132:133], v187 offset:32768
    v_mfma_f32_16x16x32_bf16 v[28:31], v[156:159], v[120:123], v[28:31]
    ds_read_b64_tr_b16 v[134:135], v187 offset:33024
    v_mfma_f32_16x16x32_bf16 v[32:35], v[160:163], v[120:123], v[32:35]
    ds_read_b128 v[104:107], v182 offset:2048
    v_mfma_f32_16x16x32_bf16 v[12:15], v[164:167], v[116:119], v[12:15]
    ds_read_b64_tr_b16 v[136:137], v190 offset:32768
    v_mfma_f32_16x16x32_bf16 v[52:55], v[156:159], v[124:127], v[52:55]
    ds_read_b64_tr_b16 v[138:139], v190 offset:33024
    v_mfma_f32_16x16x32_bf16 v[36:39], v[164:167], v[120:123], v[36:39]
    ds_read_b128 v[108:111], v182 offset:4096
    v_mfma_f32_16x16x32_bf16 v[56:59], v[160:163], v[124:127], v[56:59]
    ds_read_b64_tr_b16 v[140:141], v187 offset:36864
    v_mfma_f32_16x16x32_bf16 v[60:63], v[164:167], v[124:127], v[60:63]
    ds_read_b64_tr_b16 v[142:143], v187 offset:37120
    v_mfma_f32_16x16x32_bf16 v[16:19], v[168:171], v[116:119], v[16:19]
    ds_read_b128 v[112:115], v182 offset:6144
    v_mfma_f32_16x16x32_bf16 v[76:79], v[156:159], v[128:131], v[76:79]
    ds_read_b64_tr_b16 v[144:145], v190 offset:36864
    v_mfma_f32_16x16x32_bf16 v[40:43], v[168:171], v[120:123], v[40:43]
    ds_read_b64_tr_b16 v[146:147], v190 offset:37120
    v_mfma_f32_16x16x32_bf16 v[80:83], v[160:163], v[128:131], v[80:83]
    ds_read_b64_tr_b16 v[148:149], v187 offset:40960
    v_mfma_f32_16x16x32_bf16 v[64:67], v[168:171], v[124:127], v[64:67]
    ds_read_b64_tr_b16 v[150:151], v187 offset:41216
    v_mfma_f32_16x16x32_bf16 v[84:87], v[164:167], v[128:131], v[84:87]
    ds_read_b64_tr_b16 v[152:153], v190 offset:40960
    v_mfma_f32_16x16x32_bf16 v[88:91], v[168:171], v[128:131], v[88:91]
    ds_read_b64_tr_b16 v[154:155], v190 offset:41216
    v_mfma_f32_16x16x32_bf16 v[20:23], v[172:175], v[116:119], v[20:23]
    v_mfma_f32_16x16x32_bf16 v[44:47], v[172:175], v[120:123], v[44:47]
    v_mfma_f32_16x16x32_bf16 v[68:71], v[172:175], v[124:127], v[68:71]
    v_mfma_f32_16x16x32_bf16 v[92:95], v[172:175], v[128:131], v[92:95]
    v_mfma_f32_16x16x32_bf16 v[24:27], v[176:179], v[116:119], v[24:27]
    v_mfma_f32_16x16x32_bf16 v[48:51], v[176:179], v[120:123], v[48:51]
    v_mfma_f32_16x16x32_bf16 v[72:75], v[176:179], v[124:127], v[72:75]
    v_mfma_f32_16x16x32_bf16 v[96:99], v[176:179], v[128:131], v[96:99]
    s_bitcmp0_b32 s28, 0
    s_cbranch_scc1 cs_1005_x
    s_bitcmp1_b32 s28, 1
    s_cbranch_scc1 cs_1005_h
    v_mfma_f32_16x16x32_bf16 v[212:215], v[156:159], v[224:227], v[212:215]
    v_mfma_f32_16x16x32_bf16 v[216:219], v[160:163], v[224:227], v[216:219]
    v_mfma_f32_16x16x32_bf16 v[220:223], v[164:167], v[224:227], v[220:223]
    s_branch cs_1005_x
cs_1005_h:
    v_mfma_f32_16x16x32_bf16 v[212:215], v[168:171], v[224:227], v[212:215]
    v_mfma_f32_16x16x32_bf16 v[216:219], v[172:175], v[224:227], v[216:219]
    v_mfma_f32_16x16x32_bf16 v[220:223], v[176:179], v[224:227], v[220:223]
cs_1005_x:
    s_waitcnt lgkmcnt(13)
    v_mfma_f32_16x16x32_bf16 v[4:7], v[132:135], v[100:103], v[4:7]
    ds_read_b128 v[116:119], v183 offset:0
    s_waitcnt lgkmcnt(11)
    v_mfma_f32_16x16x32_bf16 v[8:11], v[136:139], v[100:103], v[8:11]
    ds_read_b64_tr_b16 v[156:157], v187 offset:34816
    v_mfma_f32_16x16x32_bf16 v[28:31], v[132:135], v[104:107], v[28:31]
    ds_read_b64_tr_b16 v[158:159], v187 offset:35072
    v_mfma_f32_16x16x32_bf16 v[32:35], v[136:139], v[104:107], v[32:35]
    ds_read_b128 v[120:123], v183 offset:2048
    s_waitcnt lgkmcnt(11)
    v_mfma_f32_16x16x32_bf16 v[12:15], v[140:143], v[100:103], v[12:15]
    ds_read_b64_tr_b16 v[160:161], v190 offset:34816
    v_mfma_f32_16x16x32_bf16 v[52:55], v[132:135], v[108:111], v[52:55]
    ds_read_b64_tr_b16 v[162:163], v190 offset:35072
    v_mfma_f32_16x16x32_bf16 v[36:39], v[140:143], v[104:107], v[36:39]
    ds_read_b128 v[124:127], v183 offset:4096
    v_mfma_f32_16x16x32_bf16 v[56:59], v[136:139], v[108:111], v[56:59]
    ds_read_b64_tr_b16 v[164:165], v187 offset:38912
    v_mfma_f32_16x16x32_bf16 v[60:63], v[140:143], v[108:111], v[60:63]
    ds_read_b64_tr_b16 v[166:167], v187 offset:39168
    s_waitcnt lgkmcnt(13)
    v_mfma_f32_16x16x32_bf16 v[16:19], v[144:147], v[100:103], v[16:19]
    ds_read_b128 v[128:131], v183 offset:6144
    v_mfma_f32_16x16x32_bf16 v[76:79], v[132:135], v[112:115], v[76:79]
    ds_read_b64_tr_b16 v[168:169], v190 offset:38912
    v_mfma_f32_16x16x32_bf16 v[40:43], v[144:147], v[104:107], v[40:43]
    ds_read_b64_tr_b16 v[170:171], v190 offset:39168
    v_mfma_f32_16x16x32_bf16 v[80:83], v[136:139], v[112:115], v[80:83]
    ds_read_b64_tr_b16 v[172:173], v187 offset:43008
    v_mfma_f32_16x16x32_bf16 v[64:67], v[144:147], v[108:111], v[64:67]
    ds_read_b64_tr_b16 v[174:175], v187 offset:43264
    v_mfma_f32_16x16x32_bf16 v[84:87], v[140:143], v[112:115], v[84:87]
    ds_read_b64_tr_b16 v[176:177], v190 offset:43008
    v_mfma_f32_16x16x32_bf16 v[88:91], v[144:147], v[112:115], v[88:91]
    ds_read_b64_tr_b16 v[178:179], v190 offset:43264
    s_waitcnt lgkmcnt(15)
    v_mfma_f32_16x16x32_bf16 v[20:23], v[148:151], v[100:103], v[20:23]
    v_mfma_f32_16x16x32_bf16 v[44:47], v[148:151], v[104:107], v[44:47]
    v_mfma_f32_16x16x32_bf16 v[68:71], v[148:151], v[108:111], v[68:71]
    v_mfma_f32_16x16x32_bf16 v[92:95], v[148:151], v[112:115], v[92:95]
    v_mfma_f32_16x16x32_bf16 v[24:27], v[152:155], v[100:103], v[24:27]
    v_mfma_f32_16x16x32_bf16 v[48:51], v[152:155], v[104:107], v[48:51]
    v_mfma_f32_16x16x32_bf16 v[72:75], v[152:155], v[108:111], v[72:75]
    v_mfma_f32_16x16x32_bf16 v[96:99], v[152:155], v[112:115], v[96:99]
    s_bitcmp1_b32 s28, 0
    s_cbranch_scc1 cs_1006_x
    s_bitcmp1_b32 s28, 1
    s_cbranch_scc1 cs_1006_h
    v_mfma_f32_16x16x32_bf16 v[212:215], v[132:135], v[224:227], v[212:215]
    v_mfma_f32_16x16x32_bf16 v[216:219], v[136:139], v[224:227], v[216:219]
    v_mfma_f32_16x16x32_bf16 v[220:223], v[140:143], v[224:227], v[220:223]
    s_branch cs_1006_x
cs_1006_h:
    v_mfma_f32_16x16x32_bf16 v[212:215], v[144:147], v[224:227], v[212:215]
    v_mfma_f32_16x16x32_bf16 v[216:219], v[148:151], v[224:227], v[216:219]
    v_mfma_f32_16x16x32_bf16 v[220:223], v[152:155], v[224:227], v[220:223]
cs_1006_x:
    s_waitcnt lgkmcnt(13)
    v_mfma_f32_16x16x32_bf16 v[4:7], v[156:159], v[116:119], v[4:7]
    s_waitcnt lgkmcnt(0)
    s_barrier
    ds_read_b128 v[100:103], v184 offset:0
    v_mfma_f32_16x16x32_bf16 v[8:11], v[160:163], v[116:119], v[8:11]
    ds_read_b64_tr_b16 v[132:133], v188 offset:32768
    v_mfma_f32_16x16x32_bf16 v[28:31], v[156:159], v[120:123], v[28:31]
    ds_read_b64_tr_b16 v[134:135], v188 offset:33024
    v_mfma_f32_16x16x32_bf16 v[32:35], v[160:163], v[120:123], v[32:35]
    ds_read_b128 v[104:107], v184 offset:2048
    v_mfma_f32_16x16x32_bf16 v[12:15], v[164:167], v[116:119], v[12:15]
    ds_read_b64_tr_b16 v[136:137], v191 offset:32768
    v_mfma_f32_16x16x32_bf16 v[52:55], v[156:159], v[124:127], v[52:55]
    ds_read_b64_tr_b16 v[138:139], v191 offset:33024
    v_mfma_f32_16x16x32_bf16 v[36:39], v[164:167], v[120:123], v[36:39]
    ds_read_b128 v[108:111], v184 offset:4096
    v_mfma_f32_16x16x32_bf16 v[56:59], v[160:163], v[124:127], v[56:59]
    ds_read_b64_tr_b16 v[140:141], v188 offset:36864
    v_mfma_f32_16x16x32_bf16 v[60:63], v[164:167], v[124:127], v[60:63]
    ds_read_b64_tr_b16 v[142:143], v188 offset:37120
    v_mfma_f32_16x16x32_bf16 v[16:19], v[168:171], v[116:119], v[16:19]
    ds_read_b128 v[112:115], v184 offset:6144
    v_mfma_f32_16x16x32_bf16 v[76:79], v[156:159], v[128:131], v[76:79]
    ds_read_b64_tr_b16 v[144:145], v191 offset:36864
    v_mfma_f32_16x16x32_bf16 v[40:43], v[168:171], v[120:123], v[40:43]
    ds_read_b64_tr_b16 v[146:147], v191 offset:37120
    v_mfma_f32_16x16x32_bf16 v[80:83], v[160:163], v[128:131], v[80:83]
    ds_read_b64_tr_b16 v[148:149], v188 offset:40960
    v_mfma_f32_16x16x32_bf16 v[64:67], v[168:171], v[124:127], v[64:67]
    ds_read_b64_tr_b16 v[150:151], v188 offset:41216
    v_mfma_f32_16x16x32_bf16 v[84:87], v[164:167], v[128:131], v[84:87]
    ds_read_b64_tr_b16 v[152:153], v191 offset:40960
    v_mfma_f32_16x16x32_bf16 v[88:91], v[168:171], v[128:131], v[88:91]
    ds_read_b64_tr_b16 v[154:155], v191 offset:41216
    v_mfma_f32_16x16x32_bf16 v[20:23], v[172:175], v[116:119], v[20:23]
    v_mfma_f32_16x16x32_bf16 v[44:47], v[172:175], v[120:123], v[44:47]
    v_mfma_f32_16x16x32_bf16 v[68:71], v[172:175], v[124:127], v[68:71]
    v_mfma_f32_16x16x32_bf16 v[92:95], v[172:175], v[128:131], v[92:95]
    v_mfma_f32_16x16x32_bf16 v[24:27], v[176:179], v[116:119], v[24:27]
    v_mfma_f32_16x16x32_bf16 v[48:51], v[176:179], v[120:123], v[48:51]
    v_mfma_f32_16x16x32_bf16 v[72:75], v[176:179], v[124:127], v[72:75]
    v_mfma_f32_16x16x32_bf16 v[96:99], v[176:179], v[128:131], v[96:99]
    s_bitcmp0_b32 s28, 0
    s_cbranch_scc1 cs_1007_x
    s_bitcmp1_b32 s28, 1
    s_cbranch_scc1 cs_1007_h
    v_mfma_f32_16x16x32_bf16 v[212:215], v[156:159], v[224:227], v[212:215]
    v_mfma_f32_16x16x32_bf16 v[216:219], v[160:163], v[224:227], v[216:219]
    v_mfma_f32_16x16x32_bf16 v[220:223], v[164:167], v[224:227], v[220:223]
    s_branch cs_1007_x
cs_1007_h:
    v_mfma_f32_16x16x32_bf16 v[212:215], v[168:171], v[224:227], v[212:215]
    v_mfma_f32_16x16x32_bf16 v[216:219], v[172:175], v[224:227], v[216:219]
    v_mfma_f32_16x16x32_bf16 v[220:223], v[176:179], v[224:227], v[220:223]
cs_1007_x:
    s_waitcnt lgkmcnt(13)
    v_mfma_f32_16x16x32_bf16 v[4:7], v[132:135], v[100:103], v[4:7]
    ds_read_b128 v[116:119], v185 offset:0
    s_waitcnt lgkmcnt(11)
    v_mfma_f32_16x16x32_bf16 v[8:11], v[136:139], v[100:103], v[8:11]
    ds_read_b64_tr_b16 v[156:157], v188 offset:34816
    v_mfma_f32_16x16x32_bf16 v[28:31], v[132:135], v[104:107], v[28:31]
    ds_read_b64_tr_b16 v[158:159], v188 offset:35072
    v_mfma_f32_16x16x32_bf16 v[32:35], v[136:139], v[104:107], v[32:35]
    ds_read_b128 v[120:123], v185 offset:2048
    s_waitcnt lgkmcnt(11)
    v_mfma_f32_16x16x32_bf16 v[12:15], v[140:143], v[100:103], v[12:15]
    ds_read_b64_tr_b16 v[160:161], v191 offset:34816
    v_mfma_f32_16x16x32_bf16 v[52:55], v[132:135], v[108:111], v[52:55]
    ds_read_b64_tr_b16 v[162:163], v191 offset:35072
    v_mfma_f32_16x16x32_bf16 v[36:39], v[140:143], v[104:107], v[36:39]
    ds_read_b128 v[124:127], v185 offset:4096
    v_mfma_f32_16x16x32_bf16 v[56:59], v[136:139], v[108:111], v[56:59]
    ds_read_b64_tr_b16 v[164:165], v188 offset:38912
    v_mfma_f32_16x16x32_bf16 v[60:63], v[140:143], v[108:111], v[60:63]
    ds_read_b64_tr_b16 v[166:167], v188 offset:39168
    s_waitcnt lgkmcnt(13)
    v_mfma_f32_16x16x32_bf16 v[16:19], v[144:147], v[100:103], v[16:19]
    ds_read_b128 v[128:131], v185 offset:6144
    v_mfma_f32_16x16x32_bf16 v[76:79], v[132:135], v[112:115], v[76:79]
    ds_read_b64_tr_b16 v[168:169], v191 offset:38912
    v_mfma_f32_16x16x32_bf16 v[40:43], v[144:147], v[104:107], v[40:43]
    ds_read_b64_tr_b16 v[170:171], v191 offset:39168
    v_mfma_f32_16x16x32_bf16 v[80:83], v[136:139], v[112:115], v[80:83]
    ds_read_b64_tr_b16 v[172:173], v188 offset:43008
    v_mfma_f32_16x16x32_bf16 v[64:67], v[144:147], v[108:111], v[64:67]
    ds_read_b64_tr_b16 v[174:175], v188 offset:43264
    v_mfma_f32_16x16x32_bf16 v[84:87], v[140:143], v[112:115], v[84:87]
    ds_read_b64_tr_b16 v[176:177], v191 offset:43008
    v_mfma_f32_16x16x32_bf16 v[88:91], v[144:147], v[112:115], v[88:91]
    ds_read_b64_tr_b16 v[178:179], v191 offset:43264
    s_waitcnt lgkmcnt(15)
    v_mfma_f32_16x16x32_bf16 v[20:23], v[148:151], v[100:103], v[20:23]
    v_mfma_f32_16x16x32_bf16 v[44:47], v[148:151], v[104:107], v[44:47]
    v_mfma_f32_16x16x32_bf16 v[68:71], v[148:151], v[108:111], v[68:71]
    v_mfma_f32_16x16x32_bf16 v[92:95], v[148:151], v[112:115], v[92:95]
    v_mfma_f32_16x16x32_bf16 v[24:27], v[152:155], v[100:103], v[24:27]
    v_mfma_f32_16x16x32_bf16 v[48:51], v[152:155], v[104:107], v[48:51]
    v_mfma_f32_16x16x32_bf16 v[72:75], v[152:155], v[108:111], v[72:75]
    v_mfma_f32_16x16x32_bf16 v[96:99], v[152:155], v[112:115], v[96:99]
    s_bitcmp1_b32 s28, 0
    s_cbranch_scc1 cs_1008_x
    s_bitcmp1_b32 s28, 1
    s_cbranch_scc1 cs_1008_h
    v_mfma_f32_16x16x32_bf16 v[212:215], v[132:135], v[224:227], v[212:215]
    v_mfma_f32_16x16x32_bf16 v[216:219], v[136:139], v[224:227], v[216:219]
    v_mfma_f32_16x16x32_bf16 v[220:223], v[140:143], v[224:227], v[220:223]
    s_branch cs_1008_x
cs_1008_h:
    v_mfma_f32_16x16x32_bf16 v[212:215], v[144:147], v[224:227], v[212:215]
    v_mfma_f32_16x16x32_bf16 v[216:219], v[148:151], v[224:227], v[216:219]
    v_mfma_f32_16x16x32_bf16 v[220:223], v[152:155], v[224:227], v[220:223]
cs_1008_x:
    s_waitcnt lgkmcnt(13)
    v_mfma_f32_16x16x32_bf16 v[4:7], v[156:159], v[116:119], v[4:7]
    s_waitcnt lgkmcnt(0)
    s_barrier
    ds_read_b128 v[100:103], v180 offset:0
    v_mfma_f32_16x16x32_bf16 v[8:11], v[160:163], v[116:119], v[8:11]
    ds_read_b64_tr_b16 v[132:133], v186 offset:32768
    v_mfma_f32_16x16x32_bf16 v[28:31], v[156:159], v[120:123], v[28:31]
    ds_read_b64_tr_b16 v[134:135], v186 offset:33024
    v_mfma_f32_16x16x32_bf16 v[32:35], v[160:163], v[120:123], v[32:35]
    ds_read_b128 v[104:107], v180 offset:2048
    v_mfma_f32_16x16x32_bf16 v[12:15], v[164:167], v[116:119], v[12:15]
    ds_read_b64_tr_b16 v[136:137], v189 offset:32768
    v_mfma_f32_16x16x32_bf16 v[52:55], v[156:159], v[124:127], v[52:55]
    ds_read_b64_tr_b16 v[138:139], v189 offset:33024
    v_mfma_f32_16x16x32_bf16 v[36:39], v[164:167], v[120:123], v[36:39]
    ds_read_b128 v[108:111], v180 offset:4096
    v_mfma_f32_16x16x32_bf16 v[56:59], v[160:163], v[124:127], v[56:59]
    ds_read_b64_tr_b16 v[140:141], v186 offset:36864
    v_mfma_f32_16x16x32_bf16 v[60:63], v[164:167], v[124:127], v[60:63]
    ds_read_b64_tr_b16 v[142:143], v186 offset:37120
    v_mfma_f32_16x16x32_bf16 v[16:19], v[168:171], v[116:119], v[16:19]
    ds_read_b128 v[112:115], v180 offset:6144
    v_mfma_f32_16x16x32_bf16 v[76:79], v[156:159], v[128:131], v[76:79]
    ds_read_b64_tr_b16 v[144:145], v189 offset:36864
    v_mfma_f32_16x16x32_bf16 v[40:43], v[168:171], v[120:123], v[40:43]
    ds_read_b64_tr_b16 v[146:147], v189 offset:37120
    v_mfma_f32_16x16x32_bf16 v[80:83], v[160:163], v[128:131], v[80:83]
    ds_read_b64_tr_b16 v[148:149], v186 offset:40960
    v_mfma_f32_16x16x32_bf16 v[64:67], v[168:171], v[124:127], v[64:67]
    ds_read_b64_tr_b16 v[150:151], v186 offset:41216
    v_mfma_f32_16x16x32_bf16 v[84:87], v[164:167], v[128:131], v[84:87]
    ds_read_b64_tr_b16 v[152:153], v189 offset:40960
    v_mfma_f32_16x16x32_bf16 v[88:91], v[168:171], v[128:131], v[88:91]
    ds_read_b64_tr_b16 v[154:155], v189 offset:41216
    v_mfma_f32_16x16x32_bf16 v[20:23], v[172:175], v[116:119], v[20:23]
    v_mfma_f32_16x16x32_bf16 v[44:47], v[172:175], v[120:123], v[44:47]
    v_mfma_f32_16x16x32_bf16 v[68:71], v[172:175], v[124:127], v[68:71]
    v_mfma_f32_16x16x32_bf16 v[92:95], v[172:175], v[128:131], v[92:95]
    v_mfma_f32_16x16x32_bf16 v[24:27], v[176:179], v[116:119], v[24:27]
    v_mfma_f32_16x16x32_bf16 v[48:51], v[176:179], v[120:123], v[48:51]
    v_mfma_f32_16x16x32_bf16 v[72:75], v[176:179], v[124:127], v[72:75]
    v_mfma_f32_16x16x32_bf16 v[96:99], v[176:179], v[128:131], v[96:99]
    s_bitcmp0_b32 s28, 0
    s_cbranch_scc1 cs_1009_x
    s_bitcmp1_b32 s28, 1
    s_cbranch_scc1 cs_1009_h
    v_mfma_f32_16x16x32_bf16 v[212:215], v[156:159], v[224:227], v[212:215]
    v_mfma_f32_16x16x32_bf16 v[216:219], v[160:163], v[224:227], v[216:219]
    v_mfma_f32_16x16x32_bf16 v[220:223], v[164:167], v[224:227], v[220:223]
    s_branch cs_1009_x
cs_1009_h:
    v_mfma_f32_16x16x32_bf16 v[212:215], v[168:171], v[224:227], v[212:215]
    v_mfma_f32_16x16x32_bf16 v[216:219], v[172:175], v[224:227], v[216:219]
    v_mfma_f32_16x16x32_bf16 v[220:223], v[176:179], v[224:227], v[220:223]
cs_1009_x:
    s_sub_u32 s38, s38, 1
    s_cmp_lg_u32 s38, 0
    s_cbranch_scc1 p1_cloop
    s_waitcnt lgkmcnt(13)
    v_mfma_f32_16x16x32_bf16 v[4:7], v[132:135], v[100:103], v[4:7]
    ds_read_b128 v[116:119], v181 offset:0
    s_waitcnt lgkmcnt(11)
    v_mfma_f32_16x16x32_bf16 v[8:11], v[136:139], v[100:103], v[8:11]
    ds_read_b64_tr_b16 v[156:157], v186 offset:34816
    v_mfma_f32_16x16x32_bf16 v[28:31], v[132:135], v[104:107], v[28:31]
    ds_read_b64_tr_b16 v[158:159], v186 offset:35072
    v_mfma_f32_16x16x32_bf16 v[32:35], v[136:139], v[104:107], v[32:35]
    ds_read_b128 v[120:123], v181 offset:2048
    s_waitcnt lgkmcnt(11)
    v_mfma_f32_16x16x32_bf16 v[12:15], v[140:143], v[100:103], v[12:15]
    ds_read_b64_tr_b16 v[160:161], v189 offset:34816
    v_mfma_f32_16x16x32_bf16 v[52:55], v[132:135], v[108:111], v[52:55]
    ds_read_b64_tr_b16 v[162:163], v189 offset:35072
    v_mfma_f32_16x16x32_bf16 v[36:39], v[140:143], v[104:107], v[36:39]
    ds_read_b128 v[124:127], v181 offset:4096
    v_mfma_f32_16x16x32_bf16 v[56:59], v[136:139], v[108:111], v[56:59]
    ds_read_b64_tr_b16 v[164:165], v186 offset:38912
    v_mfma_f32_16x16x32_bf16 v[60:63], v[140:143], v[108:111], v[60:63]
    ds_read_b64_tr_b16 v[166:167], v186 offset:39168
    s_waitcnt lgkmcnt(13)
    v_mfma_f32_16x16x32_bf16 v[16:19], v[144:147], v[100:103], v[16:19]
    ds_read_b128 v[128:131], v181 offset:6144
    v_mfma_f32_16x16x32_bf16 v[76:79], v[132:135], v[112:115], v[76:79]
    ds_read_b64_tr_b16 v[168:169], v189 offset:38912
    v_mfma_f32_16x16x32_bf16 v[40:43], v[144:147], v[104:107], v[40:43]
    ds_read_b64_tr_b16 v[170:171], v189 offset:39168
    v_mfma_f32_16x16x32_bf16 v[80:83], v[136:139], v[112:115], v[80:83]
    ds_read_b64_tr_b16 v[172:173], v186 offset:43008
    v_mfma_f32_16x16x32_bf16 v[64:67], v[144:147], v[108:111], v[64:67]
    ds_read_b64_tr_b16 v[174:175], v186 offset:43264
    v_mfma_f32_16x16x32_bf16 v[84:87], v[140:143], v[112:115], v[84:87]
    ds_read_b64_tr_b16 v[176:177], v189 offset:43008
    v_mfma_f32_16x16x32_bf16 v[88:91], v[144:147], v[112:115], v[88:91]
    ds_read_b64_tr_b16 v[178:179], v189 offset:43264
    s_waitcnt lgkmcnt(15)
    v_mfma_f32_16x16x32_bf16 v[20:23], v[148:151], v[100:103], v[20:23]
    v_mfma_f32_16x16x32_bf16 v[44:47], v[148:151], v[104:107], v[44:47]
    v_mfma_f32_16x16x32_bf16 v[68:71], v[148:151], v[108:111], v[68:71]
    v_mfma_f32_16x16x32_bf16 v[92:95], v[148:151], v[112:115], v[92:95]
    v_mfma_f32_16x16x32_bf16 v[24:27], v[152:155], v[100:103], v[24:27]
    v_mfma_f32_16x16x32_bf16 v[48:51], v[152:155], v[104:107], v[48:51]
    v_mfma_f32_16x16x32_bf16 v[72:75], v[152:155], v[108:111], v[72:75]
    v_mfma_f32_16x16x32_bf16 v[96:99], v[152:155], v[112:115], v[96:99]
    s_bitcmp1_b32 s28, 0
    s_cbranch_scc1 cs_1010_x
    s_bitcmp1_b32 s28, 1
    s_cbranch_scc1 cs_1010_h
    v_mfma_f32_16x16x32_bf16 v[212:215], v[132:135], v[224:227], v[212:215]
    v_mfma_f32_16x16x32_bf16 v[216:219], v[136:139], v[224:227], v[216:219]
    v_mfma_f32_16x16x32_bf16 v[220:223], v[140:143], v[224:227], v[220:223]
    s_branch cs_1010_x
cs_1010_h:
    v_mfma_f32_16x16x32_bf16 v[212:215], v[144:147], v[224:227], v[212:215]
    v_mfma_f32_16x16x32_bf16 v[216:219], v[148:151], v[224:227], v[216:219]
    v_mfma_f32_16x16x32_bf16 v[220:223], v[152:155], v[224:227], v[220:223]
cs_1010_x:
    s_waitcnt lgkmcnt(13)
    v_mfma_f32_16x16x32_bf16 v[4:7], v[156:159], v[116:119], v[4:7]
    s_waitcnt lgkmcnt(10)
    v_mfma_f32_16x16x32_bf16 v[8:11], v[160:163], v[116:119], v[8:11]
    v_mfma_f32_16x16x32_bf16 v[28:31], v[156:159], v[120:123], v[28:31]
    v_mfma_f32_16x16x32_bf16 v[32:35], v[160:163], v[120:123], v[32:35]
    s_waitcnt lgkmcnt(7)
    v_mfma_f32_16x16x32_bf16 v[12:15], v[164:167], v[116:119], v[12:15]
    v_mfma_f32_16x16x32_bf16 v[52:55], v[156:159], v[124:127], v[52:55]
    v_mfma_f32_16x16x32_bf16 v[36:39], v[164:167], v[120:123], v[36:39]
    v_mfma_f32_16x16x32_bf16 v[56:59], v[160:163], v[124:127], v[56:59]
    v_mfma_f32_16x16x32_bf16 v[60:63], v[164:167], v[124:127], v[60:63]
    s_waitcnt lgkmcnt(4)
    v_mfma_f32_16x16x32_bf16 v[16:19], v[168:171], v[116:119], v[16:19]
    v_mfma_f32_16x16x32_bf16 v[76:79], v[156:159], v[128:131], v[76:79]
    v_mfma_f32_16x16x32_bf16 v[40:43], v[168:171], v[120:123], v[40:43]
    v_mfma_f32_16x16x32_bf16 v[80:83], v[160:163], v[128:131], v[80:83]
    v_mfma_f32_16x16x32_bf16 v[64:67], v[168:171], v[124:127], v[64:67]
    v_mfma_f32_16x16x32_bf16 v[84:87], v[164:167], v[128:131], v[84:87]
    v_mfma_f32_16x16x32_bf16 v[88:91], v[168:171], v[128:131], v[88:91]
    s_waitcnt lgkmcnt(2)
    v_mfma_f32_16x16x32_bf16 v[20:23], v[172:175], v[116:119], v[20:23]
    v_mfma_f32_16x16x32_bf16 v[44:47], v[172:175], v[120:123], v[44:47]
    v_mfma_f32_16x16x32_bf16 v[68:71], v[172:175], v[124:127], v[68:71]
    v_mfma_f32_16x16x32_bf16 v[92:95], v[172:175], v[128:131], v[92:95]
    s_waitcnt lgkmcnt(0)
    v_mfma_f32_16x16x32_bf16 v[24:27], v[176:179], v[116:119], v[24:27]
    v_mfma_f32_16x16x32_bf16 v[48:51], v[176:179], v[120:123], v[48:51]
    v_mfma_f32_16x16x32_bf16 v[72:75], v[176:179], v[124:127], v[72:75]
    v_mfma_f32_16x16x32_bf16 v[96:99], v[176:179], v[128:131], v[96:99]
    s_bitcmp0_b32 s28, 0
    s_cbranch_scc1 cs_1011_x
    s_bitcmp1_b32 s28, 1
    s_cbranch_scc1 cs_1011_h
    v_mfma_f32_16x16x32_bf16 v[212:215], v[156:159], v[224:227], v[212:215]
    v_mfma_f32_16x16x32_bf16 v[216:219], v[160:163], v[224:227], v[216:219]
    v_mfma_f32_16x16x32_bf16 v[220:223], v[164:167], v[224:227], v[220:223]
    s_branch cs_1011_x
cs_1011_h:
    v_mfma_f32_16x16x32_bf16 v[212:215], v[168:171], v[224:227], v[212:215]
    v_mfma_f32_16x16x32_bf16 v[216:219], v[172:175], v[224:227], v[216:219]
    v_mfma_f32_16x16x32_bf16 v[220:223], v[176:179], v[224:227], v[220:223]
cs_1011_x:
    s_mul_i32 s31, s28, 192
    s_add_u32 s31, s31, 141440
    v_lshl_add_u32 v100, v192, 4, s31
    s_nop 7
    v_cmp_eq_u32 vcc, 0, v193
    s_nop 2
    s_and_saveexec_b64 s[66:67], vcc
    ds_write_b128 v100, v[212:215] offset:0
    ds_write_b128 v100, v[216:219] offset:64
    ds_write_b128 v100, v[220:223] offset:128
    s_mov_b64 exec, s[66:67]
    s_waitcnt lgkmcnt(0)
    s_barrier
    v_lshlrev_b32 v100, 4, v192
    v_add_u32 v100, 141440, v100
    ds_read_b128 v[104:107], v100 offset:0
    ds_read_b128 v[128:131], v100 offset:192
    ds_read_b128 v[108:111], v100 offset:64
    ds_read_b128 v[132:135], v100 offset:256
    ds_read_b128 v[112:115], v100 offset:128
    ds_read_b128 v[136:139], v100 offset:320
    ds_read_b128 v[116:119], v100 offset:384
    ds_read_b128 v[140:143], v100 offset:576
    ds_read_b128 v[120:123], v100 offset:448
    ds_read_b128 v[144:147], v100 offset:640
    ds_read_b128 v[124:127], v100 offset:512
    ds_read_b128 v[148:151], v100 offset:704
    s_waitcnt vmcnt(0) lgkmcnt(0)
    v_pk_add_f32 v[104:105], v[104:105], v[128:129]
    v_pk_add_f32 v[106:107], v[106:107], v[130:131]
    v_pk_add_f32 v[108:109], v[108:109], v[132:133]
    v_pk_add_f32 v[110:111], v[110:111], v[134:135]
    v_pk_add_f32 v[112:113], v[112:113], v[136:137]
    v_pk_add_f32 v[114:115], v[114:115], v[138:139]
    v_pk_add_f32 v[116:117], v[116:117], v[140:141]
    v_pk_add_f32 v[118:119], v[118:119], v[142:143]
    v_pk_add_f32 v[120:121], v[120:121], v[144:145]
    v_pk_add_f32 v[122:123], v[122:123], v[146:147]
    v_pk_add_f32 v[124:125], v[124:125], v[148:149]
    v_pk_add_f32 v[126:127], v[126:127], v[150:151]
    v_pk_fma_f32 v[4:5], v[104:105], v[200:201], v[4:5] op_sel_hi:[1,0,1] neg_lo:[0,1,0] neg_hi:[0,1,0]
    v_pk_fma_f32 v[6:7], v[106:107], v[200:201], v[6:7] op_sel_hi:[1,0,1] neg_lo:[0,1,0] neg_hi:[0,1,0]
    v_pk_mul_f32 v[4:5], v[4:5], v[200:201] op_sel:[0,1] op_sel_hi:[1,1]
    v_pk_mul_f32 v[6:7], v[6:7], v[200:201] op_sel:[0,1] op_sel_hi:[1,1]
    v_pk_fma_f32 v[8:9], v[108:109], v[200:201], v[8:9] op_sel_hi:[1,0,1] neg_lo:[0,1,0] neg_hi:[0,1,0]
    v_pk_fma_f32 v[10:11], v[110:111], v[200:201], v[10:11] op_sel_hi:[1,0,1] neg_lo:[0,1,0] neg_hi:[0,1,0]
    v_pk_mul_f32 v[8:9], v[8:9], v[200:201] op_sel:[0,1] op_sel_hi:[1,1]
    v_pk_mul_f32 v[10:11], v[10:11], v[200:201] op_sel:[0,1] op_sel_hi:[1,1]
    v_pk_fma_f32 v[12:13], v[112:113], v[200:201], v[12:13] op_sel_hi:[1,0,1] neg_lo:[0,1,0] neg_hi:[0,1,0]
    v_pk_fma_f32 v[14:15], v[114:115], v[200:201], v[14:15] op_sel_hi:[1,0,1] neg_lo:[0,1,0] neg_hi:[0,1,0]
    v_pk_mul_f32 v[12:13], v[12:13], v[200:201] op_sel:[0,1] op_sel_hi:[1,1]
    v_pk_mul_f32 v[14:15], v[14:15], v[200:201] op_sel:[0,1] op_sel_hi:[1,1]
    v_pk_fma_f32 v[16:17], v[116:117], v[200:201], v[16:17] op_sel_hi:[1,0,1] neg_lo:[0,1,0] neg_hi:[0,1,0]
    v_pk_fma_f32 v[18:19], v[118:119], v[200:201], v[18:19] op_sel_hi:[1,0,1] neg_lo:[0,1,0] neg_hi:[0,1,0]
    v_pk_mul_f32 v[16:17], v[16:17], v[200:201] op_sel:[0,1] op_sel_hi:[1,1]
    v_pk_mul_f32 v[18:19], v[18:19], v[200:201] op_sel:[0,1] op_sel_hi:[1,1]
    v_pk_fma_f32 v[20:21], v[120:121], v[200:201], v[20:21] op_sel_hi:[1,0,1] neg_lo:[0,1,0] neg_hi:[0,1,0]
    v_pk_fma_f32 v[22:23], v[122:123], v[200:201], v[22:23] op_sel_hi:[1,0,1] neg_lo:[0,1,0] neg_hi:[0,1,0]
    v_pk_mul_f32 v[20:21], v[20:21], v[200:201] op_sel:[0,1] op_sel_hi:[1,1]
    v_pk_mul_f32 v[22:23], v[22:23], v[200:201] op_sel:[0,1] op_sel_hi:[1,1]
    v_pk_fma_f32 v[24:25], v[124:125], v[200:201], v[24:25] op_sel_hi:[1,0,1] neg_lo:[0,1,0] neg_hi:[0,1,0]
    v_pk_fma_f32 v[26:27], v[126:127], v[200:201], v[26:27] op_sel_hi:[1,0,1] neg_lo:[0,1,0] neg_hi:[0,1,0]
    v_pk_mul_f32 v[24:25], v[24:25], v[200:201] op_sel:[0,1] op_sel_hi:[1,1]
    v_pk_mul_f32 v[26:27], v[26:27], v[200:201] op_sel:[0,1] op_sel_hi:[1,1]
    v_pk_fma_f32 v[28:29], v[104:105], v[202:203], v[28:29] op_sel_hi:[1,0,1] neg_lo:[0,1,0] neg_hi:[0,1,0]
    v_pk_fma_f32 v[30:31], v[106:107], v[202:203], v[30:31] op_sel_hi:[1,0,1] neg_lo:[0,1,0] neg_hi:[0,1,0]
    v_pk_mul_f32 v[28:29], v[28:29], v[202:203] op_sel:[0,1] op_sel_hi:[1,1]
    v_pk_mul_f32 v[30:31], v[30:31], v[202:203] op_sel:[0,1] op_sel_hi:[1,1]
    v_pk_fma_f32 v[32:33], v[108:109], v[202:203], v[32:33] op_sel_hi:[1,0,1] neg_lo:[0,1,0] neg_hi:[0,1,0]
    v_pk_fma_f32 v[34:35], v[110:111], v[202:203], v[34:35] op_sel_hi:[1,0,1] neg_lo:[0,1,0] neg_hi:[0,1,0]
    v_pk_mul_f32 v[32:33], v[32:33], v[202:203] op_sel:[0,1] op_sel_hi:[1,1]
    v_pk_mul_f32 v[34:35], v[34:35], v[202:203] op_sel:[0,1] op_sel_hi:[1,1]
    v_pk_fma_f32 v[36:37], v[112:113], v[202:203], v[36:37] op_sel_hi:[1,0,1] neg_lo:[0,1,0] neg_hi:[0,1,0]
    v_pk_fma_f32 v[38:39], v[114:115], v[202:203], v[38:39] op_sel_hi:[1,0,1] neg_lo:[0,1,0] neg_hi:[0,1,0]
    v_pk_mul_f32 v[36:37], v[36:37], v[202:203] op_sel:[0,1] op_sel_hi:[1,1]
    v_pk_mul_f32 v[38:39], v[38:39], v[202:203] op_sel:[0,1] op_sel_hi:[1,1]
    v_pk_fma_f32 v[40:41], v[116:117], v[202:203], v[40:41] op_sel_hi:[1,0,1] neg_lo:[0,1,0] neg_hi:[0,1,0]
    v_pk_fma_f32 v[42:43], v[118:119], v[202:203], v[42:43] op_sel_hi:[1,0,1] neg_lo:[0,1,0] neg_hi:[0,1,0]
    v_pk_mul_f32 v[40:41], v[40:41], v[202:203] op_sel:[0,1] op_sel_hi:[1,1]
    v_pk_mul_f32 v[42:43], v[42:43], v[202:203] op_sel:[0,1] op_sel_hi:[1,1]
    v_pk_fma_f32 v[44:45], v[120:121], v[202:203], v[44:45] op_sel_hi:[1,0,1] neg_lo:[0,1,0] neg_hi:[0,1,0]
    v_pk_fma_f32 v[46:47], v[122:123], v[202:203], v[46:47] op_sel_hi:[1,0,1] neg_lo:[0,1,0] neg_hi:[0,1,0]
    v_pk_mul_f32 v[44:45], v[44:45], v[202:203] op_sel:[0,1] op_sel_hi:[1,1]
    v_pk_mul_f32 v[46:47], v[46:47], v[202:203] op_sel:[0,1] op_sel_hi:[1,1]
    v_pk_fma_f32 v[48:49], v[124:125], v[202:203], v[48:49] op_sel_hi:[1,0,1] neg_lo:[0,1,0] neg_hi:[0,1,0]
    v_pk_fma_f32 v[50:51], v[126:127], v[202:203], v[50:51] op_sel_hi:[1,0,1] neg_lo:[0,1,0] neg_hi:[0,1,0]
    v_pk_mul_f32 v[48:49], v[48:49], v[202:203] op_sel:[0,1] op_sel_hi:[1,1]
    v_pk_mul_f32 v[50:51], v[50:51], v[202:203] op_sel:[0,1] op_sel_hi:[1,1]
    v_pk_fma_f32 v[52:53], v[104:105], v[204:205], v[52:53] op_sel_hi:[1,0,1] neg_lo:[0,1,0] neg_hi:[0,1,0]
    v_pk_fma_f32 v[54:55], v[106:107], v[204:205], v[54:55] op_sel_hi:[1,0,1] neg_lo:[0,1,0] neg_hi:[0,1,0]
    v_pk_mul_f32 v[52:53], v[52:53], v[204:205] op_sel:[0,1] op_sel_hi:[1,1]
    v_pk_mul_f32 v[54:55], v[54:55], v[204:205] op_sel:[0,1] op_sel_hi:[1,1]
    v_pk_fma_f32 v[56:57], v[108:109], v[204:205], v[56:57] op_sel_hi:[1,0,1] neg_lo:[0,1,0] neg_hi:[0,1,0]
    v_pk_fma_f32 v[58:59], v[110:111], v[204:205], v[58:59] op_sel_hi:[1,0,1] neg_lo:[0,1,0] neg_hi:[0,1,0]
    v_pk_mul_f32 v[56:57], v[56:57], v[204:205] op_sel:[0,1] op_sel_hi:[1,1]
    v_pk_mul_f32 v[58:59], v[58:59], v[204:205] op_sel:[0,1] op_sel_hi:[1,1]
    v_pk_fma_f32 v[60:61], v[112:113], v[204:205], v[60:61] op_sel_hi:[1,0,1] neg_lo:[0,1,0] neg_hi:[0,1,0]
    v_pk_fma_f32 v[62:63], v[114:115], v[204:205], v[62:63] op_sel_hi:[1,0,1] neg_lo:[0,1,0] neg_hi:[0,1,0]
    v_pk_mul_f32 v[60:61], v[60:61], v[204:205] op_sel:[0,1] op_sel_hi:[1,1]
    v_pk_mul_f32 v[62:63], v[62:63], v[204:205] op_sel:[0,1] op_sel_hi:[1,1]
    v_pk_fma_f32 v[64:65], v[116:117], v[204:205], v[64:65] op_sel_hi:[1,0,1] neg_lo:[0,1,0] neg_hi:[0,1,0]
    v_pk_fma_f32 v[66:67], v[118:119], v[204:205], v[66:67] op_sel_hi:[1,0,1] neg_lo:[0,1,0] neg_hi:[0,1,0]
    v_pk_mul_f32 v[64:65], v[64:65], v[204:205] op_sel:[0,1] op_sel_hi:[1,1]
    v_pk_mul_f32 v[66:67], v[66:67], v[204:205] op_sel:[0,1] op_sel_hi:[1,1]
    v_pk_fma_f32 v[68:69], v[120:121], v[204:205], v[68:69] op_sel_hi:[1,0,1] neg_lo:[0,1,0] neg_hi:[0,1,0]
    v_pk_fma_f32 v[70:71], v[122:123], v[204:205], v[70:71] op_sel_hi:[1,0,1] neg_lo:[0,1,0] neg_hi:[0,1,0]
    v_pk_mul_f32 v[68:69], v[68:69], v[204:205] op_sel:[0,1] op_sel_hi:[1,1]
    v_pk_mul_f32 v[70:71], v[70:71], v[204:205] op_sel:[0,1] op_sel_hi:[1,1]
    v_pk_fma_f32 v[72:73], v[124:125], v[204:205], v[72:73] op_sel_hi:[1,0,1] neg_lo:[0,1,0] neg_hi:[0,1,0]
    v_pk_fma_f32 v[74:75], v[126:127], v[204:205], v[74:75] op_sel_hi:[1,0,1] neg_lo:[0,1,0] neg_hi:[0,1,0]
    v_pk_mul_f32 v[72:73], v[72:73], v[204:205] op_sel:[0,1] op_sel_hi:[1,1]
    v_pk_mul_f32 v[74:75], v[74:75], v[204:205] op_sel:[0,1] op_sel_hi:[1,1]
    v_pk_fma_f32 v[76:77], v[104:105], v[206:207], v[76:77] op_sel_hi:[1,0,1] neg_lo:[0,1,0] neg_hi:[0,1,0]
    v_pk_fma_f32 v[78:79], v[106:107], v[206:207], v[78:79] op_sel_hi:[1,0,1] neg_lo:[0,1,0] neg_hi:[0,1,0]
    v_pk_mul_f32 v[76:77], v[76:77], v[206:207] op_sel:[0,1] op_sel_hi:[1,1]
    v_pk_mul_f32 v[78:79], v[78:79], v[206:207] op_sel:[0,1] op_sel_hi:[1,1]
    v_pk_fma_f32 v[80:81], v[108:109], v[206:207], v[80:81] op_sel_hi:[1,0,1] neg_lo:[0,1,0] neg_hi:[0,1,0]
    v_pk_fma_f32 v[82:83], v[110:111], v[206:207], v[82:83] op_sel_hi:[1,0,1] neg_lo:[0,1,0] neg_hi:[0,1,0]
    v_pk_mul_f32 v[80:81], v[80:81], v[206:207] op_sel:[0,1] op_sel_hi:[1,1]
    v_pk_mul_f32 v[82:83], v[82:83], v[206:207] op_sel:[0,1] op_sel_hi:[1,1]
    v_pk_fma_f32 v[84:85], v[112:113], v[206:207], v[84:85] op_sel_hi:[1,0,1] neg_lo:[0,1,0] neg_hi:[0,1,0]
    v_pk_fma_f32 v[86:87], v[114:115], v[206:207], v[86:87] op_sel_hi:[1,0,1] neg_lo:[0,1,0] neg_hi:[0,1,0]
    v_pk_mul_f32 v[84:85], v[84:85], v[206:207] op_sel:[0,1] op_sel_hi:[1,1]
    v_pk_mul_f32 v[86:87], v[86:87], v[206:207] op_sel:[0,1] op_sel_hi:[1,1]
    v_pk_fma_f32 v[88:89], v[116:117], v[206:207], v[88:89] op_sel_hi:[1,0,1] neg_lo:[0,1,0] neg_hi:[0,1,0]
    v_pk_fma_f32 v[90:91], v[118:119], v[206:207], v[90:91] op_sel_hi:[1,0,1] neg_lo:[0,1,0] neg_hi:[0,1,0]
    v_pk_mul_f32 v[88:89], v[88:89], v[206:207] op_sel:[0,1] op_sel_hi:[1,1]
    v_pk_mul_f32 v[90:91], v[90:91], v[206:207] op_sel:[0,1] op_sel_hi:[1,1]
    v_pk_fma_f32 v[92:93], v[120:121], v[206:207], v[92:93] op_sel_hi:[1,0,1] neg_lo:[0,1,0] neg_hi:[0,1,0]
    v_pk_fma_f32 v[94:95], v[122:123], v[206:207], v[94:95] op_sel_hi:[1,0,1] neg_lo:[0,1,0] neg_hi:[0,1,0]
    v_pk_mul_f32 v[92:93], v[92:93], v[206:207] op_sel:[0,1] op_sel_hi:[1,1]
    v_pk_mul_f32 v[94:95], v[94:95], v[206:207] op_sel:[0,1] op_sel_hi:[1,1]
    v_pk_fma_f32 v[96:97], v[124:125], v[206:207], v[96:97] op_sel_hi:[1,0,1] neg_lo:[0,1,0] neg_hi:[0,1,0]
    v_pk_fma_f32 v[98:99], v[126:127], v[206:207], v[98:99] op_sel_hi:[1,0,1] neg_lo:[0,1,0] neg_hi:[0,1,0]
    v_pk_mul_f32 v[96:97], v[96:97], v[206:207] op_sel:[0,1] op_sel_hi:[1,1]
    v_pk_mul_f32 v[98:99], v[98:99], v[206:207] op_sel:[0,1] op_sel_hi:[1,1]
    s_getpc_b64 s[74:75]
fa_1012:
    s_add_u32 s74, s74, feat_sub-fa_1012
    s_addc_u32 s75, s75, 0
    v_lshl_add_u32 v100, v192, 2, v194
    v_lshlrev_b32 v100, 6, v100
    v_lshl_add_u32 v100, v195, 3, v100
    v_add_u32 v100, 135168, v100
    ds_read_b64_tr_b16 v[200:201], v100 offset:0
    ds_read_b64_tr_b16 v[202:203], v100 offset:1024
    ds_read_b64_tr_b16 v[204:205], v100 offset:32
    ds_read_b64_tr_b16 v[206:207], v100 offset:1056
    s_lshl_b32 s31, s28, 6
    v_add_u32 v101, s31, v193
    v_mul_u32_u24 v102, 80, v101
    v_mul_u32_u24 v101, 144, v101
    v_lshl_add_u32 v101, v192, 3, v101
    v_lshl_add_u32 v102, v192, 3, v102
    v_add_u32 v101, 69632, v101
    v_add_u32 v102, 106496, v102
    s_lshl_b32 s31, s28, 11
    s_add_u32 s31, s31, 61440
    v_lshl_add_u32 v103, v0, 4, s31
    v_cvt_pk_bf16_f32 v60, v60, v61
    v_cvt_pk_bf16_f32 v61, v62, v63
    v_cvt_pk_bf16_f32 v62, v64, v65
    v_cvt_pk_bf16_f32 v63, v66, v67
    ds_write_b128 v103, v[60:63] offset:0
    v_cvt_pk_bf16_f32 v84, v84, v85
    v_cvt_pk_bf16_f32 v85, v86, v87
    v_cvt_pk_bf16_f32 v86, v88, v89
    v_cvt_pk_bf16_f32 v87, v90, v91
    ds_write_b128 v103, v[84:87] offset:1024
    s_lshl_b32 s31, s28, 12
    s_add_u32 s31, s31, 45056
    v_lshl_add_u32 v104, v0, 4, s31
    v_cvt_pk_bf16_f32 v20, v20, v21
    v_cvt_pk_bf16_f32 v21, v22, v23
    ds_write_b64 v102, v[20:21] offset:0
    v_cvt_pk_bf16_f32 v24, v24, v25
    v_cvt_pk_bf16_f32 v25, v26, v27
    ds_write_b64 v102, v[24:25] offset:32
    v_cvt_pk_bf16_f32 v44, v44, v45
    v_cvt_pk_bf16_f32 v45, v46, v47
    ds_write_b64 v102, v[44:45] offset:1280
    v_cvt_pk_bf16_f32 v48, v48, v49
    v_cvt_pk_bf16_f32 v49, v50, v51
    ds_write_b64 v102, v[48:49] offset:1312
    v_cvt_pk_bf16_f32 v68, v68, v69
    v_cvt_pk_bf16_f32 v69, v70, v71
    ds_write_b64 v102, v[68:69] offset:2560
    v_cvt_pk_bf16_f32 v72, v72, v73
    v_cvt_pk_bf16_f32 v73, v74, v75
    ds_write_b64 v102, v[72:73] offset:2592
    v_cvt_pk_bf16_f32 v92, v92, v93
    v_cvt_pk_bf16_f32 v93, v94, v95
    ds_write_b64 v102, v[92:93] offset:3840
    v_cvt_pk_bf16_f32 v96, v96, v97
    v_cvt_pk_bf16_f32 v97, v98, v99
    ds_write_b64 v102, v[96:97] offset:3872
    v_cvt_pk_bf16_f32 v4, v4, v5
    v_cvt_pk_bf16_f32 v5, v6, v7
    v_cvt_pk_bf16_f32 v6, v8, v9
    v_cvt_pk_bf16_f32 v7, v10, v11
    ds_write_b128 v104, v[4:7] offset:0
    v_cvt_pk_bf16_f32 v28, v28, v29
    v_cvt_pk_bf16_f32 v29, v30, v31
    v_cvt_pk_bf16_f32 v30, v32, v33
    v_cvt_pk_bf16_f32 v31, v34, v35
    ds_write_b128 v104, v[28:31] offset:1024
    v_cvt_pk_bf16_f32 v52, v52, v53
    v_cvt_pk_bf16_f32 v53, v54, v55
    v_cvt_pk_bf16_f32 v54, v56, v57
    v_cvt_pk_bf16_f32 v55, v58, v59
    ds_write_b128 v104, v[52:55] offset:2048
    v_cvt_pk_bf16_f32 v76, v76, v77
    v_cvt_pk_bf16_f32 v77, v78, v79
    v_cvt_pk_bf16_f32 v78, v80, v81
    v_cvt_pk_bf16_f32 v79, v82, v83
    ds_write_b128 v104, v[76:79] offset:3072
    v_cvt_pk_bf16_f32 v12, v12, v13
    v_cvt_pk_bf16_f32 v13, v14, v15
    v_cvt_pk_bf16_f32 v14, v16, v17
    v_cvt_pk_bf16_f32 v15, v18, v19
    v_cvt_pk_bf16_f32 v36, v36, v37
    v_cvt_pk_bf16_f32 v37, v38, v39
    v_cvt_pk_bf16_f32 v38, v40, v41
    v_cvt_pk_bf16_f32 v39, v42, v43
    s_waitcnt lgkmcnt(0)
    s_barrier
    v_mov_b32 v208, v12
    v_mov_b32 v209, v13
    v_mov_b32 v210, v14
    v_mov_b32 v211, v15
    s_swappc_b64 s[72:73], s[74:75]
    ds_write_b64 v101, v[244:245] offset:0
    ds_write_b64 v101, v[248:249] offset:64
    ds_write_b64 v101, v[246:247] offset:32
    ds_write_b64 v101, v[250:251] offset:96
    v_mov_b32 v208, v36
    v_mov_b32 v209, v37
    v_mov_b32 v210, v38
    v_mov_b32 v211, v39
    s_swappc_b64 s[72:73], s[74:75]
    ds_write_b64 v101, v[244:245] offset:2304
    ds_write_b64 v101, v[248:249] offset:2368
    ds_write_b64 v101, v[246:247] offset:2336
    ds_write_b64 v101, v[250:251] offset:2400
    s_waitcnt lgkmcnt(0)
    s_barrier
    v_lshl_add_u32 v105, v192, 3, v194
    v_mul_u32_u24 v106, 80, v105
    v_mul_u32_u24 v105, 144, v105
    v_lshl_add_u32 v105, v195, 3, v105
    v_lshl_add_u32 v106, v195, 3, v106
    s_lshl_b32 s31, s28, 5
    s_add_u32 s31, s31, 69632
    v_add_u32 v105, s31, v105
    v_add_u32 v106, 106496, v106
    v_mov_b32 v212, 0
    v_mov_b32 v216, 0
    v_mov_b32 v220, 0
    v_mov_b32 v224, 0x3f803f80
    v_mov_b32 v213, 0
    v_mov_b32 v217, 0
    v_mov_b32 v221, 0
    v_mov_b32 v225, 0x3f803f80
    v_mov_b32 v214, 0
    v_mov_b32 v218, 0
    v_mov_b32 v222, 0
    v_mov_b32 v226, 0x3f803f80
    v_mov_b32 v215, 0
    v_mov_b32 v219, 0
    v_mov_b32 v223, 0
    v_mov_b32 v227, 0x3f803f80
    ds_read_b64_tr_b16 v[4:5], v105 offset:0
    ds_read_b64_tr_b16 v[6:7], v105 offset:576
    ds_read_b64_tr_b16 v[8:9], v106 offset:0
    ds_read_b64_tr_b16 v[10:11], v106 offset:320
    ds_read_b64_tr_b16 v[12:13], v106 offset:32
    ds_read_b64_tr_b16 v[14:15], v106 offset:352
    ds_read_b64_tr_b16 v[16:17], v105 offset:4608
    ds_read_b64_tr_b16 v[18:19], v105 offset:5184
    ds_read_b64_tr_b16 v[20:21], v106 offset:2560
    ds_read_b64_tr_b16 v[22:23], v106 offset:2880
    ds_read_b64_tr_b16 v[24:25], v106 offset:2592
    ds_read_b64_tr_b16 v[26:27], v106 offset:2912
    s_lshl_b32 s31, s30, 3
    s_add_u32 s31, s31, s29
    s_mul_i32 s31, s31, 8448
    s_add_u32 s31, s31, 29360128
    s_lshl_b32 s32, s28, 11
    s_add_u32 s32, s32, s31
    v_lshlrev_b32 v107, 7, v193
    v_lshl_add_u32 v107, v192, 4, v107
    v_add_u32 v107, s32, v107
    s_lshl_b32 s32, s28, 6
    s_add_u32 s32, s32, s31
    s_add_u32 s32, s32, 8192
    v_lshl_add_u32 v108, v0, 2, s32
    v_mov_b32 v109, 0x80000000
    v_cmp_gt_u32 vcc, 16, v0
    s_nop 1
    v_cndmask_b32 v108, v109, v108, vcc
    s_waitcnt lgkmcnt(8)
    v_mfma_f32_16x16x32_bf16 v[212:215], v[8:11], v[4:7], v[212:215]
    v_mfma_f32_16x16x32_bf16 v[220:223], v[224:227], v[4:7], v[220:223]
    s_waitcnt lgkmcnt(6)
    v_mfma_f32_16x16x32_bf16 v[216:219], v[12:15], v[4:7], v[216:219]
    ds_read_b64_tr_b16 v[28:29], v105 offset:9216
    ds_read_b64_tr_b16 v[30:31], v105 offset:9792
    ds_read_b64_tr_b16 v[32:33], v106 offset:5120
    ds_read_b64_tr_b16 v[34:35], v106 offset:5440
    ds_read_b64_tr_b16 v[36:37], v106 offset:5152
    ds_read_b64_tr_b16 v[38:39], v106 offset:5472
    s_waitcnt lgkmcnt(8)
    v_mfma_f32_16x16x32_bf16 v[212:215], v[20:23], v[16:19], v[212:215]
    v_mfma_f32_16x16x32_bf16 v[220:223], v[224:227], v[16:19], v[220:223]
    s_waitcnt lgkmcnt(6)
    v_mfma_f32_16x16x32_bf16 v[216:219], v[24:27], v[16:19], v[216:219]
    ds_read_b64_tr_b16 v[40:41], v105 offset:13824
    ds_read_b64_tr_b16 v[42:43], v105 offset:14400
    ds_read_b64_tr_b16 v[44:45], v106 offset:7680
    ds_read_b64_tr_b16 v[46:47], v106 offset:8000
    ds_read_b64_tr_b16 v[48:49], v106 offset:7712
    ds_read_b64_tr_b16 v[50:51], v106 offset:8032
    s_waitcnt lgkmcnt(8)
    v_mfma_f32_16x16x32_bf16 v[212:215], v[32:35], v[28:31], v[212:215]
    v_mfma_f32_16x16x32_bf16 v[220:223], v[224:227], v[28:31], v[220:223]
    s_waitcnt lgkmcnt(6)
    v_mfma_f32_16x16x32_bf16 v[216:219], v[36:39], v[28:31], v[216:219]
    ds_read_b64_tr_b16 v[52:53], v105 offset:18432
    ds_read_b64_tr_b16 v[54:55], v105 offset:19008
    ds_read_b64_tr_b16 v[56:57], v106 offset:10240
    ds_read_b64_tr_b16 v[58:59], v106 offset:10560
    ds_read_b64_tr_b16 v[60:61], v106 offset:10272
    ds_read_b64_tr_b16 v[62:63], v106 offset:10592
    s_waitcnt lgkmcnt(8)
    v_mfma_f32_16x16x32_bf16 v[212:215], v[44:47], v[40:43], v[212:215]
    v_mfma_f32_16x16x32_bf16 v[220:223], v[224:227], v[40:43], v[220:223]
    s_waitcnt lgkmcnt(6)
    v_mfma_f32_16x16x32_bf16 v[216:219], v[48:51], v[40:43], v[216:219]
    ds_read_b64_tr_b16 v[64:65], v105 offset:23040
    ds_read_b64_tr_b16 v[66:67], v105 offset:23616
    ds_read_b64_tr_b16 v[68:69], v106 offset:12800
    ds_read_b64_tr_b16 v[70:71], v106 offset:13120
    ds_read_b64_tr_b16 v[72:73], v106 offset:12832
    ds_read_b64_tr_b16 v[74:75], v106 offset:13152
    s_waitcnt lgkmcnt(8)
    v_mfma_f32_16x16x32_bf16 v[212:215], v[56:59], v[52:55], v[212:215]
    v_mfma_f32_16x16x32_bf16 v[220:223], v[224:227], v[52:55], v[220:223]
    s_waitcnt lgkmcnt(6)
    v_mfma_f32_16x16x32_bf16 v[216:219], v[60:63], v[52:55], v[216:219]
    ds_read_b64_tr_b16 v[76:77], v105 offset:27648
    ds_read_b64_tr_b16 v[78:79], v105 offset:28224
    ds_read_b64_tr_b16 v[80:81], v106 offset:15360
    ds_read_b64_tr_b16 v[82:83], v106 offset:15680
    ds_read_b64_tr_b16 v[84:85], v106 offset:15392
    ds_read_b64_tr_b16 v[86:87], v106 offset:15712
    s_waitcnt lgkmcnt(8)
    v_mfma_f32_16x16x32_bf16 v[212:215], v[68:71], v[64:67], v[212:215]
    v_mfma_f32_16x16x32_bf16 v[220:223], v[224:227], v[64:67], v[220:223]
    s_waitcnt lgkmcnt(6)
    v_mfma_f32_16x16x32_bf16 v[216:219], v[72:75], v[64:67], v[216:219]
    ds_read_b64_tr_b16 v[88:89], v105 offset:32256
    ds_read_b64_tr_b16 v[90:91], v105 offset:32832
    ds_read_b64_tr_b16 v[92:93], v106 offset:17920
    ds_read_b64_tr_b16 v[94:95], v106 offset:18240
    ds_read_b64_tr_b16 v[96:97], v106 offset:17952
    ds_read_b64_tr_b16 v[98:99], v106 offset:18272
    s_waitcnt lgkmcnt(8)
    v_mfma_f32_16x16x32_bf16 v[212:215], v[80:83], v[76:79], v[212:215]
    v_mfma_f32_16x16x32_bf16 v[220:223], v[224:227], v[76:79], v[220:223]
    s_waitcnt lgkmcnt(6)
    v_mfma_f32_16x16x32_bf16 v[216:219], v[84:87], v[76:79], v[216:219]
    s_waitcnt lgkmcnt(2)
    v_mfma_f32_16x16x32_bf16 v[212:215], v[92:95], v[88:91], v[212:215]
    v_mfma_f32_16x16x32_bf16 v[220:223], v[224:227], v[88:91], v[220:223]
    s_waitcnt lgkmcnt(0)
    v_mfma_f32_16x16x32_bf16 v[216:219], v[96:99], v[88:91], v[216:219]
    s_nop 4
    buffer_store_dwordx4 v[212:215], v107, s[24:27], 0 offen sc0 sc1
    s_nop 1
    buffer_store_dwordx4 v[216:219], v107, s[24:27], 0 offen offset:64 sc0 sc1
    buffer_store_dword v220, v108, s[24:27], 0 offen sc0 sc1
    s_lshl_b32 s32, s30, 7
    s_lshl_b32 s33, s29, 4
    s_add_u32 s32, s32, s33
    s_lshl_b32 s33, s28, 2
    s_add_u32 s32, s32, s33
    s_add_u32 s32, s32, 32505856
    v_mov_b32 v107, 0x80000000
    v_mov_b32 v109, s32
    v_cmp_eq_u32 vcc, 0, v0
    s_nop 1
    v_cndmask_b32 v107, v107, v109, vcc
    v_mov_b32 v109, s65
    s_waitcnt vmcnt(0)
    buffer_store_dword v109, v107, s[24:27], 0 offen sc0 sc1
    s_mov_b32 s16, s54
    s_mov_b32 s17, s55
    s_mov_b32 s18, 7340032
    s_mov_b32 s19, 0x20000
    v_mul_u32_u24 v37, 4682, v0
    v_lshrrev_b32 v37, 16, v37
    v_mul_u32_u24 v36, 14, v37
    v_sub_u32 v36, v0, v36
    s_lshr_b32 s32, s2, 5
    s_and_b32 s33, s2, 31
    s_lshl_b32 s34, s32, 7
    s_lshl_b32 s35, s28, 5
    s_add_u32 s34, s34, s35
    s_mul_i32 s34, s34, 7168
    s_mul_i32 s35, s33, 224
    s_add_u32 s34, s34, s35
    v_mul_u32_u24 v38, 57344, v37
    v_lshl_add_u32 v38, v36, 4, v38
    v_add_u32 v38, s34, v38
    v_mov_b32 v39, 0x80000000
    v_cmp_gt_u32 vcc, 56, v0
    s_nop 1
    v_cndmask_b32 v38, v39, v38, vcc
    s_mov_b32 s35, 0
    buffer_load_dwordx4 v[4:7], v38, s[16:19], s35 offen
    s_mov_b32 s35, 7168
    buffer_load_dwordx4 v[8:11], v38, s[16:19], s35 offen
    s_mov_b32 s35, 14336
    buffer_load_dwordx4 v[12:15], v38, s[16:19], s35 offen
    s_mov_b32 s35, 21504
    buffer_load_dwordx4 v[16:19], v38, s[16:19], s35 offen
    s_mov_b32 s35, 28672
    buffer_load_dwordx4 v[20:23], v38, s[16:19], s35 offen
    s_mov_b32 s35, 35840
    buffer_load_dwordx4 v[24:27], v38, s[16:19], s35 offen
    s_mov_b32 s35, 43008
    buffer_load_dwordx4 v[28:31], v38, s[16:19], s35 offen
    s_mov_b32 s35, 50176
    buffer_load_dwordx4 v[32:35], v38, s[16:19], s35 offen
    s_waitcnt vmcnt(0)
    v_mov_b32 v44, 0
    v_mov_b32 v45, 0
    v_mov_b32 v46, 0
    v_mov_b32 v47, 0
    v_mov_b32 v48, 0
    v_mov_b32 v49, 0
    v_mov_b32 v50, 0
    v_mov_b32 v51, 0
    v_lshlrev_b32 v52, 16, v4
    v_and_b32 v53, 0xffff0000, v4
    v_add_f32 v44, v44, v52
    v_add_f32 v45, v45, v53
    v_lshlrev_b32 v52, 16, v5
    v_and_b32 v53, 0xffff0000, v5
    v_add_f32 v46, v46, v52
    v_add_f32 v47, v47, v53
    v_lshlrev_b32 v52, 16, v6
    v_and_b32 v53, 0xffff0000, v6
    v_add_f32 v48, v48, v52
    v_add_f32 v49, v49, v53
    v_lshlrev_b32 v52, 16, v7
    v_and_b32 v53, 0xffff0000, v7
    v_add_f32 v50, v50, v52
    v_add_f32 v51, v51, v53
    v_lshlrev_b32 v52, 16, v8
    v_and_b32 v53, 0xffff0000, v8
    v_add_f32 v44, v44, v52
    v_add_f32 v45, v45, v53
    v_lshlrev_b32 v52, 16, v9
    v_and_b32 v53, 0xffff0000, v9
    v_add_f32 v46, v46, v52
    v_add_f32 v47, v47, v53
    v_lshlrev_b32 v52, 16, v10
    v_and_b32 v53, 0xffff0000, v10
    v_add_f32 v48, v48, v52
    v_add_f32 v49, v49, v53
    v_lshlrev_b32 v52, 16, v11
    v_and_b32 v53, 0xffff0000, v11
    v_add_f32 v50, v50, v52
    v_add_f32 v51, v51, v53
    v_lshlrev_b32 v52, 16, v12
    v_and_b32 v53, 0xffff0000, v12
    v_add_f32 v44, v44, v52
    v_add_f32 v45, v45, v53
    v_lshlrev_b32 v52, 16, v13
    v_and_b32 v53, 0xffff0000, v13
    v_add_f32 v46, v46, v52
    v_add_f32 v47, v47, v53
    v_lshlrev_b32 v52, 16, v14
    v_and_b32 v53, 0xffff0000, v14
    v_add_f32 v48, v48, v52
    v_add_f32 v49, v49, v53
    v_lshlrev_b32 v52, 16, v15
    v_and_b32 v53, 0xffff0000, v15
    v_add_f32 v50, v50, v52
    v_add_f32 v51, v51, v53
    v_lshlrev_b32 v52, 16, v16
    v_and_b32 v53, 0xffff0000, v16
    v_add_f32 v44, v44, v52
    v_add_f32 v45, v45, v53
    v_lshlrev_b32 v52, 16, v17
    v_and_b32 v53, 0xffff0000, v17
    v_add_f32 v46, v46, v52
    v_add_f32 v47, v47, v53
    v_lshlrev_b32 v52, 16, v18
    v_and_b32 v53, 0xffff0000, v18
    v_add_f32 v48, v48, v52
    v_add_f32 v49, v49, v53
    v_lshlrev_b32 v52, 16, v19
    v_and_b32 v53, 0xffff0000, v19
    v_add_f32 v50, v50, v52
    v_add_f32 v51, v51, v53
    v_lshlrev_b32 v52, 16, v20
    v_and_b32 v53, 0xffff0000, v20
    v_add_f32 v44, v44, v52
    v_add_f32 v45, v45, v53
    v_lshlrev_b32 v52, 16, v21
    v_and_b32 v53, 0xffff0000, v21
    v_add_f32 v46, v46, v52
    v_add_f32 v47, v47, v53
    v_lshlrev_b32 v52, 16, v22
    v_and_b32 v53, 0xffff0000, v22
    v_add_f32 v48, v48, v52
    v_add_f32 v49, v49, v53
    v_lshlrev_b32 v52, 16, v23
    v_and_b32 v53, 0xffff0000, v23
    v_add_f32 v50, v50, v52
    v_add_f32 v51, v51, v53
    v_lshlrev_b32 v52, 16, v24
    v_and_b32 v53, 0xffff0000, v24
    v_add_f32 v44, v44, v52
    v_add_f32 v45, v45, v53
    v_lshlrev_b32 v52, 16, v25
    v_and_b32 v53, 0xffff0000, v25
    v_add_f32 v46, v46, v52
    v_add_f32 v47, v47, v53
    v_lshlrev_b32 v52, 16, v26
    v_and_b32 v53, 0xffff0000, v26
    v_add_f32 v48, v48, v52
    v_add_f32 v49, v49, v53
    v_lshlrev_b32 v52, 16, v27
    v_and_b32 v53, 0xffff0000, v27
    v_add_f32 v50, v50, v52
    v_add_f32 v51, v51, v53
    v_lshlrev_b32 v52, 16, v28
    v_and_b32 v53, 0xffff0000, v28
    v_add_f32 v44, v44, v52
    v_add_f32 v45, v45, v53
    v_lshlrev_b32 v52, 16, v29
    v_and_b32 v53, 0xffff0000, v29
    v_add_f32 v46, v46, v52
    v_add_f32 v47, v47, v53
    v_lshlrev_b32 v52, 16, v30
    v_and_b32 v53, 0xffff0000, v30
    v_add_f32 v48, v48, v52
    v_add_f32 v49, v49, v53
    v_lshlrev_b32 v52, 16, v31
    v_and_b32 v53, 0xffff0000, v31
    v_add_f32 v50, v50, v52
    v_add_f32 v51, v51, v53
    v_lshlrev_b32 v52, 16, v32
    v_and_b32 v53, 0xffff0000, v32
    v_add_f32 v44, v44, v52
    v_add_f32 v45, v45, v53
    v_lshlrev_b32 v52, 16, v33
    v_and_b32 v53, 0xffff0000, v33
    v_add_f32 v46, v46, v52
    v_add_f32 v47, v47, v53
    v_lshlrev_b32 v52, 16, v34
    v_and_b32 v53, 0xffff0000, v34
    v_add_f32 v48, v48, v52
    v_add_f32 v49, v49, v53
    v_lshlrev_b32 v52, 16, v35
    v_and_b32 v53, 0xffff0000, v35
    v_add_f32 v50, v50, v52
    v_add_f32 v51, v51, v53
    s_lshl_b32 s35, s28, 11
    s_add_u32 s35, s35, 143360
    v_lshl_add_u32 v39, v0, 5, s35
    ds_write_b128 v39, v[44:47]
    ds_write_b128 v39, v[48:51] offset:16
    v_lshl_add_u32 v39, v0, 3, s35
    s_waitcnt lgkmcnt(0)
    ds_read_b64 v[4:5], v39 offset:0
    ds_read_b64 v[6:7], v39 offset:448
    ds_read_b64 v[8:9], v39 offset:896
    ds_read_b64 v[10:11], v39 offset:1344
    s_waitcnt lgkmcnt(0)
    v_add_f32 v4, v4, v6
    v_add_f32 v5, v5, v7
    v_add_f32 v4, v4, v8
    v_add_f32 v5, v5, v9
    v_add_f32 v4, v4, v10
    v_add_f32 v5, v5, v11
    s_lshl_b32 s34, s32, 2
    s_add_u32 s34, s34, s28
    s_mul_i32 s35, s34, 14336
    s_mul_i32 s36, s33, 448
    s_add_u32 s35, s35, s36
    s_add_u32 s35, s35, 33030144
    v_lshl_add_u32 v39, v0, 3, s35
    v_mov_b32 v40, 0x80000000
    v_cmp_gt_u32 vcc, 56, v0
    s_nop 1
    v_cndmask_b32 v39, v40, v39, vcc
    buffer_store_dwordx2 v[4:5], v39, s[24:27], 0 offen sc0 sc1
    s_lshl_b32 s35, s33, 7
    s_lshl_b32 s36, s34, 2
    s_add_u32 s35, s35, s36
    s_add_u32 s35, s35, 32587776
    v_mov_b32 v39, 0x80000000
    v_mov_b32 v40, s35
    v_cmp_eq_u32 vcc, 0, v0
    s_nop 1
    v_cndmask_b32 v39, v39, v40, vcc
    v_mov_b32 v40, s65
    s_waitcnt vmcnt(0)
    buffer_store_dword v40, v39, s[24:27], 0 offen sc0 sc1
    s_barrier
    s_and_b32 s31, s2, 7
    s_lshr_b32 s32, s2, 3
    s_lshr_b32 s33, s31, 1
    s_and_b32 s34, s31, 1
    s_mul_i32 s29, s32, 8193
    s_lshr_b32 s29, s29, 16
    s_mul_i32 s30, s29, 8
    s_sub_u32 s30, s32, s30
    s_mul_i32 s33, s33, 4
    s_add_u32 s29, s29, s33
    s_mul_i32 s34, s34, 8
    s_add_u32 s30, s30, s34
    s_lshr_b32 s35, s29, 1
    s_lshl_b32 s35, s35, 19
    s_and_b32 s36, s29, 1
    s_lshl_b32 s36, s36, 13
    s_add_u32 s35, s35, s36
    s_add_u32 s4, s62, s35
    s_addc_u32 s5, s63, 0
    s_add_u32 s4, s4, 4194304
    s_addc_u32 s5, s5, 0
    s_sub_u32 s6, 4194304, s35
    s_mov_b32 s7, 0x20000
    s_lshl_b32 s35, s30, 7
    s_add_u32 s8, s50, s35
    s_addc_u32 s9, s51, 0
    s_sub_u32 s10, 2097152, s35
    s_mov_b32 s11, 0x20000
    s_lshr_b32 s42, s28, 1
    s_and_b32 s43, s28, 1
    s_lshl_b32 s35, s29, 18
    s_lshl_b32 s36, s30, 7
    s_add_u32 s35, s35, s36
    s_add_u32 s12, s44, s35
    s_addc_u32 s13, s45, 0
    s_sub_u32 s14, 4194304, s35
    s_mov_b32 s15, 0x20000
    s_lshl_b32 s35, s29, 18
    s_lshl_b32 s36, s30, 14
    s_add_u32 s35, s35, s36
    s_add_u32 s16, s62, s35
    s_addc_u32 s17, s63, 0
    s_add_u32 s16, s16, 8388608
    s_addc_u32 s17, s17, 0
    s_sub_u32 s18, 4194304, s35
    s_mov_b32 s19, 0x20000
    s_lshr_b32 s42, s28, 1
    s_and_b32 s43, s28, 1
    v_and_b32 v36, 15, v0
    v_lshrrev_b32 v37, 4, v0
    v_bfe_u32 v38, v0, 1, 3
    v_xor_b32 v38, v38, v37
    v_lshlrev_b32 v38, 4, v38
    v_lshl_add_u32 v38, v36, 7, v38
    s_mul_i32 s31, s42, 8192
    v_add_u32 v132, s31, v38
    v_xor_b32 v133, 64, v132
    v_add_u32 v134, 24576, v132
    v_add_u32 v135, 24576, v133
    v_add_u32 v136, 49152, v132
    v_add_u32 v137, 49152, v133
    v_add_u32 v138, 73728, v132
    v_add_u32 v139, 73728, v133
    v_bfe_u32 v38, v0, 1, 1
    s_lshl_b32 s31, s43, 1
    v_add_u32 v38, s31, v38
    v_and_b32 v39, 1, v37
    v_lshlrev_b32 v39, 1, v39
    v_xor_b32 v38, v38, v39
    v_lshlrev_b32 v38, 4, v38
    v_bfe_u32 v39, v0, 2, 2
    v_lshl_add_u32 v38, v39, 6, v38
    v_lshl_add_u32 v38, v37, 10, v38
    v_and_b32 v39, 1, v0
    v_lshl_add_u32 v140, v39, 3, v38
    v_add_u32 v141, 24576, v140
    v_add_u32 v142, 49152, v140
    v_add_u32 v143, 73728, v140
    v_mov_b32 v4, 0
    v_mov_b32 v5, 0
    v_mov_b32 v6, 0
    v_mov_b32 v7, 0
    v_mov_b32 v8, 0
    v_mov_b32 v9, 0
    v_mov_b32 v10, 0
    v_mov_b32 v11, 0
    v_mov_b32 v12, 0
    v_mov_b32 v13, 0
    v_mov_b32 v14, 0
    v_mov_b32 v15, 0
    v_mov_b32 v16, 0
    v_mov_b32 v17, 0
    v_mov_b32 v18, 0
    v_mov_b32 v19, 0
    v_mov_b32 v20, 0
    v_mov_b32 v21, 0
    v_mov_b32 v22, 0
    v_mov_b32 v23, 0
    v_mov_b32 v24, 0
    v_mov_b32 v25, 0
    v_mov_b32 v26, 0
    v_mov_b32 v27, 0
    v_mov_b32 v28, 0
    v_mov_b32 v29, 0
    v_mov_b32 v30, 0
    v_mov_b32 v31, 0
    v_mov_b32 v32, 0
    v_mov_b32 v33, 0
    v_mov_b32 v34, 0
    v_mov_b32 v35, 0
    s_lshl_b32 s31, s28, 6
    v_add_u32 v144, s31, v0
    v_lshrrev_b32 v145, 3, v144
    v_and_b32 v146, 7, v144
    v_lshrrev_b32 v147, 2, v146
    v_lshlrev_b32 v147, 13, v147
    v_lshl_add_u32 v147, v145, 6, v147
    v_and_b32 v36, 3, v146
    v_lshl_add_u32 v147, v36, 4, v147
    v_lshlrev_b32 v146, 4, v146
    v_mul_u32_u24 v36, 144, v145
    v_lshl_add_u32 v145, v145, 11, v146
    v_add_u32 v146, v146, v36
    v_add_u32 v146, 143360, v146
    s_mov_b32 s31, 0
    buffer_load_dwordx4 v[148:151], v145, s[12:15], s31 offen
    s_mov_b32 s31, 65536
    buffer_load_dwordx4 v[152:155], v145, s[12:15], s31 offen
    s_mov_b32 s31, 131072
    buffer_load_dwordx4 v[156:159], v145, s[12:15], s31 offen
    s_mov_b32 s31, 196608
    buffer_load_dwordx4 v[160:163], v145, s[12:15], s31 offen
    s_barrier
    ds_read_b128 v[36:39], v132 offset:0
    ds_read_b64_tr_b16 v[100:101], v140 offset:16384
    ds_read_b64_tr_b16 v[102:103], v140 offset:16896
    ds_read_b128 v[40:43], v132 offset:2048
    ds_read_b64_tr_b16 v[104:105], v140 offset:16640
    ds_read_b64_tr_b16 v[106:107], v140 offset:17152
    ds_read_b128 v[44:47], v132 offset:4096
    ds_read_b128 v[48:51], v132 offset:6144
    ds_read_b128 v[52:55], v133 offset:0
    ds_read_b64_tr_b16 v[108:109], v140 offset:20480
    ds_read_b64_tr_b16 v[110:111], v140 offset:20992
    ds_read_b128 v[56:59], v133 offset:2048
    ds_read_b64_tr_b16 v[112:113], v140 offset:20736
    ds_read_b64_tr_b16 v[114:115], v140 offset:21248
    ds_read_b128 v[60:63], v133 offset:4096
    ds_read_b128 v[64:67], v133 offset:6144
    s_mov_b32 s38, 3
p2_cloop:
    s_waitcnt lgkmcnt(0)
    s_barrier
    v_mfma_f32_16x16x32_bf16 v[4:7], v[100:103], v[36:39], v[4:7]
    ds_read_b128 v[68:71], v134 offset:0
    ds_read_b64_tr_b16 v[116:117], v141 offset:16384
    v_mfma_f32_16x16x32_bf16 v[8:11], v[104:107], v[36:39], v[8:11]
    ds_read_b64_tr_b16 v[118:119], v141 offset:16896
    ds_read_b128 v[72:75], v134 offset:2048
    v_mfma_f32_16x16x32_bf16 v[12:15], v[100:103], v[40:43], v[12:15]
    ds_read_b64_tr_b16 v[120:121], v141 offset:16640
    ds_read_b64_tr_b16 v[122:123], v141 offset:17152
    v_mfma_f32_16x16x32_bf16 v[16:19], v[104:107], v[40:43], v[16:19]
    ds_read_b128 v[76:79], v134 offset:4096
    ds_read_b128 v[80:83], v134 offset:6144
    v_mfma_f32_16x16x32_bf16 v[20:23], v[100:103], v[44:47], v[20:23]
    ds_read_b128 v[84:87], v135 offset:0
    ds_read_b64_tr_b16 v[124:125], v141 offset:20480
    v_mfma_f32_16x16x32_bf16 v[24:27], v[104:107], v[44:47], v[24:27]
    ds_read_b64_tr_b16 v[126:127], v141 offset:20992
    ds_read_b128 v[88:91], v135 offset:2048
    v_mfma_f32_16x16x32_bf16 v[28:31], v[100:103], v[48:51], v[28:31]
    ds_read_b64_tr_b16 v[128:129], v141 offset:20736
    ds_read_b64_tr_b16 v[130:131], v141 offset:21248
    v_mfma_f32_16x16x32_bf16 v[32:35], v[104:107], v[48:51], v[32:35]
    ds_read_b128 v[92:95], v135 offset:4096
    ds_read_b128 v[96:99], v135 offset:6144
    v_mfma_f32_16x16x32_bf16 v[4:7], v[108:111], v[52:55], v[4:7]
    v_mfma_f32_16x16x32_bf16 v[8:11], v[112:115], v[52:55], v[8:11]
    v_mfma_f32_16x16x32_bf16 v[12:15], v[108:111], v[56:59], v[12:15]
    v_mfma_f32_16x16x32_bf16 v[16:19], v[112:115], v[56:59], v[16:19]
    v_mfma_f32_16x16x32_bf16 v[20:23], v[108:111], v[60:63], v[20:23]
    v_mfma_f32_16x16x32_bf16 v[24:27], v[112:115], v[60:63], v[24:27]
    v_mfma_f32_16x16x32_bf16 v[28:31], v[108:111], v[64:67], v[28:31]
    v_mfma_f32_16x16x32_bf16 v[32:35], v[112:115], v[64:67], v[32:35]
    s_waitcnt lgkmcnt(0)
    s_barrier
    v_mfma_f32_16x16x32_bf16 v[4:7], v[116:119], v[68:71], v[4:7]
    ds_read_b128 v[36:39], v136 offset:0
    ds_read_b64_tr_b16 v[100:101], v142 offset:16384
    v_mfma_f32_16x16x32_bf16 v[8:11], v[120:123], v[68:71], v[8:11]
    ds_read_b64_tr_b16 v[102:103], v142 offset:16896
    ds_read_b128 v[40:43], v136 offset:2048
    v_mfma_f32_16x16x32_bf16 v[12:15], v[116:119], v[72:75], v[12:15]
    ds_read_b64_tr_b16 v[104:105], v142 offset:16640
    ds_read_b64_tr_b16 v[106:107], v142 offset:17152
    v_mfma_f32_16x16x32_bf16 v[16:19], v[120:123], v[72:75], v[16:19]
    ds_read_b128 v[44:47], v136 offset:4096
    ds_read_b128 v[48:51], v136 offset:6144
    v_mfma_f32_16x16x32_bf16 v[20:23], v[116:119], v[76:79], v[20:23]
    ds_read_b128 v[52:55], v137 offset:0
    ds_read_b64_tr_b16 v[108:109], v142 offset:20480
    v_mfma_f32_16x16x32_bf16 v[24:27], v[120:123], v[76:79], v[24:27]
    ds_read_b64_tr_b16 v[110:111], v142 offset:20992
    ds_read_b128 v[56:59], v137 offset:2048
    v_mfma_f32_16x16x32_bf16 v[28:31], v[116:119], v[80:83], v[28:31]
    ds_read_b64_tr_b16 v[112:113], v142 offset:20736
    ds_read_b64_tr_b16 v[114:115], v142 offset:21248
    v_mfma_f32_16x16x32_bf16 v[32:35], v[120:123], v[80:83], v[32:35]
    ds_read_b128 v[60:63], v137 offset:4096
    ds_read_b128 v[64:67], v137 offset:6144
    v_mfma_f32_16x16x32_bf16 v[4:7], v[124:127], v[84:87], v[4:7]
    v_mfma_f32_16x16x32_bf16 v[8:11], v[128:131], v[84:87], v[8:11]
    v_mfma_f32_16x16x32_bf16 v[12:15], v[124:127], v[88:91], v[12:15]
    v_mfma_f32_16x16x32_bf16 v[16:19], v[128:131], v[88:91], v[16:19]
    v_mfma_f32_16x16x32_bf16 v[20:23], v[124:127], v[92:95], v[20:23]
    v_mfma_f32_16x16x32_bf16 v[24:27], v[128:131], v[92:95], v[24:27]
    v_mfma_f32_16x16x32_bf16 v[28:31], v[124:127], v[96:99], v[28:31]
    v_mfma_f32_16x16x32_bf16 v[32:35], v[128:131], v[96:99], v[32:35]
    s_waitcnt lgkmcnt(0)
    s_barrier
    v_mfma_f32_16x16x32_bf16 v[4:7], v[100:103], v[36:39], v[4:7]
    ds_read_b128 v[68:71], v138 offset:0
    ds_read_b64_tr_b16 v[116:117], v143 offset:16384
    v_mfma_f32_16x16x32_bf16 v[8:11], v[104:107], v[36:39], v[8:11]
    ds_read_b64_tr_b16 v[118:119], v143 offset:16896
    ds_read_b128 v[72:75], v138 offset:2048
    v_mfma_f32_16x16x32_bf16 v[12:15], v[100:103], v[40:43], v[12:15]
    ds_read_b64_tr_b16 v[120:121], v143 offset:16640
    ds_read_b64_tr_b16 v[122:123], v143 offset:17152
    v_mfma_f32_16x16x32_bf16 v[16:19], v[104:107], v[40:43], v[16:19]
    ds_read_b128 v[76:79], v138 offset:4096
    ds_read_b128 v[80:83], v138 offset:6144
    v_mfma_f32_16x16x32_bf16 v[20:23], v[100:103], v[44:47], v[20:23]
    ds_read_b128 v[84:87], v139 offset:0
    ds_read_b64_tr_b16 v[124:125], v143 offset:20480
    v_mfma_f32_16x16x32_bf16 v[24:27], v[104:107], v[44:47], v[24:27]
    ds_read_b64_tr_b16 v[126:127], v143 offset:20992
    ds_read_b128 v[88:91], v139 offset:2048
    v_mfma_f32_16x16x32_bf16 v[28:31], v[100:103], v[48:51], v[28:31]
    ds_read_b64_tr_b16 v[128:129], v143 offset:20736
    ds_read_b64_tr_b16 v[130:131], v143 offset:21248
    v_mfma_f32_16x16x32_bf16 v[32:35], v[104:107], v[48:51], v[32:35]
    ds_read_b128 v[92:95], v139 offset:4096
    ds_read_b128 v[96:99], v139 offset:6144
    v_mfma_f32_16x16x32_bf16 v[4:7], v[108:111], v[52:55], v[4:7]
    v_mfma_f32_16x16x32_bf16 v[8:11], v[112:115], v[52:55], v[8:11]
    v_mfma_f32_16x16x32_bf16 v[12:15], v[108:111], v[56:59], v[12:15]
    v_mfma_f32_16x16x32_bf16 v[16:19], v[112:115], v[56:59], v[16:19]
    v_mfma_f32_16x16x32_bf16 v[20:23], v[108:111], v[60:63], v[20:23]
    v_mfma_f32_16x16x32_bf16 v[24:27], v[112:115], v[60:63], v[24:27]
    v_mfma_f32_16x16x32_bf16 v[28:31], v[108:111], v[64:67], v[28:31]
    v_mfma_f32_16x16x32_bf16 v[32:35], v[112:115], v[64:67], v[32:35]
    s_waitcnt lgkmcnt(0)
    s_barrier
    v_mfma_f32_16x16x32_bf16 v[4:7], v[116:119], v[68:71], v[4:7]
    ds_read_b128 v[36:39], v132 offset:0
    ds_read_b64_tr_b16 v[100:101], v140 offset:16384
    v_mfma_f32_16x16x32_bf16 v[8:11], v[120:123], v[68:71], v[8:11]
    ds_read_b64_tr_b16 v[102:103], v140 offset:16896
    ds_read_b128 v[40:43], v132 offset:2048
    v_mfma_f32_16x16x32_bf16 v[12:15], v[116:119], v[72:75], v[12:15]
    ds_read_b64_tr_b16 v[104:105], v140 offset:16640
    ds_read_b64_tr_b16 v[106:107], v140 offset:17152
    v_mfma_f32_16x16x32_bf16 v[16:19], v[120:123], v[72:75], v[16:19]
    ds_read_b128 v[44:47], v132 offset:4096
    ds_read_b128 v[48:51], v132 offset:6144
    v_mfma_f32_16x16x32_bf16 v[20:23], v[116:119], v[76:79], v[20:23]
    ds_read_b128 v[52:55], v133 offset:0
    ds_read_b64_tr_b16 v[108:109], v140 offset:20480
    v_mfma_f32_16x16x32_bf16 v[24:27], v[120:123], v[76:79], v[24:27]
    ds_read_b64_tr_b16 v[110:111], v140 offset:20992
    ds_read_b128 v[56:59], v133 offset:2048
    v_mfma_f32_16x16x32_bf16 v[28:31], v[116:119], v[80:83], v[28:31]
    ds_read_b64_tr_b16 v[112:113], v140 offset:20736
    ds_read_b64_tr_b16 v[114:115], v140 offset:21248
    v_mfma_f32_16x16x32_bf16 v[32:35], v[120:123], v[80:83], v[32:35]
    ds_read_b128 v[60:63], v133 offset:4096
    ds_read_b128 v[64:67], v133 offset:6144
    v_mfma_f32_16x16x32_bf16 v[4:7], v[124:127], v[84:87], v[4:7]
    v_mfma_f32_16x16x32_bf16 v[8:11], v[128:131], v[84:87], v[8:11]
    v_mfma_f32_16x16x32_bf16 v[12:15], v[124:127], v[88:91], v[12:15]
    v_mfma_f32_16x16x32_bf16 v[16:19], v[128:131], v[88:91], v[16:19]
    v_mfma_f32_16x16x32_bf16 v[20:23], v[124:127], v[92:95], v[20:23]
    v_mfma_f32_16x16x32_bf16 v[24:27], v[128:131], v[92:95], v[24:27]
    v_mfma_f32_16x16x32_bf16 v[28:31], v[124:127], v[96:99], v[28:31]
    v_mfma_f32_16x16x32_bf16 v[32:35], v[128:131], v[96:99], v[32:35]
    s_sub_u32 s38, s38, 1
    s_cmp_lg_u32 s38, 0
    s_cbranch_scc1 p2_cloop
    s_waitcnt lgkmcnt(0)
    s_barrier
    v_mfma_f32_16x16x32_bf16 v[4:7], v[100:103], v[36:39], v[4:7]
    ds_read_b128 v[68:71], v134 offset:0
    ds_read_b64_tr_b16 v[116:117], v141 offset:16384
    v_mfma_f32_16x16x32_bf16 v[8:11], v[104:107], v[36:39], v[8:11]
    ds_read_b64_tr_b16 v[118:119], v141 offset:16896
    ds_read_b128 v[72:75], v134 offset:2048
    v_mfma_f32_16x16x32_bf16 v[12:15], v[100:103], v[40:43], v[12:15]
    ds_read_b64_tr_b16 v[120:121], v141 offset:16640
    ds_read_b64_tr_b16 v[122:123], v141 offset:17152
    v_mfma_f32_16x16x32_bf16 v[16:19], v[104:107], v[40:43], v[16:19]
    ds_read_b128 v[76:79], v134 offset:4096
    ds_read_b128 v[80:83], v134 offset:6144
    v_mfma_f32_16x16x32_bf16 v[20:23], v[100:103], v[44:47], v[20:23]
    ds_read_b128 v[84:87], v135 offset:0
    ds_read_b64_tr_b16 v[124:125], v141 offset:20480
    v_mfma_f32_16x16x32_bf16 v[24:27], v[104:107], v[44:47], v[24:27]
    ds_read_b64_tr_b16 v[126:127], v141 offset:20992
    ds_read_b128 v[88:91], v135 offset:2048
    v_mfma_f32_16x16x32_bf16 v[28:31], v[100:103], v[48:51], v[28:31]
    ds_read_b64_tr_b16 v[128:129], v141 offset:20736
    ds_read_b64_tr_b16 v[130:131], v141 offset:21248
    v_mfma_f32_16x16x32_bf16 v[32:35], v[104:107], v[48:51], v[32:35]
    ds_read_b128 v[92:95], v135 offset:4096
    ds_read_b128 v[96:99], v135 offset:6144
    v_mfma_f32_16x16x32_bf16 v[4:7], v[108:111], v[52:55], v[4:7]
    v_mfma_f32_16x16x32_bf16 v[8:11], v[112:115], v[52:55], v[8:11]
    v_mfma_f32_16x16x32_bf16 v[12:15], v[108:111], v[56:59], v[12:15]
    v_mfma_f32_16x16x32_bf16 v[16:19], v[112:115], v[56:59], v[16:19]
    v_mfma_f32_16x16x32_bf16 v[20:23], v[108:111], v[60:63], v[20:23]
    v_mfma_f32_16x16x32_bf16 v[24:27], v[112:115], v[60:63], v[24:27]
    v_mfma_f32_16x16x32_bf16 v[28:31], v[108:111], v[64:67], v[28:31]
    v_mfma_f32_16x16x32_bf16 v[32:35], v[112:115], v[64:67], v[32:35]
    s_waitcnt lgkmcnt(0)
    s_barrier
    v_mfma_f32_16x16x32_bf16 v[4:7], v[116:119], v[68:71], v[4:7]
    ds_read_b128 v[36:39], v136 offset:0
    ds_read_b64_tr_b16 v[100:101], v142 offset:16384
    v_mfma_f32_16x16x32_bf16 v[8:11], v[120:123], v[68:71], v[8:11]
    ds_read_b64_tr_b16 v[102:103], v142 offset:16896
    ds_read_b128 v[40:43], v136 offset:2048
    v_mfma_f32_16x16x32_bf16 v[12:15], v[116:119], v[72:75], v[12:15]
    ds_read_b64_tr_b16 v[104:105], v142 offset:16640
    ds_read_b64_tr_b16 v[106:107], v142 offset:17152
    v_mfma_f32_16x16x32_bf16 v[16:19], v[120:123], v[72:75], v[16:19]
    ds_read_b128 v[44:47], v136 offset:4096
    ds_read_b128 v[48:51], v136 offset:6144
    v_mfma_f32_16x16x32_bf16 v[20:23], v[116:119], v[76:79], v[20:23]
    ds_read_b128 v[52:55], v137 offset:0
    ds_read_b64_tr_b16 v[108:109], v142 offset:20480
    v_mfma_f32_16x16x32_bf16 v[24:27], v[120:123], v[76:79], v[24:27]
    ds_read_b64_tr_b16 v[110:111], v142 offset:20992
    ds_read_b128 v[56:59], v137 offset:2048
    v_mfma_f32_16x16x32_bf16 v[28:31], v[116:119], v[80:83], v[28:31]
    ds_read_b64_tr_b16 v[112:113], v142 offset:20736
    ds_read_b64_tr_b16 v[114:115], v142 offset:21248
    v_mfma_f32_16x16x32_bf16 v[32:35], v[120:123], v[80:83], v[32:35]
    ds_read_b128 v[60:63], v137 offset:4096
    ds_read_b128 v[64:67], v137 offset:6144
    v_mfma_f32_16x16x32_bf16 v[4:7], v[124:127], v[84:87], v[4:7]
    v_mfma_f32_16x16x32_bf16 v[8:11], v[128:131], v[84:87], v[8:11]
    v_mfma_f32_16x16x32_bf16 v[12:15], v[124:127], v[88:91], v[12:15]
    v_mfma_f32_16x16x32_bf16 v[16:19], v[128:131], v[88:91], v[16:19]
    v_mfma_f32_16x16x32_bf16 v[20:23], v[124:127], v[92:95], v[20:23]
    v_mfma_f32_16x16x32_bf16 v[24:27], v[128:131], v[92:95], v[24:27]
    v_mfma_f32_16x16x32_bf16 v[28:31], v[124:127], v[96:99], v[28:31]
    v_mfma_f32_16x16x32_bf16 v[32:35], v[128:131], v[96:99], v[32:35]
    s_waitcnt lgkmcnt(0)
    s_barrier
    v_mfma_f32_16x16x32_bf16 v[4:7], v[100:103], v[36:39], v[4:7]
    ds_read_b128 v[68:71], v138 offset:0
    ds_read_b64_tr_b16 v[116:117], v143 offset:16384
    v_mfma_f32_16x16x32_bf16 v[8:11], v[104:107], v[36:39], v[8:11]
    ds_read_b64_tr_b16 v[118:119], v143 offset:16896
    ds_read_b128 v[72:75], v138 offset:2048
    v_mfma_f32_16x16x32_bf16 v[12:15], v[100:103], v[40:43], v[12:15]
    ds_read_b64_tr_b16 v[120:121], v143 offset:16640
    ds_read_b64_tr_b16 v[122:123], v143 offset:17152
    v_mfma_f32_16x16x32_bf16 v[16:19], v[104:107], v[40:43], v[16:19]
    ds_read_b128 v[76:79], v138 offset:4096
    ds_read_b128 v[80:83], v138 offset:6144
    v_mfma_f32_16x16x32_bf16 v[20:23], v[100:103], v[44:47], v[20:23]
    ds_read_b128 v[84:87], v139 offset:0
    ds_read_b64_tr_b16 v[124:125], v143 offset:20480
    v_mfma_f32_16x16x32_bf16 v[24:27], v[104:107], v[44:47], v[24:27]
    ds_read_b64_tr_b16 v[126:127], v143 offset:20992
    ds_read_b128 v[88:91], v139 offset:2048
    v_mfma_f32_16x16x32_bf16 v[28:31], v[100:103], v[48:51], v[28:31]
    ds_read_b64_tr_b16 v[128:129], v143 offset:20736
    ds_read_b64_tr_b16 v[130:131], v143 offset:21248
    v_mfma_f32_16x16x32_bf16 v[32:35], v[104:107], v[48:51], v[32:35]
    ds_read_b128 v[92:95], v139 offset:4096
    ds_read_b128 v[96:99], v139 offset:6144
    v_mfma_f32_16x16x32_bf16 v[4:7], v[108:111], v[52:55], v[4:7]
    v_mfma_f32_16x16x32_bf16 v[8:11], v[112:115], v[52:55], v[8:11]
    v_mfma_f32_16x16x32_bf16 v[12:15], v[108:111], v[56:59], v[12:15]
    v_mfma_f32_16x16x32_bf16 v[16:19], v[112:115], v[56:59], v[16:19]
    v_mfma_f32_16x16x32_bf16 v[20:23], v[108:111], v[60:63], v[20:23]
    v_mfma_f32_16x16x32_bf16 v[24:27], v[112:115], v[60:63], v[24:27]
    v_mfma_f32_16x16x32_bf16 v[28:31], v[108:111], v[64:67], v[28:31]
    v_mfma_f32_16x16x32_bf16 v[32:35], v[112:115], v[64:67], v[32:35]
    s_waitcnt lgkmcnt(0)
    v_mfma_f32_16x16x32_bf16 v[4:7], v[116:119], v[68:71], v[4:7]
    v_mfma_f32_16x16x32_bf16 v[8:11], v[120:123], v[68:71], v[8:11]
    v_mfma_f32_16x16x32_bf16 v[12:15], v[116:119], v[72:75], v[12:15]
    v_mfma_f32_16x16x32_bf16 v[16:19], v[120:123], v[72:75], v[16:19]
    v_mfma_f32_16x16x32_bf16 v[20:23], v[116:119], v[76:79], v[20:23]
    v_mfma_f32_16x16x32_bf16 v[24:27], v[120:123], v[76:79], v[24:27]
    v_mfma_f32_16x16x32_bf16 v[28:31], v[116:119], v[80:83], v[28:31]
    v_mfma_f32_16x16x32_bf16 v[32:35], v[120:123], v[80:83], v[32:35]
    v_mfma_f32_16x16x32_bf16 v[4:7], v[124:127], v[84:87], v[4:7]
    v_mfma_f32_16x16x32_bf16 v[8:11], v[128:131], v[84:87], v[8:11]
    v_mfma_f32_16x16x32_bf16 v[12:15], v[124:127], v[88:91], v[12:15]
    v_mfma_f32_16x16x32_bf16 v[16:19], v[128:131], v[88:91], v[16:19]
    v_mfma_f32_16x16x32_bf16 v[20:23], v[124:127], v[92:95], v[20:23]
    v_mfma_f32_16x16x32_bf16 v[24:27], v[128:131], v[92:95], v[24:27]
    v_mfma_f32_16x16x32_bf16 v[28:31], v[124:127], v[96:99], v[28:31]
    v_mfma_f32_16x16x32_bf16 v[32:35], v[128:131], v[96:99], v[32:35]
    v_and_b32 v36, 15, v0
    s_lshl_b32 s31, s42, 6
    v_add_u32 v36, s31, v36
    v_mul_u32_u24 v36, 144, v36
    v_lshrrev_b32 v37, 4, v0
    v_lshl_add_u32 v36, v37, 3, v36
    s_lshl_b32 s31, s43, 5
    s_add_u32 s31, s31, 143360
    v_add_u32 v36, s31, v36
    v_cvt_pk_bf16_f32 v4, v4, v5
    v_cvt_pk_bf16_f32 v5, v6, v7
    ds_write_b64 v36, v[4:5] offset:0
    v_cvt_pk_bf16_f32 v8, v8, v9
    v_cvt_pk_bf16_f32 v9, v10, v11
    ds_write_b64 v36, v[8:9] offset:64
    v_cvt_pk_bf16_f32 v12, v12, v13
    v_cvt_pk_bf16_f32 v13, v14, v15
    ds_write_b64 v36, v[12:13] offset:2304
    v_cvt_pk_bf16_f32 v16, v16, v17
    v_cvt_pk_bf16_f32 v17, v18, v19
    ds_write_b64 v36, v[16:17] offset:2368
    v_cvt_pk_bf16_f32 v20, v20, v21
    v_cvt_pk_bf16_f32 v21, v22, v23
    ds_write_b64 v36, v[20:21] offset:4608
    v_cvt_pk_bf16_f32 v24, v24, v25
    v_cvt_pk_bf16_f32 v25, v26, v27
    ds_write_b64 v36, v[24:25] offset:4672
    v_cvt_pk_bf16_f32 v28, v28, v29
    v_cvt_pk_bf16_f32 v29, v30, v31
    ds_write_b64 v36, v[28:29] offset:6912
    v_cvt_pk_bf16_f32 v32, v32, v33
    v_cvt_pk_bf16_f32 v33, v34, v35
    ds_write_b64 v36, v[32:33] offset:6976
    s_waitcnt lgkmcnt(0)
    s_barrier
    ds_read_b128 v[40:43], v146 offset:0
    ds_read_b128 v[44:47], v146 offset:4608
    ds_read_b128 v[48:51], v146 offset:9216
    ds_read_b128 v[52:55], v146 offset:13824
    s_lshl_b32 s31, s30, 11
    s_lshl_b32 s32, s29, 7
    s_add_u32 s31, s31, s32
    v_lshrrev_b32 v74, 3, v144
    v_add_u32 v74, s31, v74
    v_lshlrev_b32 v74, 3, v74
    v_add_u32 v74, 32636928, v74
    v_mov_b32 v64, 0x80000000
    v_and_b32 v65, 7, v144
    v_cmp_eq_u32 vcc, 0, v65
    s_nop 1
    v_cndmask_b32 v74, v64, v74, vcc
    s_waitcnt vmcnt(0)
    s_waitcnt lgkmcnt(3)
    v_lshlrev_b32 v56, 16, v40
    v_lshlrev_b32 v64, 16, v148
    v_add_f32 v56, v56, v64
    v_and_b32 v57, 0xffff0000, v40
    v_and_b32 v65, 0xffff0000, v148
    v_add_f32 v57, v57, v65
    v_cvt_pk_bf16_f32 v40, v56, v57
    v_lshlrev_b32 v58, 16, v41
    v_lshlrev_b32 v64, 16, v149
    v_add_f32 v58, v58, v64
    v_and_b32 v59, 0xffff0000, v41
    v_and_b32 v65, 0xffff0000, v149
    v_add_f32 v59, v59, v65
    v_cvt_pk_bf16_f32 v41, v58, v59
    v_lshlrev_b32 v60, 16, v42
    v_lshlrev_b32 v64, 16, v150
    v_add_f32 v60, v60, v64
    v_and_b32 v61, 0xffff0000, v42
    v_and_b32 v65, 0xffff0000, v150
    v_add_f32 v61, v61, v65
    v_cvt_pk_bf16_f32 v42, v60, v61
    v_lshlrev_b32 v62, 16, v43
    v_lshlrev_b32 v64, 16, v151
    v_add_f32 v62, v62, v64
    v_and_b32 v63, 0xffff0000, v43
    v_and_b32 v65, 0xffff0000, v151
    v_add_f32 v63, v63, v65
    v_cvt_pk_bf16_f32 v43, v62, v63
    s_mov_b32 s31, 0
    buffer_store_dwordx4 v[40:43], v147, s[16:19], s31 offen sc0 sc1
    s_waitcnt lgkmcnt(2)
    v_lshlrev_b32 v56, 16, v44
    v_lshlrev_b32 v64, 16, v152
    v_add_f32 v56, v56, v64
    v_and_b32 v57, 0xffff0000, v44
    v_and_b32 v65, 0xffff0000, v152
    v_add_f32 v57, v57, v65
    v_cvt_pk_bf16_f32 v44, v56, v57
    v_lshlrev_b32 v58, 16, v45
    v_lshlrev_b32 v64, 16, v153
    v_add_f32 v58, v58, v64
    v_and_b32 v59, 0xffff0000, v45
    v_and_b32 v65, 0xffff0000, v153
    v_add_f32 v59, v59, v65
    v_cvt_pk_bf16_f32 v45, v58, v59
    v_lshlrev_b32 v60, 16, v46
    v_lshlrev_b32 v64, 16, v154
    v_add_f32 v60, v60, v64
    v_and_b32 v61, 0xffff0000, v46
    v_and_b32 v65, 0xffff0000, v154
    v_add_f32 v61, v61, v65
    v_cvt_pk_bf16_f32 v46, v60, v61
    v_lshlrev_b32 v62, 16, v47
    v_lshlrev_b32 v64, 16, v155
    v_add_f32 v62, v62, v64
    v_and_b32 v63, 0xffff0000, v47
    v_and_b32 v65, 0xffff0000, v155
    v_add_f32 v63, v63, v65
    v_cvt_pk_bf16_f32 v47, v62, v63
    s_mov_b32 s31, 2048
    buffer_store_dwordx4 v[44:47], v147, s[16:19], s31 offen sc0 sc1
    s_waitcnt lgkmcnt(1)
    v_lshlrev_b32 v56, 16, v48
    v_lshlrev_b32 v64, 16, v156
    v_add_f32 v56, v56, v64
    v_and_b32 v57, 0xffff0000, v48
    v_and_b32 v65, 0xffff0000, v156
    v_add_f32 v57, v57, v65
    v_cvt_pk_bf16_f32 v48, v56, v57
    v_lshlrev_b32 v58, 16, v49
    v_lshlrev_b32 v64, 16, v157
    v_add_f32 v58, v58, v64
    v_and_b32 v59, 0xffff0000, v49
    v_and_b32 v65, 0xffff0000, v157
    v_add_f32 v59, v59, v65
    v_cvt_pk_bf16_f32 v49, v58, v59
    v_lshlrev_b32 v60, 16, v50
    v_lshlrev_b32 v64, 16, v158
    v_add_f32 v60, v60, v64
    v_and_b32 v61, 0xffff0000, v50
    v_and_b32 v65, 0xffff0000, v158
    v_add_f32 v61, v61, v65
    v_cvt_pk_bf16_f32 v50, v60, v61
    v_lshlrev_b32 v62, 16, v51
    v_lshlrev_b32 v64, 16, v159
    v_add_f32 v62, v62, v64
    v_and_b32 v63, 0xffff0000, v51
    v_and_b32 v65, 0xffff0000, v159
    v_add_f32 v63, v63, v65
    v_cvt_pk_bf16_f32 v51, v62, v63
    s_mov_b32 s31, 4096
    buffer_store_dwordx4 v[48:51], v147, s[16:19], s31 offen sc0 sc1
    s_waitcnt lgkmcnt(0)
    v_lshlrev_b32 v56, 16, v52
    v_lshlrev_b32 v64, 16, v160
    v_add_f32 v56, v56, v64
    v_and_b32 v57, 0xffff0000, v52
    v_and_b32 v65, 0xffff0000, v160
    v_add_f32 v57, v57, v65
    v_cvt_pk_bf16_f32 v52, v56, v57
    v_lshlrev_b32 v58, 16, v53
    v_lshlrev_b32 v64, 16, v161
    v_add_f32 v58, v58, v64
    v_and_b32 v59, 0xffff0000, v53
    v_and_b32 v65, 0xffff0000, v161
    v_add_f32 v59, v59, v65
    v_cvt_pk_bf16_f32 v53, v58, v59
    v_lshlrev_b32 v60, 16, v54
    v_lshlrev_b32 v64, 16, v162
    v_add_f32 v60, v60, v64
    v_and_b32 v61, 0xffff0000, v54
    v_and_b32 v65, 0xffff0000, v162
    v_add_f32 v61, v61, v65
    v_cvt_pk_bf16_f32 v54, v60, v61
    v_lshlrev_b32 v62, 16, v55
    v_lshlrev_b32 v64, 16, v163
    v_add_f32 v62, v62, v64
    v_and_b32 v63, 0xffff0000, v55
    v_and_b32 v65, 0xffff0000, v163
    v_add_f32 v63, v63, v65
    v_cvt_pk_bf16_f32 v55, v62, v63
    s_mov_b32 s31, 6144
    buffer_store_dwordx4 v[52:55], v147, s[16:19], s31 offen sc0 sc1
    v_lshlrev_b32 v56, 16, v40
    v_and_b32 v57, 0xffff0000, v40
    v_lshlrev_b32 v58, 16, v41
    v_and_b32 v59, 0xffff0000, v41
    v_lshlrev_b32 v60, 16, v42
    v_and_b32 v61, 0xffff0000, v42
    v_lshlrev_b32 v62, 16, v43
    v_and_b32 v63, 0xffff0000, v43
    v_add_f32 v66, v56, v57
    v_add_f32 v66, v66, v58
    v_add_f32 v66, v66, v59
    v_add_f32 v66, v66, v60
    v_add_f32 v66, v66, v61
    v_add_f32 v66, v66, v62
    v_add_f32 v66, v66, v63
    s_nop 1
    v_add_f32_dpp v66, v66, v66 quad_perm:[1,0,3,2] row_mask:0xf bank_mask:0xf
    s_nop 1
    v_add_f32_dpp v66, v66, v66 quad_perm:[2,3,0,1] row_mask:0xf bank_mask:0xf
    s_nop 1
    v_add_f32_dpp v66, v66, v66 row_half_mirror row_mask:0xf bank_mask:0xf
    v_mul_f32 v64, 0x3c800000, v66
    v_sub_f32 v65, v56, v64
    v_mul_f32 v67, v65, v65
    v_sub_f32 v65, v57, v64
    v_fmac_f32 v67, v65, v65
    v_sub_f32 v65, v58, v64
    v_fmac_f32 v67, v65, v65
    v_sub_f32 v65, v59, v64
    v_fmac_f32 v67, v65, v65
    v_sub_f32 v65, v60, v64
    v_fmac_f32 v67, v65, v65
    v_sub_f32 v65, v61, v64
    v_fmac_f32 v67, v65, v65
    v_sub_f32 v65, v62, v64
    v_fmac_f32 v67, v65, v65
    v_sub_f32 v65, v63, v64
    v_fmac_f32 v67, v65, v65
    s_nop 1
    v_add_f32_dpp v67, v67, v67 quad_perm:[1,0,3,2] row_mask:0xf bank_mask:0xf
    s_nop 1
    v_add_f32_dpp v67, v67, v67 quad_perm:[2,3,0,1] row_mask:0xf bank_mask:0xf
    s_nop 1
    v_add_f32_dpp v67, v67, v67 row_half_mirror row_mask:0xf bank_mask:0xf
    s_mov_b32 s31, 0
    buffer_store_dwordx2 v[66:67], v74, s[24:27], s31 offen sc0 sc1
    v_lshlrev_b32 v56, 16, v44
    v_and_b32 v57, 0xffff0000, v44
    v_lshlrev_b32 v58, 16, v45
    v_and_b32 v59, 0xffff0000, v45
    v_lshlrev_b32 v60, 16, v46
    v_and_b32 v61, 0xffff0000, v46
    v_lshlrev_b32 v62, 16, v47
    v_and_b32 v63, 0xffff0000, v47
    v_add_f32 v68, v56, v57
    v_add_f32 v68, v68, v58
    v_add_f32 v68, v68, v59
    v_add_f32 v68, v68, v60
    v_add_f32 v68, v68, v61
    v_add_f32 v68, v68, v62
    v_add_f32 v68, v68, v63
    s_nop 1
    v_add_f32_dpp v68, v68, v68 quad_perm:[1,0,3,2] row_mask:0xf bank_mask:0xf
    s_nop 1
    v_add_f32_dpp v68, v68, v68 quad_perm:[2,3,0,1] row_mask:0xf bank_mask:0xf
    s_nop 1
    v_add_f32_dpp v68, v68, v68 row_half_mirror row_mask:0xf bank_mask:0xf
    v_mul_f32 v64, 0x3c800000, v68
    v_sub_f32 v65, v56, v64
    v_mul_f32 v69, v65, v65
    v_sub_f32 v65, v57, v64
    v_fmac_f32 v69, v65, v65
    v_sub_f32 v65, v58, v64
    v_fmac_f32 v69, v65, v65
    v_sub_f32 v65, v59, v64
    v_fmac_f32 v69, v65, v65
    v_sub_f32 v65, v60, v64
    v_fmac_f32 v69, v65, v65
    v_sub_f32 v65, v61, v64
    v_fmac_f32 v69, v65, v65
    v_sub_f32 v65, v62, v64
    v_fmac_f32 v69, v65, v65
    v_sub_f32 v65, v63, v64
    v_fmac_f32 v69, v65, v65
    s_nop 1
    v_add_f32_dpp v69, v69, v69 quad_perm:[1,0,3,2] row_mask:0xf bank_mask:0xf
    s_nop 1
    v_add_f32_dpp v69, v69, v69 quad_perm:[2,3,0,1] row_mask:0xf bank_mask:0xf
    s_nop 1
    v_add_f32_dpp v69, v69, v69 row_half_mirror row_mask:0xf bank_mask:0xf
    s_mov_b32 s31, 256
    buffer_store_dwordx2 v[68:69], v74, s[24:27], s31 offen sc0 sc1
    v_lshlrev_b32 v56, 16, v48
    v_and_b32 v57, 0xffff0000, v48
    v_lshlrev_b32 v58, 16, v49
    v_and_b32 v59, 0xffff0000, v49
    v_lshlrev_b32 v60, 16, v50
    v_and_b32 v61, 0xffff0000, v50
    v_lshlrev_b32 v62, 16, v51
    v_and_b32 v63, 0xffff0000, v51
    v_add_f32 v70, v56, v57
    v_add_f32 v70, v70, v58
    v_add_f32 v70, v70, v59
    v_add_f32 v70, v70, v60
    v_add_f32 v70, v70, v61
    v_add_f32 v70, v70, v62
    v_add_f32 v70, v70, v63
    s_nop 1
    v_add_f32_dpp v70, v70, v70 quad_perm:[1,0,3,2] row_mask:0xf bank_mask:0xf
    s_nop 1
    v_add_f32_dpp v70, v70, v70 quad_perm:[2,3,0,1] row_mask:0xf bank_mask:0xf
    s_nop 1
    v_add_f32_dpp v70, v70, v70 row_half_mirror row_mask:0xf bank_mask:0xf
    v_mul_f32 v64, 0x3c800000, v70
    v_sub_f32 v65, v56, v64
    v_mul_f32 v71, v65, v65
    v_sub_f32 v65, v57, v64
    v_fmac_f32 v71, v65, v65
    v_sub_f32 v65, v58, v64
    v_fmac_f32 v71, v65, v65
    v_sub_f32 v65, v59, v64
    v_fmac_f32 v71, v65, v65
    v_sub_f32 v65, v60, v64
    v_fmac_f32 v71, v65, v65
    v_sub_f32 v65, v61, v64
    v_fmac_f32 v71, v65, v65
    v_sub_f32 v65, v62, v64
    v_fmac_f32 v71, v65, v65
    v_sub_f32 v65, v63, v64
    v_fmac_f32 v71, v65, v65
    s_nop 1
    v_add_f32_dpp v71, v71, v71 quad_perm:[1,0,3,2] row_mask:0xf bank_mask:0xf
    s_nop 1
    v_add_f32_dpp v71, v71, v71 quad_perm:[2,3,0,1] row_mask:0xf bank_mask:0xf
    s_nop 1
    v_add_f32_dpp v71, v71, v71 row_half_mirror row_mask:0xf bank_mask:0xf
    s_mov_b32 s31, 512
    buffer_store_dwordx2 v[70:71], v74, s[24:27], s31 offen sc0 sc1
    v_lshlrev_b32 v56, 16, v52
    v_and_b32 v57, 0xffff0000, v52
    v_lshlrev_b32 v58, 16, v53
    v_and_b32 v59, 0xffff0000, v53
    v_lshlrev_b32 v60, 16, v54
    v_and_b32 v61, 0xffff0000, v54
    v_lshlrev_b32 v62, 16, v55
    v_and_b32 v63, 0xffff0000, v55
    v_add_f32 v72, v56, v57
    v_add_f32 v72, v72, v58
    v_add_f32 v72, v72, v59
    v_add_f32 v72, v72, v60
    v_add_f32 v72, v72, v61
    v_add_f32 v72, v72, v62
    v_add_f32 v72, v72, v63
    s_nop 1
    v_add_f32_dpp v72, v72, v72 quad_perm:[1,0,3,2] row_mask:0xf bank_mask:0xf
    s_nop 1
    v_add_f32_dpp v72, v72, v72 quad_perm:[2,3,0,1] row_mask:0xf bank_mask:0xf
    s_nop 1
    v_add_f32_dpp v72, v72, v72 row_half_mirror row_mask:0xf bank_mask:0xf
    v_mul_f32 v64, 0x3c800000, v72
    v_sub_f32 v65, v56, v64
    v_mul_f32 v73, v65, v65
    v_sub_f32 v65, v57, v64
    v_fmac_f32 v73, v65, v65
    v_sub_f32 v65, v58, v64
    v_fmac_f32 v73, v65, v65
    v_sub_f32 v65, v59, v64
    v_fmac_f32 v73, v65, v65
    v_sub_f32 v65, v60, v64
    v_fmac_f32 v73, v65, v65
    v_sub_f32 v65, v61, v64
    v_fmac_f32 v73, v65, v65
    v_sub_f32 v65, v62, v64
    v_fmac_f32 v73, v65, v65
    v_sub_f32 v65, v63, v64
    v_fmac_f32 v73, v65, v65
    s_nop 1
    v_add_f32_dpp v73, v73, v73 quad_perm:[1,0,3,2] row_mask:0xf bank_mask:0xf
    s_nop 1
    v_add_f32_dpp v73, v73, v73 quad_perm:[2,3,0,1] row_mask:0xf bank_mask:0xf
    s_nop 1
    v_add_f32_dpp v73, v73, v73 row_half_mirror row_mask:0xf bank_mask:0xf
    s_mov_b32 s31, 768
    buffer_store_dwordx2 v[72:73], v74, s[24:27], s31 offen sc0 sc1
    s_lshl_b32 s32, s29, 8
    s_lshl_b32 s33, s30, 4
    s_add_u32 s32, s32, s33
    s_lshl_b32 s33, s28, 2
    s_add_u32 s32, s32, s33
    s_add_u32 s32, s32, 32514048
    v_mov_b32 v64, 0x80000000
    v_mov_b32 v65, s32
    v_cmp_eq_u32 vcc, 0, v0
    s_nop 1
    v_cndmask_b32 v64, v64, v65, vcc
    v_mov_b32 v65, s65
    s_waitcnt vmcnt(0)
    buffer_store_dword v65, v64, s[24:27], 0 offen sc0 sc1
    s_and_b32 s31, s2, 7
    s_lshr_b32 s32, s2, 3
    s_lshr_b32 s33, s31, 2
    s_and_b32 s34, s31, 3
    s_mul_i32 s29, s32, 16385
    s_lshr_b32 s29, s29, 16
    s_mul_i32 s30, s29, 4
    s_sub_u32 s30, s32, s30
    s_mul_i32 s33, s33, 8
    s_add_u32 s29, s29, s33
    s_mul_i32 s34, s34, 4
    s_add_u32 s30, s30, s34
    s_mul_i32 s35, s29, 262144
    s_add_u32 s4, s62, s35
    s_addc_u32 s5, s63, 0
    s_add_u32 s4, s4, 8388608
    s_addc_u32 s5, s5, 0
    s_sub_u32 s6, 4194304, s35
    s_mov_b32 s7, 0x20000
    s_mul_i32 s35, s30, 448
    s_add_u32 s8, s54, s35
    s_addc_u32 s9, s55, 0
    s_sub_u32 s10, 7340032, s35
    s_mov_b32 s11, 0x20000
    s_lshr_b32 s42, s28, 1
    s_and_b32 s43, s28, 1
    s_mul_i32 s35, s30, 57344
    s_mul_i32 s36, s29, 917504
    s_add_u32 s35, s35, s36
    s_add_u32 s16, s62, s35
    s_addc_u32 s17, s63, 0
    s_add_u32 s16, s16, 12582912
    s_addc_u32 s17, s17, 0
    s_sub_u32 s18, 14680064, s35
    s_mov_b32 s19, 0x20000
    s_lshr_b32 s42, s28, 1
    s_and_b32 s43, s28, 1
    v_and_b32 v116, 15, v0
    v_lshrrev_b32 v117, 4, v0
    v_bfe_u32 v118, v0, 1, 3
    v_xor_b32 v118, v118, v117
    v_lshlrev_b32 v118, 4, v118
    v_lshl_add_u32 v118, v116, 7, v118
    s_mul_i32 s31, s42, 8192
    v_add_u32 v204, s31, v118
    v_xor_b32 v205, 64, v204
    v_add_u32 v206, 45056, v204
    v_add_u32 v207, 45056, v205
    v_add_u32 v208, 90112, v204
    v_add_u32 v209, 90112, v205
    v_bfe_u32 v118, v0, 1, 1
    s_lshl_b32 s31, s43, 1
    v_add_u32 v118, s31, v118
    v_and_b32 v119, 1, v117
    v_lshlrev_b32 v119, 1, v119
    v_xor_b32 v118, v118, v119
    v_lshlrev_b32 v118, 4, v118
    v_bfe_u32 v119, v0, 2, 2
    v_lshl_add_u32 v118, v119, 6, v118
    v_lshl_add_u32 v118, v117, 10, v118
    v_and_b32 v119, 1, v0
    v_lshl_add_u32 v210, v119, 3, v118
    v_add_u32 v211, 45056, v210
    v_add_u32 v212, 90112, v210
    v_bfe_u32 v118, v0, 1, 1
    s_lshl_b32 s31, s43, 1
    v_add_u32 v118, s31, v118
    v_and_b32 v119, 1, v117
    v_lshlrev_b32 v119, 1, v119
    v_xor_b32 v118, v118, v119
    v_lshlrev_b32 v118, 4, v118
    v_bfe_u32 v119, v0, 2, 2
    v_lshl_add_u32 v118, v119, 6, v118
    v_lshl_add_u32 v118, v117, 9, v118
    v_and_b32 v119, 1, v0
    v_lshl_add_u32 v213, v119, 3, v118
    v_add_u32 v214, 45056, v213
    v_add_u32 v215, 90112, v213
    v_mov_b32 v4, 0
    v_mov_b32 v5, 0
    v_mov_b32 v6, 0
    v_mov_b32 v7, 0
    v_mov_b32 v8, 0
    v_mov_b32 v9, 0
    v_mov_b32 v10, 0
    v_mov_b32 v11, 0
    v_mov_b32 v12, 0
    v_mov_b32 v13, 0
    v_mov_b32 v14, 0
    v_mov_b32 v15, 0
    v_mov_b32 v16, 0
    v_mov_b32 v17, 0
    v_mov_b32 v18, 0
    v_mov_b32 v19, 0
    v_mov_b32 v20, 0
    v_mov_b32 v21, 0
    v_mov_b32 v22, 0
    v_mov_b32 v23, 0
    v_mov_b32 v24, 0
    v_mov_b32 v25, 0
    v_mov_b32 v26, 0
    v_mov_b32 v27, 0
    v_mov_b32 v28, 0
    v_mov_b32 v29, 0
    v_mov_b32 v30, 0
    v_mov_b32 v31, 0
    v_mov_b32 v32, 0
    v_mov_b32 v33, 0
    v_mov_b32 v34, 0
    v_mov_b32 v35, 0
    v_mov_b32 v36, 0
    v_mov_b32 v37, 0
    v_mov_b32 v38, 0
    v_mov_b32 v39, 0
    v_mov_b32 v40, 0
    v_mov_b32 v41, 0
    v_mov_b32 v42, 0
    v_mov_b32 v43, 0
    v_mov_b32 v44, 0
    v_mov_b32 v45, 0
    v_mov_b32 v46, 0
    v_mov_b32 v47, 0
    v_mov_b32 v48, 0
    v_mov_b32 v49, 0
    v_mov_b32 v50, 0
    v_mov_b32 v51, 0
    v_mov_b32 v52, 0
    v_mov_b32 v53, 0
    v_mov_b32 v54, 0
    v_mov_b32 v55, 0
    v_mov_b32 v56, 0
    v_mov_b32 v57, 0
    v_mov_b32 v58, 0
    v_mov_b32 v59, 0
    v_mov_b32 v60, 0
    v_mov_b32 v61, 0
    v_mov_b32 v62, 0
    v_mov_b32 v63, 0
    v_mov_b32 v64, 0
    v_mov_b32 v65, 0
    v_mov_b32 v66, 0
    v_mov_b32 v67, 0
    v_mov_b32 v68, 0
    v_mov_b32 v69, 0
    v_mov_b32 v70, 0
    v_mov_b32 v71, 0
    v_mov_b32 v72, 0
    v_mov_b32 v73, 0
    v_mov_b32 v74, 0
    v_mov_b32 v75, 0
    v_mov_b32 v76, 0
    v_mov_b32 v77, 0
    v_mov_b32 v78, 0
    v_mov_b32 v79, 0
    v_mov_b32 v80, 0
    v_mov_b32 v81, 0
    v_mov_b32 v82, 0
    v_mov_b32 v83, 0
    v_mov_b32 v84, 0
    v_mov_b32 v85, 0
    v_mov_b32 v86, 0
    v_mov_b32 v87, 0
    v_mov_b32 v88, 0
    v_mov_b32 v89, 0
    v_mov_b32 v90, 0
    v_mov_b32 v91, 0
    v_mov_b32 v92, 0
    v_mov_b32 v93, 0
    v_mov_b32 v94, 0
    v_mov_b32 v95, 0
    v_mov_b32 v96, 0
    v_mov_b32 v97, 0
    v_mov_b32 v98, 0
    v_mov_b32 v99, 0
    v_mov_b32 v100, 0
    v_mov_b32 v101, 0
    v_mov_b32 v102, 0
    v_mov_b32 v103, 0
    v_mov_b32 v104, 0
    v_mov_b32 v105, 0
    v_mov_b32 v106, 0
    v_mov_b32 v107, 0
    v_mov_b32 v108, 0
    v_mov_b32 v109, 0
    v_mov_b32 v110, 0
    v_mov_b32 v111, 0
    v_mov_b32 v112, 0
    v_mov_b32 v113, 0
    v_mov_b32 v114, 0
    v_mov_b32 v115, 0
    s_barrier
    ds_read_b128 v[116:119], v204 offset:0
    ds_read_b64_tr_b16 v[148:149], v210 offset:16384
    ds_read_b64_tr_b16 v[150:151], v210 offset:16896
    ds_read_b128 v[120:123], v204 offset:2048
    ds_read_b64_tr_b16 v[152:153], v210 offset:16640
    ds_read_b64_tr_b16 v[154:155], v210 offset:17152
    ds_read_b128 v[124:127], v204 offset:4096
    ds_read_b64_tr_b16 v[156:157], v210 offset:24576
    ds_read_b64_tr_b16 v[158:159], v210 offset:25088
    ds_read_b128 v[128:131], v204 offset:6144
    ds_read_b64_tr_b16 v[160:161], v210 offset:24832
    ds_read_b64_tr_b16 v[162:163], v210 offset:25344
    ds_read_b64_tr_b16 v[164:165], v210 offset:32768
    ds_read_b64_tr_b16 v[166:167], v210 offset:33280
    ds_read_b64_tr_b16 v[168:169], v210 offset:33024
    ds_read_b64_tr_b16 v[170:171], v210 offset:33536
    ds_read_b64_tr_b16 v[172:173], v213 offset:40960
    ds_read_b64_tr_b16 v[174:175], v213 offset:41216
    s_mov_b32 s38, 5
p3_cloop:
    s_waitcnt lgkmcnt(15)
    v_mfma_f32_16x16x32_bf16 v[4:7], v[148:151], v[116:119], v[4:7]
    ds_read_b128 v[132:135], v205 offset:0
    s_waitcnt lgkmcnt(13)
    v_mfma_f32_16x16x32_bf16 v[8:11], v[152:155], v[116:119], v[8:11]
    ds_read_b64_tr_b16 v[176:177], v210 offset:20480
    v_mfma_f32_16x16x32_bf16 v[32:35], v[148:151], v[120:123], v[32:35]
    ds_read_b64_tr_b16 v[178:179], v210 offset:20992
    v_mfma_f32_16x16x32_bf16 v[36:39], v[152:155], v[120:123], v[36:39]
    ds_read_b128 v[136:139], v205 offset:2048
    s_waitcnt lgkmcnt(13)
    v_mfma_f32_16x16x32_bf16 v[12:15], v[156:159], v[116:119], v[12:15]
    ds_read_b64_tr_b16 v[180:181], v210 offset:20736
    v_mfma_f32_16x16x32_bf16 v[60:63], v[148:151], v[124:127], v[60:63]
    ds_read_b64_tr_b16 v[182:183], v210 offset:21248
    v_mfma_f32_16x16x32_bf16 v[40:43], v[156:159], v[120:123], v[40:43]
    ds_read_b128 v[140:143], v205 offset:4096
    v_mfma_f32_16x16x32_bf16 v[64:67], v[152:155], v[124:127], v[64:67]
    ds_read_b64_tr_b16 v[184:185], v210 offset:28672
    v_mfma_f32_16x16x32_bf16 v[68:71], v[156:159], v[124:127], v[68:71]
    ds_read_b64_tr_b16 v[186:187], v210 offset:29184
    s_waitcnt lgkmcnt(15)
    v_mfma_f32_16x16x32_bf16 v[16:19], v[160:163], v[116:119], v[16:19]
    ds_read_b128 v[144:147], v205 offset:6144
    v_mfma_f32_16x16x32_bf16 v[88:91], v[148:151], v[128:131], v[88:91]
    ds_read_b64_tr_b16 v[188:189], v210 offset:28928
    v_mfma_f32_16x16x32_bf16 v[44:47], v[160:163], v[120:123], v[44:47]
    ds_read_b64_tr_b16 v[190:191], v210 offset:29440
    v_mfma_f32_16x16x32_bf16 v[92:95], v[152:155], v[128:131], v[92:95]
    ds_read_b64_tr_b16 v[192:193], v210 offset:36864
    v_mfma_f32_16x16x32_bf16 v[72:75], v[160:163], v[124:127], v[72:75]
    ds_read_b64_tr_b16 v[194:195], v210 offset:37376
    v_mfma_f32_16x16x32_bf16 v[96:99], v[156:159], v[128:131], v[96:99]
    ds_read_b64_tr_b16 v[196:197], v210 offset:37120
    v_mfma_f32_16x16x32_bf16 v[100:103], v[160:163], v[128:131], v[100:103]
    ds_read_b64_tr_b16 v[198:199], v210 offset:37632
    s_waitcnt lgkmcnt(15)
    v_mfma_f32_16x16x32_bf16 v[20:23], v[164:167], v[116:119], v[20:23]
    ds_read_b64_tr_b16 v[200:201], v213 offset:43008
    v_mfma_f32_16x16x32_bf16 v[48:51], v[164:167], v[120:123], v[48:51]
    ds_read_b64_tr_b16 v[202:203], v213 offset:43264
    v_mfma_f32_16x16x32_bf16 v[76:79], v[164:167], v[124:127], v[76:79]
    v_mfma_f32_16x16x32_bf16 v[104:107], v[164:167], v[128:131], v[104:107]
    v_mfma_f32_16x16x32_bf16 v[24:27], v[168:171], v[116:119], v[24:27]
    v_mfma_f32_16x16x32_bf16 v[52:55], v[168:171], v[120:123], v[52:55]
    v_mfma_f32_16x16x32_bf16 v[80:83], v[168:171], v[124:127], v[80:83]
    v_mfma_f32_16x16x32_bf16 v[108:111], v[168:171], v[128:131], v[108:111]
    v_mfma_f32_16x16x32_bf16 v[28:31], v[172:175], v[116:119], v[28:31]
    v_mfma_f32_16x16x32_bf16 v[56:59], v[172:175], v[120:123], v[56:59]
    v_mfma_f32_16x16x32_bf16 v[84:87], v[172:175], v[124:127], v[84:87]
    v_mfma_f32_16x16x32_bf16 v[112:115], v[172:175], v[128:131], v[112:115]
    s_waitcnt lgkmcnt(15)
    v_mfma_f32_16x16x32_bf16 v[4:7], v[176:179], v[132:135], v[4:7]
    s_waitcnt lgkmcnt(0)
    s_barrier
    ds_read_b128 v[116:119], v206 offset:0
    v_mfma_f32_16x16x32_bf16 v[8:11], v[180:183], v[132:135], v[8:11]
    ds_read_b64_tr_b16 v[148:149], v211 offset:16384
    v_mfma_f32_16x16x32_bf16 v[32:35], v[176:179], v[136:139], v[32:35]
    ds_read_b64_tr_b16 v[150:151], v211 offset:16896
    v_mfma_f32_16x16x32_bf16 v[36:39], v[180:183], v[136:139], v[36:39]
    ds_read_b128 v[120:123], v206 offset:2048
    v_mfma_f32_16x16x32_bf16 v[12:15], v[184:187], v[132:135], v[12:15]
    ds_read_b64_tr_b16 v[152:153], v211 offset:16640
    v_mfma_f32_16x16x32_bf16 v[60:63], v[176:179], v[140:143], v[60:63]
    ds_read_b64_tr_b16 v[154:155], v211 offset:17152
    v_mfma_f32_16x16x32_bf16 v[40:43], v[184:187], v[136:139], v[40:43]
    ds_read_b128 v[124:127], v206 offset:4096
    v_mfma_f32_16x16x32_bf16 v[64:67], v[180:183], v[140:143], v[64:67]
    ds_read_b64_tr_b16 v[156:157], v211 offset:24576
    v_mfma_f32_16x16x32_bf16 v[68:71], v[184:187], v[140:143], v[68:71]
    ds_read_b64_tr_b16 v[158:159], v211 offset:25088
    v_mfma_f32_16x16x32_bf16 v[16:19], v[188:191], v[132:135], v[16:19]
    ds_read_b128 v[128:131], v206 offset:6144
    v_mfma_f32_16x16x32_bf16 v[88:91], v[176:179], v[144:147], v[88:91]
    ds_read_b64_tr_b16 v[160:161], v211 offset:24832
    v_mfma_f32_16x16x32_bf16 v[44:47], v[188:191], v[136:139], v[44:47]
    ds_read_b64_tr_b16 v[162:163], v211 offset:25344
    v_mfma_f32_16x16x32_bf16 v[92:95], v[180:183], v[144:147], v[92:95]
    ds_read_b64_tr_b16 v[164:165], v211 offset:32768
    v_mfma_f32_16x16x32_bf16 v[72:75], v[188:191], v[140:143], v[72:75]
    ds_read_b64_tr_b16 v[166:167], v211 offset:33280
    v_mfma_f32_16x16x32_bf16 v[96:99], v[184:187], v[144:147], v[96:99]
    ds_read_b64_tr_b16 v[168:169], v211 offset:33024
    v_mfma_f32_16x16x32_bf16 v[100:103], v[188:191], v[144:147], v[100:103]
    ds_read_b64_tr_b16 v[170:171], v211 offset:33536
    v_mfma_f32_16x16x32_bf16 v[20:23], v[192:195], v[132:135], v[20:23]
    ds_read_b64_tr_b16 v[172:173], v214 offset:40960
    v_mfma_f32_16x16x32_bf16 v[48:51], v[192:195], v[136:139], v[48:51]
    ds_read_b64_tr_b16 v[174:175], v214 offset:41216
    v_mfma_f32_16x16x32_bf16 v[76:79], v[192:195], v[140:143], v[76:79]
    v_mfma_f32_16x16x32_bf16 v[104:107], v[192:195], v[144:147], v[104:107]
    v_mfma_f32_16x16x32_bf16 v[24:27], v[196:199], v[132:135], v[24:27]
    v_mfma_f32_16x16x32_bf16 v[52:55], v[196:199], v[136:139], v[52:55]
    v_mfma_f32_16x16x32_bf16 v[80:83], v[196:199], v[140:143], v[80:83]
    v_mfma_f32_16x16x32_bf16 v[108:111], v[196:199], v[144:147], v[108:111]
    v_mfma_f32_16x16x32_bf16 v[28:31], v[200:203], v[132:135], v[28:31]
    v_mfma_f32_16x16x32_bf16 v[56:59], v[200:203], v[136:139], v[56:59]
    v_mfma_f32_16x16x32_bf16 v[84:87], v[200:203], v[140:143], v[84:87]
    v_mfma_f32_16x16x32_bf16 v[112:115], v[200:203], v[144:147], v[112:115]
    s_waitcnt lgkmcnt(15)
    v_mfma_f32_16x16x32_bf16 v[4:7], v[148:151], v[116:119], v[4:7]
    ds_read_b128 v[132:135], v207 offset:0
    s_waitcnt lgkmcnt(13)
    v_mfma_f32_16x16x32_bf16 v[8:11], v[152:155], v[116:119], v[8:11]
    ds_read_b64_tr_b16 v[176:177], v211 offset:20480
    v_mfma_f32_16x16x32_bf16 v[32:35], v[148:151], v[120:123], v[32:35]
    ds_read_b64_tr_b16 v[178:179], v211 offset:20992
    v_mfma_f32_16x16x32_bf16 v[36:39], v[152:155], v[120:123], v[36:39]
    ds_read_b128 v[136:139], v207 offset:2048
    s_waitcnt lgkmcnt(13)
    v_mfma_f32_16x16x32_bf16 v[12:15], v[156:159], v[116:119], v[12:15]
    ds_read_b64_tr_b16 v[180:181], v211 offset:20736
    v_mfma_f32_16x16x32_bf16 v[60:63], v[148:151], v[124:127], v[60:63]
    ds_read_b64_tr_b16 v[182:183], v211 offset:21248
    v_mfma_f32_16x16x32_bf16 v[40:43], v[156:159], v[120:123], v[40:43]
    ds_read_b128 v[140:143], v207 offset:4096
    v_mfma_f32_16x16x32_bf16 v[64:67], v[152:155], v[124:127], v[64:67]
    ds_read_b64_tr_b16 v[184:185], v211 offset:28672
    v_mfma_f32_16x16x32_bf16 v[68:71], v[156:159], v[124:127], v[68:71]
    ds_read_b64_tr_b16 v[186:187], v211 offset:29184
    s_waitcnt lgkmcnt(15)
    v_mfma_f32_16x16x32_bf16 v[16:19], v[160:163], v[116:119], v[16:19]
    ds_read_b128 v[144:147], v207 offset:6144
    v_mfma_f32_16x16x32_bf16 v[88:91], v[148:151], v[128:131], v[88:91]
    ds_read_b64_tr_b16 v[188:189], v211 offset:28928
    v_mfma_f32_16x16x32_bf16 v[44:47], v[160:163], v[120:123], v[44:47]
    ds_read_b64_tr_b16 v[190:191], v211 offset:29440
    v_mfma_f32_16x16x32_bf16 v[92:95], v[152:155], v[128:131], v[92:95]
    ds_read_b64_tr_b16 v[192:193], v211 offset:36864
    v_mfma_f32_16x16x32_bf16 v[72:75], v[160:163], v[124:127], v[72:75]
    ds_read_b64_tr_b16 v[194:195], v211 offset:37376
    v_mfma_f32_16x16x32_bf16 v[96:99], v[156:159], v[128:131], v[96:99]
    ds_read_b64_tr_b16 v[196:197], v211 offset:37120
    v_mfma_f32_16x16x32_bf16 v[100:103], v[160:163], v[128:131], v[100:103]
    ds_read_b64_tr_b16 v[198:199], v211 offset:37632
    s_waitcnt lgkmcnt(15)
    v_mfma_f32_16x16x32_bf16 v[20:23], v[164:167], v[116:119], v[20:23]
    ds_read_b64_tr_b16 v[200:201], v214 offset:43008
    v_mfma_f32_16x16x32_bf16 v[48:51], v[164:167], v[120:123], v[48:51]
    ds_read_b64_tr_b16 v[202:203], v214 offset:43264
    v_mfma_f32_16x16x32_bf16 v[76:79], v[164:167], v[124:127], v[76:79]
    v_mfma_f32_16x16x32_bf16 v[104:107], v[164:167], v[128:131], v[104:107]
    v_mfma_f32_16x16x32_bf16 v[24:27], v[168:171], v[116:119], v[24:27]
    v_mfma_f32_16x16x32_bf16 v[52:55], v[168:171], v[120:123], v[52:55]
    v_mfma_f32_16x16x32_bf16 v[80:83], v[168:171], v[124:127], v[80:83]
    v_mfma_f32_16x16x32_bf16 v[108:111], v[168:171], v[128:131], v[108:111]
    v_mfma_f32_16x16x32_bf16 v[28:31], v[172:175], v[116:119], v[28:31]
    v_mfma_f32_16x16x32_bf16 v[56:59], v[172:175], v[120:123], v[56:59]
    v_mfma_f32_16x16x32_bf16 v[84:87], v[172:175], v[124:127], v[84:87]
    v_mfma_f32_16x16x32_bf16 v[112:115], v[172:175], v[128:131], v[112:115]
    s_waitcnt lgkmcnt(15)
    v_mfma_f32_16x16x32_bf16 v[4:7], v[176:179], v[132:135], v[4:7]
    s_waitcnt lgkmcnt(0)
    s_barrier
    ds_read_b128 v[116:119], v208 offset:0
    v_mfma_f32_16x16x32_bf16 v[8:11], v[180:183], v[132:135], v[8:11]
    ds_read_b64_tr_b16 v[148:149], v212 offset:16384
    v_mfma_f32_16x16x32_bf16 v[32:35], v[176:179], v[136:139], v[32:35]
    ds_read_b64_tr_b16 v[150:151], v212 offset:16896
    v_mfma_f32_16x16x32_bf16 v[36:39], v[180:183], v[136:139], v[36:39]
    ds_read_b128 v[120:123], v208 offset:2048
    v_mfma_f32_16x16x32_bf16 v[12:15], v[184:187], v[132:135], v[12:15]
    ds_read_b64_tr_b16 v[152:153], v212 offset:16640
    v_mfma_f32_16x16x32_bf16 v[60:63], v[176:179], v[140:143], v[60:63]
    ds_read_b64_tr_b16 v[154:155], v212 offset:17152
    v_mfma_f32_16x16x32_bf16 v[40:43], v[184:187], v[136:139], v[40:43]
    ds_read_b128 v[124:127], v208 offset:4096
    v_mfma_f32_16x16x32_bf16 v[64:67], v[180:183], v[140:143], v[64:67]
    ds_read_b64_tr_b16 v[156:157], v212 offset:24576
    v_mfma_f32_16x16x32_bf16 v[68:71], v[184:187], v[140:143], v[68:71]
    ds_read_b64_tr_b16 v[158:159], v212 offset:25088
    v_mfma_f32_16x16x32_bf16 v[16:19], v[188:191], v[132:135], v[16:19]
    ds_read_b128 v[128:131], v208 offset:6144
    v_mfma_f32_16x16x32_bf16 v[88:91], v[176:179], v[144:147], v[88:91]
    ds_read_b64_tr_b16 v[160:161], v212 offset:24832
    v_mfma_f32_16x16x32_bf16 v[44:47], v[188:191], v[136:139], v[44:47]
    ds_read_b64_tr_b16 v[162:163], v212 offset:25344
    v_mfma_f32_16x16x32_bf16 v[92:95], v[180:183], v[144:147], v[92:95]
    ds_read_b64_tr_b16 v[164:165], v212 offset:32768
    v_mfma_f32_16x16x32_bf16 v[72:75], v[188:191], v[140:143], v[72:75]
    ds_read_b64_tr_b16 v[166:167], v212 offset:33280
    v_mfma_f32_16x16x32_bf16 v[96:99], v[184:187], v[144:147], v[96:99]
    ds_read_b64_tr_b16 v[168:169], v212 offset:33024
    v_mfma_f32_16x16x32_bf16 v[100:103], v[188:191], v[144:147], v[100:103]
    ds_read_b64_tr_b16 v[170:171], v212 offset:33536
    v_mfma_f32_16x16x32_bf16 v[20:23], v[192:195], v[132:135], v[20:23]
    ds_read_b64_tr_b16 v[172:173], v215 offset:40960
    v_mfma_f32_16x16x32_bf16 v[48:51], v[192:195], v[136:139], v[48:51]
    ds_read_b64_tr_b16 v[174:175], v215 offset:41216
    v_mfma_f32_16x16x32_bf16 v[76:79], v[192:195], v[140:143], v[76:79]
    v_mfma_f32_16x16x32_bf16 v[104:107], v[192:195], v[144:147], v[104:107]
    v_mfma_f32_16x16x32_bf16 v[24:27], v[196:199], v[132:135], v[24:27]
    v_mfma_f32_16x16x32_bf16 v[52:55], v[196:199], v[136:139], v[52:55]
    v_mfma_f32_16x16x32_bf16 v[80:83], v[196:199], v[140:143], v[80:83]
    v_mfma_f32_16x16x32_bf16 v[108:111], v[196:199], v[144:147], v[108:111]
    v_mfma_f32_16x16x32_bf16 v[28:31], v[200:203], v[132:135], v[28:31]
    v_mfma_f32_16x16x32_bf16 v[56:59], v[200:203], v[136:139], v[56:59]
    v_mfma_f32_16x16x32_bf16 v[84:87], v[200:203], v[140:143], v[84:87]
    v_mfma_f32_16x16x32_bf16 v[112:115], v[200:203], v[144:147], v[112:115]
    s_waitcnt lgkmcnt(15)
    v_mfma_f32_16x16x32_bf16 v[4:7], v[148:151], v[116:119], v[4:7]
    ds_read_b128 v[132:135], v209 offset:0
    s_waitcnt lgkmcnt(13)
    v_mfma_f32_16x16x32_bf16 v[8:11], v[152:155], v[116:119], v[8:11]
    ds_read_b64_tr_b16 v[176:177], v212 offset:20480
    v_mfma_f32_16x16x32_bf16 v[32:35], v[148:151], v[120:123], v[32:35]
    ds_read_b64_tr_b16 v[178:179], v212 offset:20992
    v_mfma_f32_16x16x32_bf16 v[36:39], v[152:155], v[120:123], v[36:39]
    ds_read_b128 v[136:139], v209 offset:2048
    s_waitcnt lgkmcnt(13)
    v_mfma_f32_16x16x32_bf16 v[12:15], v[156:159], v[116:119], v[12:15]
    ds_read_b64_tr_b16 v[180:181], v212 offset:20736
    v_mfma_f32_16x16x32_bf16 v[60:63], v[148:151], v[124:127], v[60:63]
    ds_read_b64_tr_b16 v[182:183], v212 offset:21248
    v_mfma_f32_16x16x32_bf16 v[40:43], v[156:159], v[120:123], v[40:43]
    ds_read_b128 v[140:143], v209 offset:4096
    v_mfma_f32_16x16x32_bf16 v[64:67], v[152:155], v[124:127], v[64:67]
    ds_read_b64_tr_b16 v[184:185], v212 offset:28672
    v_mfma_f32_16x16x32_bf16 v[68:71], v[156:159], v[124:127], v[68:71]
    ds_read_b64_tr_b16 v[186:187], v212 offset:29184
    s_waitcnt lgkmcnt(15)
    v_mfma_f32_16x16x32_bf16 v[16:19], v[160:163], v[116:119], v[16:19]
    ds_read_b128 v[144:147], v209 offset:6144
    v_mfma_f32_16x16x32_bf16 v[88:91], v[148:151], v[128:131], v[88:91]
    ds_read_b64_tr_b16 v[188:189], v212 offset:28928
    v_mfma_f32_16x16x32_bf16 v[44:47], v[160:163], v[120:123], v[44:47]
    ds_read_b64_tr_b16 v[190:191], v212 offset:29440
    v_mfma_f32_16x16x32_bf16 v[92:95], v[152:155], v[128:131], v[92:95]
    ds_read_b64_tr_b16 v[192:193], v212 offset:36864
    v_mfma_f32_16x16x32_bf16 v[72:75], v[160:163], v[124:127], v[72:75]
    ds_read_b64_tr_b16 v[194:195], v212 offset:37376
    v_mfma_f32_16x16x32_bf16 v[96:99], v[156:159], v[128:131], v[96:99]
    ds_read_b64_tr_b16 v[196:197], v212 offset:37120
    v_mfma_f32_16x16x32_bf16 v[100:103], v[160:163], v[128:131], v[100:103]
    ds_read_b64_tr_b16 v[198:199], v212 offset:37632
    s_waitcnt lgkmcnt(15)
    v_mfma_f32_16x16x32_bf16 v[20:23], v[164:167], v[116:119], v[20:23]
    ds_read_b64_tr_b16 v[200:201], v215 offset:43008
    v_mfma_f32_16x16x32_bf16 v[48:51], v[164:167], v[120:123], v[48:51]
    ds_read_b64_tr_b16 v[202:203], v215 offset:43264
    v_mfma_f32_16x16x32_bf16 v[76:79], v[164:167], v[124:127], v[76:79]
    v_mfma_f32_16x16x32_bf16 v[104:107], v[164:167], v[128:131], v[104:107]
    v_mfma_f32_16x16x32_bf16 v[24:27], v[168:171], v[116:119], v[24:27]
    v_mfma_f32_16x16x32_bf16 v[52:55], v[168:171], v[120:123], v[52:55]
    v_mfma_f32_16x16x32_bf16 v[80:83], v[168:171], v[124:127], v[80:83]
    v_mfma_f32_16x16x32_bf16 v[108:111], v[168:171], v[128:131], v[108:111]
    v_mfma_f32_16x16x32_bf16 v[28:31], v[172:175], v[116:119], v[28:31]
    v_mfma_f32_16x16x32_bf16 v[56:59], v[172:175], v[120:123], v[56:59]
    v_mfma_f32_16x16x32_bf16 v[84:87], v[172:175], v[124:127], v[84:87]
    v_mfma_f32_16x16x32_bf16 v[112:115], v[172:175], v[128:131], v[112:115]
    s_waitcnt lgkmcnt(15)
    v_mfma_f32_16x16x32_bf16 v[4:7], v[176:179], v[132:135], v[4:7]
    s_waitcnt lgkmcnt(0)
    s_barrier
    ds_read_b128 v[116:119], v204 offset:0
    v_mfma_f32_16x16x32_bf16 v[8:11], v[180:183], v[132:135], v[8:11]
    ds_read_b64_tr_b16 v[148:149], v210 offset:16384
    v_mfma_f32_16x16x32_bf16 v[32:35], v[176:179], v[136:139], v[32:35]
    ds_read_b64_tr_b16 v[150:151], v210 offset:16896
    v_mfma_f32_16x16x32_bf16 v[36:39], v[180:183], v[136:139], v[36:39]
    ds_read_b128 v[120:123], v204 offset:2048
    v_mfma_f32_16x16x32_bf16 v[12:15], v[184:187], v[132:135], v[12:15]
    ds_read_b64_tr_b16 v[152:153], v210 offset:16640
    v_mfma_f32_16x16x32_bf16 v[60:63], v[176:179], v[140:143], v[60:63]
    ds_read_b64_tr_b16 v[154:155], v210 offset:17152
    v_mfma_f32_16x16x32_bf16 v[40:43], v[184:187], v[136:139], v[40:43]
    ds_read_b128 v[124:127], v204 offset:4096
    v_mfma_f32_16x16x32_bf16 v[64:67], v[180:183], v[140:143], v[64:67]
    ds_read_b64_tr_b16 v[156:157], v210 offset:24576
    v_mfma_f32_16x16x32_bf16 v[68:71], v[184:187], v[140:143], v[68:71]
    ds_read_b64_tr_b16 v[158:159], v210 offset:25088
    v_mfma_f32_16x16x32_bf16 v[16:19], v[188:191], v[132:135], v[16:19]
    ds_read_b128 v[128:131], v204 offset:6144
    v_mfma_f32_16x16x32_bf16 v[88:91], v[176:179], v[144:147], v[88:91]
    ds_read_b64_tr_b16 v[160:161], v210 offset:24832
    v_mfma_f32_16x16x32_bf16 v[44:47], v[188:191], v[136:139], v[44:47]
    ds_read_b64_tr_b16 v[162:163], v210 offset:25344
    v_mfma_f32_16x16x32_bf16 v[92:95], v[180:183], v[144:147], v[92:95]
    ds_read_b64_tr_b16 v[164:165], v210 offset:32768
    v_mfma_f32_16x16x32_bf16 v[72:75], v[188:191], v[140:143], v[72:75]
    ds_read_b64_tr_b16 v[166:167], v210 offset:33280
    v_mfma_f32_16x16x32_bf16 v[96:99], v[184:187], v[144:147], v[96:99]
    ds_read_b64_tr_b16 v[168:169], v210 offset:33024
    v_mfma_f32_16x16x32_bf16 v[100:103], v[188:191], v[144:147], v[100:103]
    ds_read_b64_tr_b16 v[170:171], v210 offset:33536
    v_mfma_f32_16x16x32_bf16 v[20:23], v[192:195], v[132:135], v[20:23]
    ds_read_b64_tr_b16 v[172:173], v213 offset:40960
    v_mfma_f32_16x16x32_bf16 v[48:51], v[192:195], v[136:139], v[48:51]
    ds_read_b64_tr_b16 v[174:175], v213 offset:41216
    v_mfma_f32_16x16x32_bf16 v[76:79], v[192:195], v[140:143], v[76:79]
    v_mfma_f32_16x16x32_bf16 v[104:107], v[192:195], v[144:147], v[104:107]
    v_mfma_f32_16x16x32_bf16 v[24:27], v[196:199], v[132:135], v[24:27]
    v_mfma_f32_16x16x32_bf16 v[52:55], v[196:199], v[136:139], v[52:55]
    v_mfma_f32_16x16x32_bf16 v[80:83], v[196:199], v[140:143], v[80:83]
    v_mfma_f32_16x16x32_bf16 v[108:111], v[196:199], v[144:147], v[108:111]
    v_mfma_f32_16x16x32_bf16 v[28:31], v[200:203], v[132:135], v[28:31]
    v_mfma_f32_16x16x32_bf16 v[56:59], v[200:203], v[136:139], v[56:59]
    v_mfma_f32_16x16x32_bf16 v[84:87], v[200:203], v[140:143], v[84:87]
    v_mfma_f32_16x16x32_bf16 v[112:115], v[200:203], v[144:147], v[112:115]
    s_sub_u32 s38, s38, 1
    s_cmp_lg_u32 s38, 0
    s_cbranch_scc1 p3_cloop
    s_waitcnt lgkmcnt(15)
    v_mfma_f32_16x16x32_bf16 v[4:7], v[148:151], v[116:119], v[4:7]
    ds_read_b128 v[132:135], v205 offset:0
    s_waitcnt lgkmcnt(13)
    v_mfma_f32_16x16x32_bf16 v[8:11], v[152:155], v[116:119], v[8:11]
    ds_read_b64_tr_b16 v[176:177], v210 offset:20480
    v_mfma_f32_16x16x32_bf16 v[32:35], v[148:151], v[120:123], v[32:35]
    ds_read_b64_tr_b16 v[178:179], v210 offset:20992
    v_mfma_f32_16x16x32_bf16 v[36:39], v[152:155], v[120:123], v[36:39]
    ds_read_b128 v[136:139], v205 offset:2048
    s_waitcnt lgkmcnt(13)
    v_mfma_f32_16x16x32_bf16 v[12:15], v[156:159], v[116:119], v[12:15]
    ds_read_b64_tr_b16 v[180:181], v210 offset:20736
    v_mfma_f32_16x16x32_bf16 v[60:63], v[148:151], v[124:127], v[60:63]
    ds_read_b64_tr_b16 v[182:183], v210 offset:21248
    v_mfma_f32_16x16x32_bf16 v[40:43], v[156:159], v[120:123], v[40:43]
    ds_read_b128 v[140:143], v205 offset:4096
    v_mfma_f32_16x16x32_bf16 v[64:67], v[152:155], v[124:127], v[64:67]
    ds_read_b64_tr_b16 v[184:185], v210 offset:28672
    v_mfma_f32_16x16x32_bf16 v[68:71], v[156:159], v[124:127], v[68:71]
    ds_read_b64_tr_b16 v[186:187], v210 offset:29184
    s_waitcnt lgkmcnt(15)
    v_mfma_f32_16x16x32_bf16 v[16:19], v[160:163], v[116:119], v[16:19]
    ds_read_b128 v[144:147], v205 offset:6144
    v_mfma_f32_16x16x32_bf16 v[88:91], v[148:151], v[128:131], v[88:91]
    ds_read_b64_tr_b16 v[188:189], v210 offset:28928
    v_mfma_f32_16x16x32_bf16 v[44:47], v[160:163], v[120:123], v[44:47]
    ds_read_b64_tr_b16 v[190:191], v210 offset:29440
    v_mfma_f32_16x16x32_bf16 v[92:95], v[152:155], v[128:131], v[92:95]
    ds_read_b64_tr_b16 v[192:193], v210 offset:36864
    v_mfma_f32_16x16x32_bf16 v[72:75], v[160:163], v[124:127], v[72:75]
    ds_read_b64_tr_b16 v[194:195], v210 offset:37376
    v_mfma_f32_16x16x32_bf16 v[96:99], v[156:159], v[128:131], v[96:99]
    ds_read_b64_tr_b16 v[196:197], v210 offset:37120
    v_mfma_f32_16x16x32_bf16 v[100:103], v[160:163], v[128:131], v[100:103]
    ds_read_b64_tr_b16 v[198:199], v210 offset:37632
    s_waitcnt lgkmcnt(15)
    v_mfma_f32_16x16x32_bf16 v[20:23], v[164:167], v[116:119], v[20:23]
    ds_read_b64_tr_b16 v[200:201], v213 offset:43008
    v_mfma_f32_16x16x32_bf16 v[48:51], v[164:167], v[120:123], v[48:51]
    ds_read_b64_tr_b16 v[202:203], v213 offset:43264
    v_mfma_f32_16x16x32_bf16 v[76:79], v[164:167], v[124:127], v[76:79]
    v_mfma_f32_16x16x32_bf16 v[104:107], v[164:167], v[128:131], v[104:107]
    v_mfma_f32_16x16x32_bf16 v[24:27], v[168:171], v[116:119], v[24:27]
    v_mfma_f32_16x16x32_bf16 v[52:55], v[168:171], v[120:123], v[52:55]
    v_mfma_f32_16x16x32_bf16 v[80:83], v[168:171], v[124:127], v[80:83]
    v_mfma_f32_16x16x32_bf16 v[108:111], v[168:171], v[128:131], v[108:111]
    v_mfma_f32_16x16x32_bf16 v[28:31], v[172:175], v[116:119], v[28:31]
    v_mfma_f32_16x16x32_bf16 v[56:59], v[172:175], v[120:123], v[56:59]
    v_mfma_f32_16x16x32_bf16 v[84:87], v[172:175], v[124:127], v[84:87]
    v_mfma_f32_16x16x32_bf16 v[112:115], v[172:175], v[128:131], v[112:115]
    s_waitcnt lgkmcnt(15)
    v_mfma_f32_16x16x32_bf16 v[4:7], v[176:179], v[132:135], v[4:7]
    s_waitcnt lgkmcnt(12)
    v_mfma_f32_16x16x32_bf16 v[8:11], v[180:183], v[132:135], v[8:11]
    v_mfma_f32_16x16x32_bf16 v[32:35], v[176:179], v[136:139], v[32:35]
    v_mfma_f32_16x16x32_bf16 v[36:39], v[180:183], v[136:139], v[36:39]
    s_waitcnt lgkmcnt(9)
    v_mfma_f32_16x16x32_bf16 v[12:15], v[184:187], v[132:135], v[12:15]
    v_mfma_f32_16x16x32_bf16 v[60:63], v[176:179], v[140:143], v[60:63]
    v_mfma_f32_16x16x32_bf16 v[40:43], v[184:187], v[136:139], v[40:43]
    v_mfma_f32_16x16x32_bf16 v[64:67], v[180:183], v[140:143], v[64:67]
    v_mfma_f32_16x16x32_bf16 v[68:71], v[184:187], v[140:143], v[68:71]
    s_waitcnt lgkmcnt(6)
    v_mfma_f32_16x16x32_bf16 v[16:19], v[188:191], v[132:135], v[16:19]
    v_mfma_f32_16x16x32_bf16 v[88:91], v[176:179], v[144:147], v[88:91]
    v_mfma_f32_16x16x32_bf16 v[44:47], v[188:191], v[136:139], v[44:47]
    v_mfma_f32_16x16x32_bf16 v[92:95], v[180:183], v[144:147], v[92:95]
    v_mfma_f32_16x16x32_bf16 v[72:75], v[188:191], v[140:143], v[72:75]
    v_mfma_f32_16x16x32_bf16 v[96:99], v[184:187], v[144:147], v[96:99]
    v_mfma_f32_16x16x32_bf16 v[100:103], v[188:191], v[144:147], v[100:103]
    s_waitcnt lgkmcnt(4)
    v_mfma_f32_16x16x32_bf16 v[20:23], v[192:195], v[132:135], v[20:23]
    v_mfma_f32_16x16x32_bf16 v[48:51], v[192:195], v[136:139], v[48:51]
    v_mfma_f32_16x16x32_bf16 v[76:79], v[192:195], v[140:143], v[76:79]
    v_mfma_f32_16x16x32_bf16 v[104:107], v[192:195], v[144:147], v[104:107]
    s_waitcnt lgkmcnt(2)
    v_mfma_f32_16x16x32_bf16 v[24:27], v[196:199], v[132:135], v[24:27]
    v_mfma_f32_16x16x32_bf16 v[52:55], v[196:199], v[136:139], v[52:55]
    v_mfma_f32_16x16x32_bf16 v[80:83], v[196:199], v[140:143], v[80:83]
    v_mfma_f32_16x16x32_bf16 v[108:111], v[196:199], v[144:147], v[108:111]
    s_waitcnt lgkmcnt(0)
    v_mfma_f32_16x16x32_bf16 v[28:31], v[200:203], v[132:135], v[28:31]
    v_mfma_f32_16x16x32_bf16 v[56:59], v[200:203], v[136:139], v[56:59]
    v_mfma_f32_16x16x32_bf16 v[84:87], v[200:203], v[140:143], v[84:87]
    v_mfma_f32_16x16x32_bf16 v[112:115], v[200:203], v[144:147], v[112:115]
    v_and_b32 v116, 15, v0
    v_lshrrev_b32 v117, 4, v0
    s_lshl_b32 s31, s42, 6
    v_add_u32 v118, s31, v116
    v_lshlrev_b32 v119, 3, v118
    v_add_u32 v119, 135168, v119
    v_mul_u32_u24 v118, 464, v118
    v_lshl_add_u32 v118, v117, 3, v118
    s_lshl_b32 s31, s43, 5
    s_add_u32 s31, s31, 45056
    v_add_u32 v118, s31, v118
    v_lshlrev_b32 v120, 4, v117
    s_lshl_b32 s31, s43, 6
    s_add_u32 s31, s31, 136192
    v_add_u32 v120, s31, v120
    ds_read_b64 v[122:123], v119 offset:0
    ds_read_b64 v[124:125], v119 offset:128
    ds_read_b64 v[126:127], v119 offset:256
    ds_read_b64 v[128:129], v119 offset:384
    ds_read_b128 v[132:135], v120 offset:0
    ds_read_b128 v[136:139], v120 offset:128
    ds_read_b128 v[140:143], v120 offset:256
    ds_read_b128 v[144:147], v120 offset:384
    ds_read_b128 v[148:151], v120 offset:512
    ds_read_b128 v[152:155], v120 offset:640
    ds_read_b128 v[156:159], v120 offset:768
    s_waitcnt lgkmcnt(0)
    v_pk_fma_f32 v[4:5], v[132:133], v[122:123], v[4:5] op_sel_hi:[1,0,1] neg_lo:[0,1,0] neg_hi:[0,1,0]
    v_pk_fma_f32 v[6:7], v[134:135], v[122:123], v[6:7] op_sel_hi:[1,0,1] neg_lo:[0,1,0] neg_hi:[0,1,0]
    v_pk_mul_f32 v[4:5], v[4:5], v[122:123] op_sel:[0,1] op_sel_hi:[1,1]
    v_pk_mul_f32 v[6:7], v[6:7], v[122:123] op_sel:[0,1] op_sel_hi:[1,1]
    v_cvt_pk_bf16_f32 v4, v4, v5
    v_cvt_pk_bf16_f32 v5, v6, v7
    v_pk_max_i16 v4, v4, 0
    v_pk_max_i16 v5, v5, 0
    ds_write_b64 v118, v[4:5] offset:0
    v_pk_fma_f32 v[8:9], v[136:137], v[122:123], v[8:9] op_sel_hi:[1,0,1] neg_lo:[0,1,0] neg_hi:[0,1,0]
    v_pk_fma_f32 v[10:11], v[138:139], v[122:123], v[10:11] op_sel_hi:[1,0,1] neg_lo:[0,1,0] neg_hi:[0,1,0]
    v_pk_mul_f32 v[8:9], v[8:9], v[122:123] op_sel:[0,1] op_sel_hi:[1,1]
    v_pk_mul_f32 v[10:11], v[10:11], v[122:123] op_sel:[0,1] op_sel_hi:[1,1]
    v_cvt_pk_bf16_f32 v8, v8, v9
    v_cvt_pk_bf16_f32 v9, v10, v11
    v_pk_max_i16 v8, v8, 0
    v_pk_max_i16 v9, v9, 0
    ds_write_b64 v118, v[8:9] offset:64
    v_pk_fma_f32 v[12:13], v[140:141], v[122:123], v[12:13] op_sel_hi:[1,0,1] neg_lo:[0,1,0] neg_hi:[0,1,0]
    v_pk_fma_f32 v[14:15], v[142:143], v[122:123], v[14:15] op_sel_hi:[1,0,1] neg_lo:[0,1,0] neg_hi:[0,1,0]
    v_pk_mul_f32 v[12:13], v[12:13], v[122:123] op_sel:[0,1] op_sel_hi:[1,1]
    v_pk_mul_f32 v[14:15], v[14:15], v[122:123] op_sel:[0,1] op_sel_hi:[1,1]
    v_cvt_pk_bf16_f32 v12, v12, v13
    v_cvt_pk_bf16_f32 v13, v14, v15
    v_pk_max_i16 v12, v12, 0
    v_pk_max_i16 v13, v13, 0
    ds_write_b64 v118, v[12:13] offset:128
    v_pk_fma_f32 v[16:17], v[144:145], v[122:123], v[16:17] op_sel_hi:[1,0,1] neg_lo:[0,1,0] neg_hi:[0,1,0]
    v_pk_fma_f32 v[18:19], v[146:147], v[122:123], v[18:19] op_sel_hi:[1,0,1] neg_lo:[0,1,0] neg_hi:[0,1,0]
    v_pk_mul_f32 v[16:17], v[16:17], v[122:123] op_sel:[0,1] op_sel_hi:[1,1]
    v_pk_mul_f32 v[18:19], v[18:19], v[122:123] op_sel:[0,1] op_sel_hi:[1,1]
    v_cvt_pk_bf16_f32 v16, v16, v17
    v_cvt_pk_bf16_f32 v17, v18, v19
    v_pk_max_i16 v16, v16, 0
    v_pk_max_i16 v17, v17, 0
    ds_write_b64 v118, v[16:17] offset:192
    v_pk_fma_f32 v[20:21], v[148:149], v[122:123], v[20:21] op_sel_hi:[1,0,1] neg_lo:[0,1,0] neg_hi:[0,1,0]
    v_pk_fma_f32 v[22:23], v[150:151], v[122:123], v[22:23] op_sel_hi:[1,0,1] neg_lo:[0,1,0] neg_hi:[0,1,0]
    v_pk_mul_f32 v[20:21], v[20:21], v[122:123] op_sel:[0,1] op_sel_hi:[1,1]
    v_pk_mul_f32 v[22:23], v[22:23], v[122:123] op_sel:[0,1] op_sel_hi:[1,1]
    v_cvt_pk_bf16_f32 v20, v20, v21
    v_cvt_pk_bf16_f32 v21, v22, v23
    v_pk_max_i16 v20, v20, 0
    v_pk_max_i16 v21, v21, 0
    ds_write_b64 v118, v[20:21] offset:256
    v_pk_fma_f32 v[24:25], v[152:153], v[122:123], v[24:25] op_sel_hi:[1,0,1] neg_lo:[0,1,0] neg_hi:[0,1,0]
    v_pk_fma_f32 v[26:27], v[154:155], v[122:123], v[26:27] op_sel_hi:[1,0,1] neg_lo:[0,1,0] neg_hi:[0,1,0]
    v_pk_mul_f32 v[24:25], v[24:25], v[122:123] op_sel:[0,1] op_sel_hi:[1,1]
    v_pk_mul_f32 v[26:27], v[26:27], v[122:123] op_sel:[0,1] op_sel_hi:[1,1]
    v_cvt_pk_bf16_f32 v24, v24, v25
    v_cvt_pk_bf16_f32 v25, v26, v27
    v_pk_max_i16 v24, v24, 0
    v_pk_max_i16 v25, v25, 0
    ds_write_b64 v118, v[24:25] offset:320
    v_pk_fma_f32 v[28:29], v[156:157], v[122:123], v[28:29] op_sel_hi:[1,0,1] neg_lo:[0,1,0] neg_hi:[0,1,0]
    v_pk_fma_f32 v[30:31], v[158:159], v[122:123], v[30:31] op_sel_hi:[1,0,1] neg_lo:[0,1,0] neg_hi:[0,1,0]
    v_pk_mul_f32 v[28:29], v[28:29], v[122:123] op_sel:[0,1] op_sel_hi:[1,1]
    v_pk_mul_f32 v[30:31], v[30:31], v[122:123] op_sel:[0,1] op_sel_hi:[1,1]
    v_cvt_pk_bf16_f32 v28, v28, v29
    v_cvt_pk_bf16_f32 v29, v30, v31
    v_pk_max_i16 v28, v28, 0
    v_pk_max_i16 v29, v29, 0
    ds_write_b64 v118, v[28:29] offset:384
    v_pk_fma_f32 v[32:33], v[132:133], v[124:125], v[32:33] op_sel_hi:[1,0,1] neg_lo:[0,1,0] neg_hi:[0,1,0]
    v_pk_fma_f32 v[34:35], v[134:135], v[124:125], v[34:35] op_sel_hi:[1,0,1] neg_lo:[0,1,0] neg_hi:[0,1,0]
    v_pk_mul_f32 v[32:33], v[32:33], v[124:125] op_sel:[0,1] op_sel_hi:[1,1]
    v_pk_mul_f32 v[34:35], v[34:35], v[124:125] op_sel:[0,1] op_sel_hi:[1,1]
    v_cvt_pk_bf16_f32 v32, v32, v33
    v_cvt_pk_bf16_f32 v33, v34, v35
    v_pk_max_i16 v32, v32, 0
    v_pk_max_i16 v33, v33, 0
    ds_write_b64 v118, v[32:33] offset:7424
    v_pk_fma_f32 v[36:37], v[136:137], v[124:125], v[36:37] op_sel_hi:[1,0,1] neg_lo:[0,1,0] neg_hi:[0,1,0]
    v_pk_fma_f32 v[38:39], v[138:139], v[124:125], v[38:39] op_sel_hi:[1,0,1] neg_lo:[0,1,0] neg_hi:[0,1,0]
    v_pk_mul_f32 v[36:37], v[36:37], v[124:125] op_sel:[0,1] op_sel_hi:[1,1]
    v_pk_mul_f32 v[38:39], v[38:39], v[124:125] op_sel:[0,1] op_sel_hi:[1,1]
    v_cvt_pk_bf16_f32 v36, v36, v37
    v_cvt_pk_bf16_f32 v37, v38, v39
    v_pk_max_i16 v36, v36, 0
    v_pk_max_i16 v37, v37, 0
    ds_write_b64 v118, v[36:37] offset:7488
    v_pk_fma_f32 v[40:41], v[140:141], v[124:125], v[40:41] op_sel_hi:[1,0,1] neg_lo:[0,1,0] neg_hi:[0,1,0]
    v_pk_fma_f32 v[42:43], v[142:143], v[124:125], v[42:43] op_sel_hi:[1,0,1] neg_lo:[0,1,0] neg_hi:[0,1,0]
    v_pk_mul_f32 v[40:41], v[40:41], v[124:125] op_sel:[0,1] op_sel_hi:[1,1]
    v_pk_mul_f32 v[42:43], v[42:43], v[124:125] op_sel:[0,1] op_sel_hi:[1,1]
    v_cvt_pk_bf16_f32 v40, v40, v41
    v_cvt_pk_bf16_f32 v41, v42, v43
    v_pk_max_i16 v40, v40, 0
    v_pk_max_i16 v41, v41, 0
    ds_write_b64 v118, v[40:41] offset:7552
    v_pk_fma_f32 v[44:45], v[144:145], v[124:125], v[44:45] op_sel_hi:[1,0,1] neg_lo:[0,1,0] neg_hi:[0,1,0]
    v_pk_fma_f32 v[46:47], v[146:147], v[124:125], v[46:47] op_sel_hi:[1,0,1] neg_lo:[0,1,0] neg_hi:[0,1,0]
    v_pk_mul_f32 v[44:45], v[44:45], v[124:125] op_sel:[0,1] op_sel_hi:[1,1]
    v_pk_mul_f32 v[46:47], v[46:47], v[124:125] op_sel:[0,1] op_sel_hi:[1,1]
    v_cvt_pk_bf16_f32 v44, v44, v45
    v_cvt_pk_bf16_f32 v45, v46, v47
    v_pk_max_i16 v44, v44, 0
    v_pk_max_i16 v45, v45, 0
    ds_write_b64 v118, v[44:45] offset:7616
    v_pk_fma_f32 v[48:49], v[148:149], v[124:125], v[48:49] op_sel_hi:[1,0,1] neg_lo:[0,1,0] neg_hi:[0,1,0]
    v_pk_fma_f32 v[50:51], v[150:151], v[124:125], v[50:51] op_sel_hi:[1,0,1] neg_lo:[0,1,0] neg_hi:[0,1,0]
    v_pk_mul_f32 v[48:49], v[48:49], v[124:125] op_sel:[0,1] op_sel_hi:[1,1]
    v_pk_mul_f32 v[50:51], v[50:51], v[124:125] op_sel:[0,1] op_sel_hi:[1,1]
    v_cvt_pk_bf16_f32 v48, v48, v49
    v_cvt_pk_bf16_f32 v49, v50, v51
    v_pk_max_i16 v48, v48, 0
    v_pk_max_i16 v49, v49, 0
    ds_write_b64 v118, v[48:49] offset:7680
    v_pk_fma_f32 v[52:53], v[152:153], v[124:125], v[52:53] op_sel_hi:[1,0,1] neg_lo:[0,1,0] neg_hi:[0,1,0]
    v_pk_fma_f32 v[54:55], v[154:155], v[124:125], v[54:55] op_sel_hi:[1,0,1] neg_lo:[0,1,0] neg_hi:[0,1,0]
    v_pk_mul_f32 v[52:53], v[52:53], v[124:125] op_sel:[0,1] op_sel_hi:[1,1]
    v_pk_mul_f32 v[54:55], v[54:55], v[124:125] op_sel:[0,1] op_sel_hi:[1,1]
    v_cvt_pk_bf16_f32 v52, v52, v53
    v_cvt_pk_bf16_f32 v53, v54, v55
    v_pk_max_i16 v52, v52, 0
    v_pk_max_i16 v53, v53, 0
    ds_write_b64 v118, v[52:53] offset:7744
    v_pk_fma_f32 v[56:57], v[156:157], v[124:125], v[56:57] op_sel_hi:[1,0,1] neg_lo:[0,1,0] neg_hi:[0,1,0]
    v_pk_fma_f32 v[58:59], v[158:159], v[124:125], v[58:59] op_sel_hi:[1,0,1] neg_lo:[0,1,0] neg_hi:[0,1,0]
    v_pk_mul_f32 v[56:57], v[56:57], v[124:125] op_sel:[0,1] op_sel_hi:[1,1]
    v_pk_mul_f32 v[58:59], v[58:59], v[124:125] op_sel:[0,1] op_sel_hi:[1,1]
    v_cvt_pk_bf16_f32 v56, v56, v57
    v_cvt_pk_bf16_f32 v57, v58, v59
    v_pk_max_i16 v56, v56, 0
    v_pk_max_i16 v57, v57, 0
    ds_write_b64 v118, v[56:57] offset:7808
    v_pk_fma_f32 v[60:61], v[132:133], v[126:127], v[60:61] op_sel_hi:[1,0,1] neg_lo:[0,1,0] neg_hi:[0,1,0]
    v_pk_fma_f32 v[62:63], v[134:135], v[126:127], v[62:63] op_sel_hi:[1,0,1] neg_lo:[0,1,0] neg_hi:[0,1,0]
    v_pk_mul_f32 v[60:61], v[60:61], v[126:127] op_sel:[0,1] op_sel_hi:[1,1]
    v_pk_mul_f32 v[62:63], v[62:63], v[126:127] op_sel:[0,1] op_sel_hi:[1,1]
    v_cvt_pk_bf16_f32 v60, v60, v61
    v_cvt_pk_bf16_f32 v61, v62, v63
    v_pk_max_i16 v60, v60, 0
    v_pk_max_i16 v61, v61, 0
    ds_write_b64 v118, v[60:61] offset:14848
    v_pk_fma_f32 v[64:65], v[136:137], v[126:127], v[64:65] op_sel_hi:[1,0,1] neg_lo:[0,1,0] neg_hi:[0,1,0]
    v_pk_fma_f32 v[66:67], v[138:139], v[126:127], v[66:67] op_sel_hi:[1,0,1] neg_lo:[0,1,0] neg_hi:[0,1,0]
    v_pk_mul_f32 v[64:65], v[64:65], v[126:127] op_sel:[0,1] op_sel_hi:[1,1]
    v_pk_mul_f32 v[66:67], v[66:67], v[126:127] op_sel:[0,1] op_sel_hi:[1,1]
    v_cvt_pk_bf16_f32 v64, v64, v65
    v_cvt_pk_bf16_f32 v65, v66, v67
    v_pk_max_i16 v64, v64, 0
    v_pk_max_i16 v65, v65, 0
    ds_write_b64 v118, v[64:65] offset:14912
    v_pk_fma_f32 v[68:69], v[140:141], v[126:127], v[68:69] op_sel_hi:[1,0,1] neg_lo:[0,1,0] neg_hi:[0,1,0]
    v_pk_fma_f32 v[70:71], v[142:143], v[126:127], v[70:71] op_sel_hi:[1,0,1] neg_lo:[0,1,0] neg_hi:[0,1,0]
    v_pk_mul_f32 v[68:69], v[68:69], v[126:127] op_sel:[0,1] op_sel_hi:[1,1]
    v_pk_mul_f32 v[70:71], v[70:71], v[126:127] op_sel:[0,1] op_sel_hi:[1,1]
    v_cvt_pk_bf16_f32 v68, v68, v69
    v_cvt_pk_bf16_f32 v69, v70, v71
    v_pk_max_i16 v68, v68, 0
    v_pk_max_i16 v69, v69, 0
    ds_write_b64 v118, v[68:69] offset:14976
    v_pk_fma_f32 v[72:73], v[144:145], v[126:127], v[72:73] op_sel_hi:[1,0,1] neg_lo:[0,1,0] neg_hi:[0,1,0]
    v_pk_fma_f32 v[74:75], v[146:147], v[126:127], v[74:75] op_sel_hi:[1,0,1] neg_lo:[0,1,0] neg_hi:[0,1,0]
    v_pk_mul_f32 v[72:73], v[72:73], v[126:127] op_sel:[0,1] op_sel_hi:[1,1]
    v_pk_mul_f32 v[74:75], v[74:75], v[126:127] op_sel:[0,1] op_sel_hi:[1,1]
    v_cvt_pk_bf16_f32 v72, v72, v73
    v_cvt_pk_bf16_f32 v73, v74, v75
    v_pk_max_i16 v72, v72, 0
    v_pk_max_i16 v73, v73, 0
    ds_write_b64 v118, v[72:73] offset:15040
    v_pk_fma_f32 v[76:77], v[148:149], v[126:127], v[76:77] op_sel_hi:[1,0,1] neg_lo:[0,1,0] neg_hi:[0,1,0]
    v_pk_fma_f32 v[78:79], v[150:151], v[126:127], v[78:79] op_sel_hi:[1,0,1] neg_lo:[0,1,0] neg_hi:[0,1,0]
    v_pk_mul_f32 v[76:77], v[76:77], v[126:127] op_sel:[0,1] op_sel_hi:[1,1]
    v_pk_mul_f32 v[78:79], v[78:79], v[126:127] op_sel:[0,1] op_sel_hi:[1,1]
    v_cvt_pk_bf16_f32 v76, v76, v77
    v_cvt_pk_bf16_f32 v77, v78, v79
    v_pk_max_i16 v76, v76, 0
    v_pk_max_i16 v77, v77, 0
    ds_write_b64 v118, v[76:77] offset:15104
    v_pk_fma_f32 v[80:81], v[152:153], v[126:127], v[80:81] op_sel_hi:[1,0,1] neg_lo:[0,1,0] neg_hi:[0,1,0]
    v_pk_fma_f32 v[82:83], v[154:155], v[126:127], v[82:83] op_sel_hi:[1,0,1] neg_lo:[0,1,0] neg_hi:[0,1,0]
    v_pk_mul_f32 v[80:81], v[80:81], v[126:127] op_sel:[0,1] op_sel_hi:[1,1]
    v_pk_mul_f32 v[82:83], v[82:83], v[126:127] op_sel:[0,1] op_sel_hi:[1,1]
    v_cvt_pk_bf16_f32 v80, v80, v81
    v_cvt_pk_bf16_f32 v81, v82, v83
    v_pk_max_i16 v80, v80, 0
    v_pk_max_i16 v81, v81, 0
    ds_write_b64 v118, v[80:81] offset:15168
    v_pk_fma_f32 v[84:85], v[156:157], v[126:127], v[84:85] op_sel_hi:[1,0,1] neg_lo:[0,1,0] neg_hi:[0,1,0]
    v_pk_fma_f32 v[86:87], v[158:159], v[126:127], v[86:87] op_sel_hi:[1,0,1] neg_lo:[0,1,0] neg_hi:[0,1,0]
    v_pk_mul_f32 v[84:85], v[84:85], v[126:127] op_sel:[0,1] op_sel_hi:[1,1]
    v_pk_mul_f32 v[86:87], v[86:87], v[126:127] op_sel:[0,1] op_sel_hi:[1,1]
    v_cvt_pk_bf16_f32 v84, v84, v85
    v_cvt_pk_bf16_f32 v85, v86, v87
    v_pk_max_i16 v84, v84, 0
    v_pk_max_i16 v85, v85, 0
    ds_write_b64 v118, v[84:85] offset:15232
    v_pk_fma_f32 v[88:89], v[132:133], v[128:129], v[88:89] op_sel_hi:[1,0,1] neg_lo:[0,1,0] neg_hi:[0,1,0]
    v_pk_fma_f32 v[90:91], v[134:135], v[128:129], v[90:91] op_sel_hi:[1,0,1] neg_lo:[0,1,0] neg_hi:[0,1,0]
    v_pk_mul_f32 v[88:89], v[88:89], v[128:129] op_sel:[0,1] op_sel_hi:[1,1]
    v_pk_mul_f32 v[90:91], v[90:91], v[128:129] op_sel:[0,1] op_sel_hi:[1,1]
    v_cvt_pk_bf16_f32 v88, v88, v89
    v_cvt_pk_bf16_f32 v89, v90, v91
    v_pk_max_i16 v88, v88, 0
    v_pk_max_i16 v89, v89, 0
    ds_write_b64 v118, v[88:89] offset:22272
    v_pk_fma_f32 v[92:93], v[136:137], v[128:129], v[92:93] op_sel_hi:[1,0,1] neg_lo:[0,1,0] neg_hi:[0,1,0]
    v_pk_fma_f32 v[94:95], v[138:139], v[128:129], v[94:95] op_sel_hi:[1,0,1] neg_lo:[0,1,0] neg_hi:[0,1,0]
    v_pk_mul_f32 v[92:93], v[92:93], v[128:129] op_sel:[0,1] op_sel_hi:[1,1]
    v_pk_mul_f32 v[94:95], v[94:95], v[128:129] op_sel:[0,1] op_sel_hi:[1,1]
    v_cvt_pk_bf16_f32 v92, v92, v93
    v_cvt_pk_bf16_f32 v93, v94, v95
    v_pk_max_i16 v92, v92, 0
    v_pk_max_i16 v93, v93, 0
    ds_write_b64 v118, v[92:93] offset:22336
    v_pk_fma_f32 v[96:97], v[140:141], v[128:129], v[96:97] op_sel_hi:[1,0,1] neg_lo:[0,1,0] neg_hi:[0,1,0]
    v_pk_fma_f32 v[98:99], v[142:143], v[128:129], v[98:99] op_sel_hi:[1,0,1] neg_lo:[0,1,0] neg_hi:[0,1,0]
    v_pk_mul_f32 v[96:97], v[96:97], v[128:129] op_sel:[0,1] op_sel_hi:[1,1]
    v_pk_mul_f32 v[98:99], v[98:99], v[128:129] op_sel:[0,1] op_sel_hi:[1,1]
    v_cvt_pk_bf16_f32 v96, v96, v97
    v_cvt_pk_bf16_f32 v97, v98, v99
    v_pk_max_i16 v96, v96, 0
    v_pk_max_i16 v97, v97, 0
    ds_write_b64 v118, v[96:97] offset:22400
    v_pk_fma_f32 v[100:101], v[144:145], v[128:129], v[100:101] op_sel_hi:[1,0,1] neg_lo:[0,1,0] neg_hi:[0,1,0]
    v_pk_fma_f32 v[102:103], v[146:147], v[128:129], v[102:103] op_sel_hi:[1,0,1] neg_lo:[0,1,0] neg_hi:[0,1,0]
    v_pk_mul_f32 v[100:101], v[100:101], v[128:129] op_sel:[0,1] op_sel_hi:[1,1]
    v_pk_mul_f32 v[102:103], v[102:103], v[128:129] op_sel:[0,1] op_sel_hi:[1,1]
    v_cvt_pk_bf16_f32 v100, v100, v101
    v_cvt_pk_bf16_f32 v101, v102, v103
    v_pk_max_i16 v100, v100, 0
    v_pk_max_i16 v101, v101, 0
    ds_write_b64 v118, v[100:101] offset:22464
    v_pk_fma_f32 v[104:105], v[148:149], v[128:129], v[104:105] op_sel_hi:[1,0,1] neg_lo:[0,1,0] neg_hi:[0,1,0]
    v_pk_fma_f32 v[106:107], v[150:151], v[128:129], v[106:107] op_sel_hi:[1,0,1] neg_lo:[0,1,0] neg_hi:[0,1,0]
    v_pk_mul_f32 v[104:105], v[104:105], v[128:129] op_sel:[0,1] op_sel_hi:[1,1]
    v_pk_mul_f32 v[106:107], v[106:107], v[128:129] op_sel:[0,1] op_sel_hi:[1,1]
    v_cvt_pk_bf16_f32 v104, v104, v105
    v_cvt_pk_bf16_f32 v105, v106, v107
    v_pk_max_i16 v104, v104, 0
    v_pk_max_i16 v105, v105, 0
    ds_write_b64 v118, v[104:105] offset:22528
    v_pk_fma_f32 v[108:109], v[152:153], v[128:129], v[108:109] op_sel_hi:[1,0,1] neg_lo:[0,1,0] neg_hi:[0,1,0]
    v_pk_fma_f32 v[110:111], v[154:155], v[128:129], v[110:111] op_sel_hi:[1,0,1] neg_lo:[0,1,0] neg_hi:[0,1,0]
    v_pk_mul_f32 v[108:109], v[108:109], v[128:129] op_sel:[0,1] op_sel_hi:[1,1]
    v_pk_mul_f32 v[110:111], v[110:111], v[128:129] op_sel:[0,1] op_sel_hi:[1,1]
    v_cvt_pk_bf16_f32 v108, v108, v109
    v_cvt_pk_bf16_f32 v109, v110, v111
    v_pk_max_i16 v108, v108, 0
    v_pk_max_i16 v109, v109, 0
    ds_write_b64 v118, v[108:109] offset:22592
    v_pk_fma_f32 v[112:113], v[156:157], v[128:129], v[112:113] op_sel_hi:[1,0,1] neg_lo:[0,1,0] neg_hi:[0,1,0]
    v_pk_fma_f32 v[114:115], v[158:159], v[128:129], v[114:115] op_sel_hi:[1,0,1] neg_lo:[0,1,0] neg_hi:[0,1,0]
    v_pk_mul_f32 v[112:113], v[112:113], v[128:129] op_sel:[0,1] op_sel_hi:[1,1]
    v_pk_mul_f32 v[114:115], v[114:115], v[128:129] op_sel:[0,1] op_sel_hi:[1,1]
    v_cvt_pk_bf16_f32 v112, v112, v113
    v_cvt_pk_bf16_f32 v113, v114, v115
    v_pk_max_i16 v112, v112, 0
    v_pk_max_i16 v113, v113, 0
    ds_write_b64 v118, v[112:113] offset:22656
    s_waitcnt lgkmcnt(0)
    s_barrier
    v_lshrrev_b32 v163, 2, v0
    v_and_b32 v162, 3, v0
    v_lshlrev_b32 v162, 4, v162
    s_mul_i32 s31, s28, 14848
    s_add_u32 s31, s31, 45056
    v_mul_u32_u24 v160, 464, v163
    v_add3_u32 v160, v160, v162, s31
    s_lshl_b32 s32, s28, 11
    v_lshl_add_u32 v161, v0, 4, s32
    ds_read_b128 v[4:7], v160 offset:0
    ds_read_b128 v[8:11], v160 offset:7424
    ds_read_b128 v[12:15], v160 offset:64
    ds_read_b128 v[16:19], v160 offset:7488
    ds_read_b128 v[20:23], v160 offset:128
    ds_read_b128 v[24:27], v160 offset:7552
    ds_read_b128 v[28:31], v160 offset:192
    ds_read_b128 v[32:35], v160 offset:7616
    ds_read_b128 v[36:39], v160 offset:256
    ds_read_b128 v[40:43], v160 offset:7680
    ds_read_b128 v[44:47], v160 offset:320
    ds_read_b128 v[48:51], v160 offset:7744
    ds_read_b128 v[52:55], v160 offset:384
    ds_read_b128 v[56:59], v160 offset:7808
    s_waitcnt lgkmcnt(13)
    s_mov_b32 s34, 0
    buffer_store_dwordx4 v[4:7], v161, s[16:19], s34 offen sc0 sc1
    s_waitcnt lgkmcnt(12)
    s_mov_b32 s34, 1024
    buffer_store_dwordx4 v[8:11], v161, s[16:19], s34 offen sc0 sc1
    s_waitcnt lgkmcnt(11)
    s_mov_b32 s34, 8192
    buffer_store_dwordx4 v[12:15], v161, s[16:19], s34 offen sc0 sc1
    s_waitcnt lgkmcnt(10)
    s_mov_b32 s34, 9216
    buffer_store_dwordx4 v[16:19], v161, s[16:19], s34 offen sc0 sc1
    s_waitcnt lgkmcnt(9)
    s_mov_b32 s34, 16384
    buffer_store_dwordx4 v[20:23], v161, s[16:19], s34 offen sc0 sc1
    s_waitcnt lgkmcnt(8)
    s_mov_b32 s34, 17408
    buffer_store_dwordx4 v[24:27], v161, s[16:19], s34 offen sc0 sc1
    s_waitcnt lgkmcnt(7)
    s_mov_b32 s34, 24576
    buffer_store_dwordx4 v[28:31], v161, s[16:19], s34 offen sc0 sc1
    s_waitcnt lgkmcnt(6)
    s_mov_b32 s34, 25600
    buffer_store_dwordx4 v[32:35], v161, s[16:19], s34 offen sc0 sc1
    s_waitcnt lgkmcnt(5)
    s_mov_b32 s34, 32768
    buffer_store_dwordx4 v[36:39], v161, s[16:19], s34 offen sc0 sc1
    s_waitcnt lgkmcnt(4)
    s_mov_b32 s34, 33792
    buffer_store_dwordx4 v[40:43], v161, s[16:19], s34 offen sc0 sc1
    s_waitcnt lgkmcnt(3)
    s_mov_b32 s34, 40960
    buffer_store_dwordx4 v[44:47], v161, s[16:19], s34 offen sc0 sc1
    s_waitcnt lgkmcnt(2)
    s_mov_b32 s34, 41984
    buffer_store_dwordx4 v[48:51], v161, s[16:19], s34 offen sc0 sc1
    s_waitcnt lgkmcnt(1)
    s_mov_b32 s34, 49152
    buffer_store_dwordx4 v[52:55], v161, s[16:19], s34 offen sc0 sc1
    s_waitcnt lgkmcnt(0)
    s_mov_b32 s34, 50176
    buffer_store_dwordx4 v[56:59], v161, s[16:19], s34 offen sc0 sc1
    s_barrier
    s_lshl_b32 s32, s29, 8
    s_lshl_b32 s33, s30, 4
    s_add_u32 s32, s32, s33
    s_lshl_b32 s33, s28, 2
    s_add_u32 s32, s32, s33
    s_add_u32 s32, s32, 32518144
    v_mov_b32 v163, 0x80000000
    v_mov_b32 v162, s32
    v_cmp_eq_u32 vcc, 0, v0
    s_nop 1
    v_cndmask_b32 v163, v163, v162, vcc
    v_mov_b32 v162, s65
    s_waitcnt vmcnt(0)
    buffer_store_dword v162, v163, s[24:27], 0 offen sc0 sc1
    s_and_b32 s31, s2, 7
    s_lshr_b32 s32, s2, 3
    s_lshr_b32 s68, s31, 2
    s_bfe_u32 s33, s31, 0x10001
    s_lshl_b32 s33, s33, 3
    s_lshr_b32 s29, s32, 2
    s_add_u32 s29, s29, s33
    s_and_b32 s33, s31, 1
    s_lshl_b32 s33, s33, 2
    s_and_b32 s30, s32, 3
    s_add_u32 s30, s30, s33
    s_mul_i32 s35, s29, 917504
    s_mul_i32 s36, s68, 458752
    s_add_u32 s35, s35, s36
    s_add_u32 s4, s62, s35
    s_addc_u32 s5, s63, 0
    s_add_u32 s4, s4, 12582912
    s_addc_u32 s5, s5, 0
    s_sub_u32 s6, 14680064, s35
    s_mov_b32 s7, 0x20000
    s_mul_i32 s35, s68, 3670016
    s_lshl_b32 s36, s30, 8
    s_add_u32 s35, s35, s36
    s_add_u32 s8, s56, s35
    s_addc_u32 s9, s57, 0
    s_sub_u32 s10, 7340032, s35
    s_mov_b32 s11, 0x20000
    s_lshr_b32 s42, s28, 1
    s_and_b32 s43, s28, 1
    s_lshl_b32 s35, s29, 18
    s_lshl_b32 s36, s68, 17
    s_add_u32 s35, s35, s36
    s_lshl_b32 s36, s30, 8
    s_add_u32 s35, s35, s36
    s_add_u32 s16, s58, s35
    s_addc_u32 s17, s59, 0
    s_sub_u32 s18, 4194304, s35
    s_mov_b32 s19, 0x20000
    s_lshl_b32 s35, s29, 18
    s_lshl_b32 s36, s30, 15
    s_add_u32 s35, s35, s36
    s_lshl_b32 s36, s68, 12
    s_add_u32 s35, s35, s36
    s_add_u32 s12, s62, s35
    s_addc_u32 s13, s63, 0
    s_add_u32 s12, s12, 8388608
    s_addc_u32 s13, s13, 0
    s_sub_u32 s14, 4194304, s35
    s_mov_b32 s15, 0x20000
    s_lshr_b32 s42, s28, 1
    s_and_b32 s43, s28, 1
    v_and_b32 v68, 15, v0
    v_lshrrev_b32 v69, 4, v0
    v_bfe_u32 v70, v0, 1, 3
    v_xor_b32 v70, v70, v69
    v_lshlrev_b32 v70, 4, v70
    v_lshl_add_u32 v70, v68, 7, v70
    s_mul_i32 s31, s42, 8192
    v_add_u32 v132, s31, v70
    v_xor_b32 v133, 64, v132
    v_add_u32 v134, 32768, v132
    v_add_u32 v135, 32768, v133
    v_add_u32 v136, 65536, v132
    v_add_u32 v137, 65536, v133
    v_add_u32 v138, 98304, v132
    v_add_u32 v139, 98304, v133
    v_bfe_u32 v70, v0, 1, 1
    s_lshl_b32 s31, s43, 1
    v_add_u32 v70, s31, v70
    v_and_b32 v71, 1, v69
    v_lshlrev_b32 v71, 1, v71
    v_xor_b32 v70, v70, v71
    v_lshlrev_b32 v70, 4, v70
    v_bfe_u32 v71, v0, 2, 2
    v_lshl_add_u32 v70, v71, 6, v70
    v_lshl_add_u32 v70, v69, 10, v70
    v_and_b32 v71, 1, v0
    v_lshl_add_u32 v140, v71, 3, v70
    v_add_u32 v141, 32768, v140
    v_add_u32 v142, 65536, v140
    v_add_u32 v143, 98304, v140
    v_mov_b32 v4, 0
    v_mov_b32 v5, 0
    v_mov_b32 v6, 0
    v_mov_b32 v7, 0
    v_mov_b32 v8, 0
    v_mov_b32 v9, 0
    v_mov_b32 v10, 0
    v_mov_b32 v11, 0
    v_mov_b32 v12, 0
    v_mov_b32 v13, 0
    v_mov_b32 v14, 0
    v_mov_b32 v15, 0
    v_mov_b32 v16, 0
    v_mov_b32 v17, 0
    v_mov_b32 v18, 0
    v_mov_b32 v19, 0
    v_mov_b32 v20, 0
    v_mov_b32 v21, 0
    v_mov_b32 v22, 0
    v_mov_b32 v23, 0
    v_mov_b32 v24, 0
    v_mov_b32 v25, 0
    v_mov_b32 v26, 0
    v_mov_b32 v27, 0
    v_mov_b32 v28, 0
    v_mov_b32 v29, 0
    v_mov_b32 v30, 0
    v_mov_b32 v31, 0
    v_mov_b32 v32, 0
    v_mov_b32 v33, 0
    v_mov_b32 v34, 0
    v_mov_b32 v35, 0
    v_mov_b32 v36, 0
    v_mov_b32 v37, 0
    v_mov_b32 v38, 0
    v_mov_b32 v39, 0
    v_mov_b32 v40, 0
    v_mov_b32 v41, 0
    v_mov_b32 v42, 0
    v_mov_b32 v43, 0
    v_mov_b32 v44, 0
    v_mov_b32 v45, 0
    v_mov_b32 v46, 0
    v_mov_b32 v47, 0
    v_mov_b32 v48, 0
    v_mov_b32 v49, 0
    v_mov_b32 v50, 0
    v_mov_b32 v51, 0
    v_mov_b32 v52, 0
    v_mov_b32 v53, 0
    v_mov_b32 v54, 0
    v_mov_b32 v55, 0
    v_mov_b32 v56, 0
    v_mov_b32 v57, 0
    v_mov_b32 v58, 0
    v_mov_b32 v59, 0
    v_mov_b32 v60, 0
    v_mov_b32 v61, 0
    v_mov_b32 v62, 0
    v_mov_b32 v63, 0
    v_mov_b32 v64, 0
    v_mov_b32 v65, 0
    v_mov_b32 v66, 0
    v_mov_b32 v67, 0
    s_lshl_b32 s31, s28, 6
    v_add_u32 v144, s31, v0
    v_lshrrev_b32 v145, 4, v144
    v_and_b32 v146, 15, v144
    v_lshrrev_b32 v147, 2, v146
    v_lshlrev_b32 v147, 13, v147
    v_lshl_add_u32 v147, v145, 6, v147
    v_and_b32 v68, 3, v146
    v_lshl_add_u32 v147, v68, 4, v147
    v_lshlrev_b32 v146, 4, v146
    v_mul_u32_u24 v68, 272, v145
    v_lshl_add_u32 v145, v145, 11, v146
    v_add_u32 v146, v146, v68
    s_barrier
    buffer_load_dwordx4 v[148:151], v147, s[12:15], 0 offen offset:0 sc0 sc1
    buffer_load_dwordx4 v[152:155], v147, s[12:15], 0 offen offset:1024 sc0 sc1
    buffer_load_dwordx4 v[156:159], v147, s[12:15], 0 offen offset:2048 sc0 sc1
    buffer_load_dwordx4 v[160:163], v147, s[12:15], 0 offen offset:3072 sc0 sc1
    ds_read_b128 v[68:71], v132 offset:0
    ds_read_b64_tr_b16 v[100:101], v140 offset:16384
    ds_read_b64_tr_b16 v[102:103], v140 offset:16896
    ds_read_b128 v[72:75], v132 offset:2048
    ds_read_b64_tr_b16 v[104:105], v140 offset:16640
    ds_read_b64_tr_b16 v[106:107], v140 offset:17152
    ds_read_b128 v[76:79], v132 offset:4096
    ds_read_b64_tr_b16 v[108:109], v140 offset:24576
    ds_read_b64_tr_b16 v[110:111], v140 offset:25088
    ds_read_b128 v[80:83], v132 offset:6144
    ds_read_b64_tr_b16 v[112:113], v140 offset:24832
    ds_read_b64_tr_b16 v[114:115], v140 offset:25344
    s_mov_b32 s38, 6
p4_cloop:
    s_waitcnt lgkmcnt(9)
    v_mfma_f32_16x16x32_bf16 v[4:7], v[100:103], v[68:71], v[4:7]
    ds_read_b128 v[84:87], v133 offset:0
    s_waitcnt lgkmcnt(7)
    v_mfma_f32_16x16x32_bf16 v[8:11], v[104:107], v[68:71], v[8:11]
    ds_read_b64_tr_b16 v[116:117], v140 offset:20480
    v_mfma_f32_16x16x32_bf16 v[20:23], v[100:103], v[72:75], v[20:23]
    ds_read_b64_tr_b16 v[118:119], v140 offset:20992
    v_mfma_f32_16x16x32_bf16 v[24:27], v[104:107], v[72:75], v[24:27]
    ds_read_b128 v[88:91], v133 offset:2048
    s_waitcnt lgkmcnt(7)
    v_mfma_f32_16x16x32_bf16 v[12:15], v[108:111], v[68:71], v[12:15]
    ds_read_b64_tr_b16 v[120:121], v140 offset:20736
    v_mfma_f32_16x16x32_bf16 v[36:39], v[100:103], v[76:79], v[36:39]
    ds_read_b64_tr_b16 v[122:123], v140 offset:21248
    v_mfma_f32_16x16x32_bf16 v[28:31], v[108:111], v[72:75], v[28:31]
    ds_read_b128 v[92:95], v133 offset:4096
    v_mfma_f32_16x16x32_bf16 v[40:43], v[104:107], v[76:79], v[40:43]
    ds_read_b64_tr_b16 v[124:125], v140 offset:28672
    v_mfma_f32_16x16x32_bf16 v[44:47], v[108:111], v[76:79], v[44:47]
    ds_read_b64_tr_b16 v[126:127], v140 offset:29184
    s_waitcnt lgkmcnt(9)
    v_mfma_f32_16x16x32_bf16 v[16:19], v[112:115], v[68:71], v[16:19]
    ds_read_b128 v[96:99], v133 offset:6144
    v_mfma_f32_16x16x32_bf16 v[52:55], v[100:103], v[80:83], v[52:55]
    ds_read_b64_tr_b16 v[128:129], v140 offset:28928
    v_mfma_f32_16x16x32_bf16 v[32:35], v[112:115], v[72:75], v[32:35]
    ds_read_b64_tr_b16 v[130:131], v140 offset:29440
    v_mfma_f32_16x16x32_bf16 v[56:59], v[104:107], v[80:83], v[56:59]
    v_mfma_f32_16x16x32_bf16 v[48:51], v[112:115], v[76:79], v[48:51]
    v_mfma_f32_16x16x32_bf16 v[60:63], v[108:111], v[80:83], v[60:63]
    v_mfma_f32_16x16x32_bf16 v[64:67], v[112:115], v[80:83], v[64:67]
    s_waitcnt lgkmcnt(9)
    v_mfma_f32_16x16x32_bf16 v[4:7], v[116:119], v[84:87], v[4:7]
    s_waitcnt lgkmcnt(0)
    s_barrier
    ds_read_b128 v[68:71], v134 offset:0
    v_mfma_f32_16x16x32_bf16 v[8:11], v[120:123], v[84:87], v[8:11]
    ds_read_b64_tr_b16 v[100:101], v141 offset:16384
    v_mfma_f32_16x16x32_bf16 v[20:23], v[116:119], v[88:91], v[20:23]
    ds_read_b64_tr_b16 v[102:103], v141 offset:16896
    v_mfma_f32_16x16x32_bf16 v[24:27], v[120:123], v[88:91], v[24:27]
    ds_read_b128 v[72:75], v134 offset:2048
    v_mfma_f32_16x16x32_bf16 v[12:15], v[124:127], v[84:87], v[12:15]
    ds_read_b64_tr_b16 v[104:105], v141 offset:16640
    v_mfma_f32_16x16x32_bf16 v[36:39], v[116:119], v[92:95], v[36:39]
    ds_read_b64_tr_b16 v[106:107], v141 offset:17152
    v_mfma_f32_16x16x32_bf16 v[28:31], v[124:127], v[88:91], v[28:31]
    ds_read_b128 v[76:79], v134 offset:4096
    v_mfma_f32_16x16x32_bf16 v[40:43], v[120:123], v[92:95], v[40:43]
    ds_read_b64_tr_b16 v[108:109], v141 offset:24576
    v_mfma_f32_16x16x32_bf16 v[44:47], v[124:127], v[92:95], v[44:47]
    ds_read_b64_tr_b16 v[110:111], v141 offset:25088
    v_mfma_f32_16x16x32_bf16 v[16:19], v[128:131], v[84:87], v[16:19]
    ds_read_b128 v[80:83], v134 offset:6144
    v_mfma_f32_16x16x32_bf16 v[52:55], v[116:119], v[96:99], v[52:55]
    ds_read_b64_tr_b16 v[112:113], v141 offset:24832
    v_mfma_f32_16x16x32_bf16 v[32:35], v[128:131], v[88:91], v[32:35]
    ds_read_b64_tr_b16 v[114:115], v141 offset:25344
    v_mfma_f32_16x16x32_bf16 v[56:59], v[120:123], v[96:99], v[56:59]
    v_mfma_f32_16x16x32_bf16 v[48:51], v[128:131], v[92:95], v[48:51]
    v_mfma_f32_16x16x32_bf16 v[60:63], v[124:127], v[96:99], v[60:63]
    v_mfma_f32_16x16x32_bf16 v[64:67], v[128:131], v[96:99], v[64:67]
    s_waitcnt lgkmcnt(9)
    v_mfma_f32_16x16x32_bf16 v[4:7], v[100:103], v[68:71], v[4:7]
    ds_read_b128 v[84:87], v135 offset:0
    s_waitcnt lgkmcnt(7)
    v_mfma_f32_16x16x32_bf16 v[8:11], v[104:107], v[68:71], v[8:11]
    ds_read_b64_tr_b16 v[116:117], v141 offset:20480
    v_mfma_f32_16x16x32_bf16 v[20:23], v[100:103], v[72:75], v[20:23]
    ds_read_b64_tr_b16 v[118:119], v141 offset:20992
    v_mfma_f32_16x16x32_bf16 v[24:27], v[104:107], v[72:75], v[24:27]
    ds_read_b128 v[88:91], v135 offset:2048
    s_waitcnt lgkmcnt(7)
    v_mfma_f32_16x16x32_bf16 v[12:15], v[108:111], v[68:71], v[12:15]
    ds_read_b64_tr_b16 v[120:121], v141 offset:20736
    v_mfma_f32_16x16x32_bf16 v[36:39], v[100:103], v[76:79], v[36:39]
    ds_read_b64_tr_b16 v[122:123], v141 offset:21248
    v_mfma_f32_16x16x32_bf16 v[28:31], v[108:111], v[72:75], v[28:31]
    ds_read_b128 v[92:95], v135 offset:4096
    v_mfma_f32_16x16x32_bf16 v[40:43], v[104:107], v[76:79], v[40:43]
    ds_read_b64_tr_b16 v[124:125], v141 offset:28672
    v_mfma_f32_16x16x32_bf16 v[44:47], v[108:111], v[76:79], v[44:47]
    ds_read_b64_tr_b16 v[126:127], v141 offset:29184
    s_waitcnt lgkmcnt(9)
    v_mfma_f32_16x16x32_bf16 v[16:19], v[112:115], v[68:71], v[16:19]
    ds_read_b128 v[96:99], v135 offset:6144
    v_mfma_f32_16x16x32_bf16 v[52:55], v[100:103], v[80:83], v[52:55]
    ds_read_b64_tr_b16 v[128:129], v141 offset:28928
    v_mfma_f32_16x16x32_bf16 v[32:35], v[112:115], v[72:75], v[32:35]
    ds_read_b64_tr_b16 v[130:131], v141 offset:29440
    v_mfma_f32_16x16x32_bf16 v[56:59], v[104:107], v[80:83], v[56:59]
    v_mfma_f32_16x16x32_bf16 v[48:51], v[112:115], v[76:79], v[48:51]
    v_mfma_f32_16x16x32_bf16 v[60:63], v[108:111], v[80:83], v[60:63]
    v_mfma_f32_16x16x32_bf16 v[64:67], v[112:115], v[80:83], v[64:67]
    s_waitcnt lgkmcnt(9)
    v_mfma_f32_16x16x32_bf16 v[4:7], v[116:119], v[84:87], v[4:7]
    s_waitcnt lgkmcnt(0)
    s_barrier
    ds_read_b128 v[68:71], v136 offset:0
    v_mfma_f32_16x16x32_bf16 v[8:11], v[120:123], v[84:87], v[8:11]
    ds_read_b64_tr_b16 v[100:101], v142 offset:16384
    v_mfma_f32_16x16x32_bf16 v[20:23], v[116:119], v[88:91], v[20:23]
    ds_read_b64_tr_b16 v[102:103], v142 offset:16896
    v_mfma_f32_16x16x32_bf16 v[24:27], v[120:123], v[88:91], v[24:27]
    ds_read_b128 v[72:75], v136 offset:2048
    v_mfma_f32_16x16x32_bf16 v[12:15], v[124:127], v[84:87], v[12:15]
    ds_read_b64_tr_b16 v[104:105], v142 offset:16640
    v_mfma_f32_16x16x32_bf16 v[36:39], v[116:119], v[92:95], v[36:39]
    ds_read_b64_tr_b16 v[106:107], v142 offset:17152
    v_mfma_f32_16x16x32_bf16 v[28:31], v[124:127], v[88:91], v[28:31]
    ds_read_b128 v[76:79], v136 offset:4096
    v_mfma_f32_16x16x32_bf16 v[40:43], v[120:123], v[92:95], v[40:43]
    ds_read_b64_tr_b16 v[108:109], v142 offset:24576
    v_mfma_f32_16x16x32_bf16 v[44:47], v[124:127], v[92:95], v[44:47]
    ds_read_b64_tr_b16 v[110:111], v142 offset:25088
    v_mfma_f32_16x16x32_bf16 v[16:19], v[128:131], v[84:87], v[16:19]
    ds_read_b128 v[80:83], v136 offset:6144
    v_mfma_f32_16x16x32_bf16 v[52:55], v[116:119], v[96:99], v[52:55]
    ds_read_b64_tr_b16 v[112:113], v142 offset:24832
    v_mfma_f32_16x16x32_bf16 v[32:35], v[128:131], v[88:91], v[32:35]
    ds_read_b64_tr_b16 v[114:115], v142 offset:25344
    v_mfma_f32_16x16x32_bf16 v[56:59], v[120:123], v[96:99], v[56:59]
    v_mfma_f32_16x16x32_bf16 v[48:51], v[128:131], v[92:95], v[48:51]
    v_mfma_f32_16x16x32_bf16 v[60:63], v[124:127], v[96:99], v[60:63]
    v_mfma_f32_16x16x32_bf16 v[64:67], v[128:131], v[96:99], v[64:67]
    s_waitcnt lgkmcnt(9)
    v_mfma_f32_16x16x32_bf16 v[4:7], v[100:103], v[68:71], v[4:7]
    ds_read_b128 v[84:87], v137 offset:0
    s_waitcnt lgkmcnt(7)
    v_mfma_f32_16x16x32_bf16 v[8:11], v[104:107], v[68:71], v[8:11]
    ds_read_b64_tr_b16 v[116:117], v142 offset:20480
    v_mfma_f32_16x16x32_bf16 v[20:23], v[100:103], v[72:75], v[20:23]
    ds_read_b64_tr_b16 v[118:119], v142 offset:20992
    v_mfma_f32_16x16x32_bf16 v[24:27], v[104:107], v[72:75], v[24:27]
    ds_read_b128 v[88:91], v137 offset:2048
    s_waitcnt lgkmcnt(7)
    v_mfma_f32_16x16x32_bf16 v[12:15], v[108:111], v[68:71], v[12:15]
    ds_read_b64_tr_b16 v[120:121], v142 offset:20736
    v_mfma_f32_16x16x32_bf16 v[36:39], v[100:103], v[76:79], v[36:39]
    ds_read_b64_tr_b16 v[122:123], v142 offset:21248
    v_mfma_f32_16x16x32_bf16 v[28:31], v[108:111], v[72:75], v[28:31]
    ds_read_b128 v[92:95], v137 offset:4096
    v_mfma_f32_16x16x32_bf16 v[40:43], v[104:107], v[76:79], v[40:43]
    ds_read_b64_tr_b16 v[124:125], v142 offset:28672
    v_mfma_f32_16x16x32_bf16 v[44:47], v[108:111], v[76:79], v[44:47]
    ds_read_b64_tr_b16 v[126:127], v142 offset:29184
    s_waitcnt lgkmcnt(9)
    v_mfma_f32_16x16x32_bf16 v[16:19], v[112:115], v[68:71], v[16:19]
    ds_read_b128 v[96:99], v137 offset:6144
    v_mfma_f32_16x16x32_bf16 v[52:55], v[100:103], v[80:83], v[52:55]
    ds_read_b64_tr_b16 v[128:129], v142 offset:28928
    v_mfma_f32_16x16x32_bf16 v[32:35], v[112:115], v[72:75], v[32:35]
    ds_read_b64_tr_b16 v[130:131], v142 offset:29440
    v_mfma_f32_16x16x32_bf16 v[56:59], v[104:107], v[80:83], v[56:59]
    v_mfma_f32_16x16x32_bf16 v[48:51], v[112:115], v[76:79], v[48:51]
    v_mfma_f32_16x16x32_bf16 v[60:63], v[108:111], v[80:83], v[60:63]
    v_mfma_f32_16x16x32_bf16 v[64:67], v[112:115], v[80:83], v[64:67]
    s_waitcnt lgkmcnt(9)
    v_mfma_f32_16x16x32_bf16 v[4:7], v[116:119], v[84:87], v[4:7]
    s_waitcnt lgkmcnt(0)
    s_barrier
    ds_read_b128 v[68:71], v138 offset:0
    v_mfma_f32_16x16x32_bf16 v[8:11], v[120:123], v[84:87], v[8:11]
    ds_read_b64_tr_b16 v[100:101], v143 offset:16384
    v_mfma_f32_16x16x32_bf16 v[20:23], v[116:119], v[88:91], v[20:23]
    ds_read_b64_tr_b16 v[102:103], v143 offset:16896
    v_mfma_f32_16x16x32_bf16 v[24:27], v[120:123], v[88:91], v[24:27]
    ds_read_b128 v[72:75], v138 offset:2048
    v_mfma_f32_16x16x32_bf16 v[12:15], v[124:127], v[84:87], v[12:15]
    ds_read_b64_tr_b16 v[104:105], v143 offset:16640
    v_mfma_f32_16x16x32_bf16 v[36:39], v[116:119], v[92:95], v[36:39]
    ds_read_b64_tr_b16 v[106:107], v143 offset:17152
    v_mfma_f32_16x16x32_bf16 v[28:31], v[124:127], v[88:91], v[28:31]
    ds_read_b128 v[76:79], v138 offset:4096
    v_mfma_f32_16x16x32_bf16 v[40:43], v[120:123], v[92:95], v[40:43]
    ds_read_b64_tr_b16 v[108:109], v143 offset:24576
    v_mfma_f32_16x16x32_bf16 v[44:47], v[124:127], v[92:95], v[44:47]
    ds_read_b64_tr_b16 v[110:111], v143 offset:25088
    v_mfma_f32_16x16x32_bf16 v[16:19], v[128:131], v[84:87], v[16:19]
    ds_read_b128 v[80:83], v138 offset:6144
    v_mfma_f32_16x16x32_bf16 v[52:55], v[116:119], v[96:99], v[52:55]
    ds_read_b64_tr_b16 v[112:113], v143 offset:24832
    v_mfma_f32_16x16x32_bf16 v[32:35], v[128:131], v[88:91], v[32:35]
    ds_read_b64_tr_b16 v[114:115], v143 offset:25344
    v_mfma_f32_16x16x32_bf16 v[56:59], v[120:123], v[96:99], v[56:59]
    v_mfma_f32_16x16x32_bf16 v[48:51], v[128:131], v[92:95], v[48:51]
    v_mfma_f32_16x16x32_bf16 v[60:63], v[124:127], v[96:99], v[60:63]
    v_mfma_f32_16x16x32_bf16 v[64:67], v[128:131], v[96:99], v[64:67]
    s_waitcnt lgkmcnt(9)
    v_mfma_f32_16x16x32_bf16 v[4:7], v[100:103], v[68:71], v[4:7]
    ds_read_b128 v[84:87], v139 offset:0
    s_waitcnt lgkmcnt(7)
    v_mfma_f32_16x16x32_bf16 v[8:11], v[104:107], v[68:71], v[8:11]
    ds_read_b64_tr_b16 v[116:117], v143 offset:20480
    v_mfma_f32_16x16x32_bf16 v[20:23], v[100:103], v[72:75], v[20:23]
    ds_read_b64_tr_b16 v[118:119], v143 offset:20992
    v_mfma_f32_16x16x32_bf16 v[24:27], v[104:107], v[72:75], v[24:27]
    ds_read_b128 v[88:91], v139 offset:2048
    s_waitcnt lgkmcnt(7)
    v_mfma_f32_16x16x32_bf16 v[12:15], v[108:111], v[68:71], v[12:15]
    ds_read_b64_tr_b16 v[120:121], v143 offset:20736
    v_mfma_f32_16x16x32_bf16 v[36:39], v[100:103], v[76:79], v[36:39]
    ds_read_b64_tr_b16 v[122:123], v143 offset:21248
    v_mfma_f32_16x16x32_bf16 v[28:31], v[108:111], v[72:75], v[28:31]
    ds_read_b128 v[92:95], v139 offset:4096
    v_mfma_f32_16x16x32_bf16 v[40:43], v[104:107], v[76:79], v[40:43]
    ds_read_b64_tr_b16 v[124:125], v143 offset:28672
    v_mfma_f32_16x16x32_bf16 v[44:47], v[108:111], v[76:79], v[44:47]
    ds_read_b64_tr_b16 v[126:127], v143 offset:29184
    s_waitcnt lgkmcnt(9)
    v_mfma_f32_16x16x32_bf16 v[16:19], v[112:115], v[68:71], v[16:19]
    ds_read_b128 v[96:99], v139 offset:6144
    v_mfma_f32_16x16x32_bf16 v[52:55], v[100:103], v[80:83], v[52:55]
    ds_read_b64_tr_b16 v[128:129], v143 offset:28928
    v_mfma_f32_16x16x32_bf16 v[32:35], v[112:115], v[72:75], v[32:35]
    ds_read_b64_tr_b16 v[130:131], v143 offset:29440
    v_mfma_f32_16x16x32_bf16 v[56:59], v[104:107], v[80:83], v[56:59]
    v_mfma_f32_16x16x32_bf16 v[48:51], v[112:115], v[76:79], v[48:51]
    v_mfma_f32_16x16x32_bf16 v[60:63], v[108:111], v[80:83], v[60:63]
    v_mfma_f32_16x16x32_bf16 v[64:67], v[112:115], v[80:83], v[64:67]
    s_waitcnt lgkmcnt(9)
    v_mfma_f32_16x16x32_bf16 v[4:7], v[116:119], v[84:87], v[4:7]
    s_waitcnt lgkmcnt(0)
    s_barrier
    ds_read_b128 v[68:71], v132 offset:0
    v_mfma_f32_16x16x32_bf16 v[8:11], v[120:123], v[84:87], v[8:11]
    ds_read_b64_tr_b16 v[100:101], v140 offset:16384
    v_mfma_f32_16x16x32_bf16 v[20:23], v[116:119], v[88:91], v[20:23]
    ds_read_b64_tr_b16 v[102:103], v140 offset:16896
    v_mfma_f32_16x16x32_bf16 v[24:27], v[120:123], v[88:91], v[24:27]
    ds_read_b128 v[72:75], v132 offset:2048
    v_mfma_f32_16x16x32_bf16 v[12:15], v[124:127], v[84:87], v[12:15]
    ds_read_b64_tr_b16 v[104:105], v140 offset:16640
    v_mfma_f32_16x16x32_bf16 v[36:39], v[116:119], v[92:95], v[36:39]
    ds_read_b64_tr_b16 v[106:107], v140 offset:17152
    v_mfma_f32_16x16x32_bf16 v[28:31], v[124:127], v[88:91], v[28:31]
    ds_read_b128 v[76:79], v132 offset:4096
    v_mfma_f32_16x16x32_bf16 v[40:43], v[120:123], v[92:95], v[40:43]
    ds_read_b64_tr_b16 v[108:109], v140 offset:24576
    v_mfma_f32_16x16x32_bf16 v[44:47], v[124:127], v[92:95], v[44:47]
    ds_read_b64_tr_b16 v[110:111], v140 offset:25088
    v_mfma_f32_16x16x32_bf16 v[16:19], v[128:131], v[84:87], v[16:19]
    ds_read_b128 v[80:83], v132 offset:6144
    v_mfma_f32_16x16x32_bf16 v[52:55], v[116:119], v[96:99], v[52:55]
    ds_read_b64_tr_b16 v[112:113], v140 offset:24832
    v_mfma_f32_16x16x32_bf16 v[32:35], v[128:131], v[88:91], v[32:35]
    ds_read_b64_tr_b16 v[114:115], v140 offset:25344
    v_mfma_f32_16x16x32_bf16 v[56:59], v[120:123], v[96:99], v[56:59]
    v_mfma_f32_16x16x32_bf16 v[48:51], v[128:131], v[92:95], v[48:51]
    v_mfma_f32_16x16x32_bf16 v[60:63], v[124:127], v[96:99], v[60:63]
    v_mfma_f32_16x16x32_bf16 v[64:67], v[128:131], v[96:99], v[64:67]
    s_sub_u32 s38, s38, 1
    s_cmp_lg_u32 s38, 0
    s_cbranch_scc1 p4_cloop
    s_waitcnt lgkmcnt(9)
    v_mfma_f32_16x16x32_bf16 v[4:7], v[100:103], v[68:71], v[4:7]
    ds_read_b128 v[84:87], v133 offset:0
    s_waitcnt lgkmcnt(7)
    v_mfma_f32_16x16x32_bf16 v[8:11], v[104:107], v[68:71], v[8:11]
    ds_read_b64_tr_b16 v[116:117], v140 offset:20480
    v_mfma_f32_16x16x32_bf16 v[20:23], v[100:103], v[72:75], v[20:23]
    ds_read_b64_tr_b16 v[118:119], v140 offset:20992
    v_mfma_f32_16x16x32_bf16 v[24:27], v[104:107], v[72:75], v[24:27]
    ds_read_b128 v[88:91], v133 offset:2048
    s_waitcnt lgkmcnt(7)
    v_mfma_f32_16x16x32_bf16 v[12:15], v[108:111], v[68:71], v[12:15]
    ds_read_b64_tr_b16 v[120:121], v140 offset:20736
    v_mfma_f32_16x16x32_bf16 v[36:39], v[100:103], v[76:79], v[36:39]
    ds_read_b64_tr_b16 v[122:123], v140 offset:21248
    v_mfma_f32_16x16x32_bf16 v[28:31], v[108:111], v[72:75], v[28:31]
    ds_read_b128 v[92:95], v133 offset:4096
    v_mfma_f32_16x16x32_bf16 v[40:43], v[104:107], v[76:79], v[40:43]
    ds_read_b64_tr_b16 v[124:125], v140 offset:28672
    v_mfma_f32_16x16x32_bf16 v[44:47], v[108:111], v[76:79], v[44:47]
    ds_read_b64_tr_b16 v[126:127], v140 offset:29184
    s_waitcnt lgkmcnt(9)
    v_mfma_f32_16x16x32_bf16 v[16:19], v[112:115], v[68:71], v[16:19]
    ds_read_b128 v[96:99], v133 offset:6144
    v_mfma_f32_16x16x32_bf16 v[52:55], v[100:103], v[80:83], v[52:55]
    ds_read_b64_tr_b16 v[128:129], v140 offset:28928
    v_mfma_f32_16x16x32_bf16 v[32:35], v[112:115], v[72:75], v[32:35]
    ds_read_b64_tr_b16 v[130:131], v140 offset:29440
    v_mfma_f32_16x16x32_bf16 v[56:59], v[104:107], v[80:83], v[56:59]
    v_mfma_f32_16x16x32_bf16 v[48:51], v[112:115], v[76:79], v[48:51]
    v_mfma_f32_16x16x32_bf16 v[60:63], v[108:111], v[80:83], v[60:63]
    v_mfma_f32_16x16x32_bf16 v[64:67], v[112:115], v[80:83], v[64:67]
    s_waitcnt lgkmcnt(9)
    v_mfma_f32_16x16x32_bf16 v[4:7], v[116:119], v[84:87], v[4:7]
    s_waitcnt lgkmcnt(0)
    s_barrier
    ds_read_b128 v[68:71], v134 offset:0
    v_mfma_f32_16x16x32_bf16 v[8:11], v[120:123], v[84:87], v[8:11]
    ds_read_b64_tr_b16 v[100:101], v141 offset:16384
    v_mfma_f32_16x16x32_bf16 v[20:23], v[116:119], v[88:91], v[20:23]
    ds_read_b64_tr_b16 v[102:103], v141 offset:16896
    v_mfma_f32_16x16x32_bf16 v[24:27], v[120:123], v[88:91], v[24:27]
    ds_read_b128 v[72:75], v134 offset:2048
    v_mfma_f32_16x16x32_bf16 v[12:15], v[124:127], v[84:87], v[12:15]
    ds_read_b64_tr_b16 v[104:105], v141 offset:16640
    v_mfma_f32_16x16x32_bf16 v[36:39], v[116:119], v[92:95], v[36:39]
    ds_read_b64_tr_b16 v[106:107], v141 offset:17152
    v_mfma_f32_16x16x32_bf16 v[28:31], v[124:127], v[88:91], v[28:31]
    ds_read_b128 v[76:79], v134 offset:4096
    v_mfma_f32_16x16x32_bf16 v[40:43], v[120:123], v[92:95], v[40:43]
    ds_read_b64_tr_b16 v[108:109], v141 offset:24576
    v_mfma_f32_16x16x32_bf16 v[44:47], v[124:127], v[92:95], v[44:47]
    ds_read_b64_tr_b16 v[110:111], v141 offset:25088
    v_mfma_f32_16x16x32_bf16 v[16:19], v[128:131], v[84:87], v[16:19]
    ds_read_b128 v[80:83], v134 offset:6144
    v_mfma_f32_16x16x32_bf16 v[52:55], v[116:119], v[96:99], v[52:55]
    ds_read_b64_tr_b16 v[112:113], v141 offset:24832
    v_mfma_f32_16x16x32_bf16 v[32:35], v[128:131], v[88:91], v[32:35]
    ds_read_b64_tr_b16 v[114:115], v141 offset:25344
    v_mfma_f32_16x16x32_bf16 v[56:59], v[120:123], v[96:99], v[56:59]
    v_mfma_f32_16x16x32_bf16 v[48:51], v[128:131], v[92:95], v[48:51]
    v_mfma_f32_16x16x32_bf16 v[60:63], v[124:127], v[96:99], v[60:63]
    v_mfma_f32_16x16x32_bf16 v[64:67], v[128:131], v[96:99], v[64:67]
    s_waitcnt lgkmcnt(9)
    v_mfma_f32_16x16x32_bf16 v[4:7], v[100:103], v[68:71], v[4:7]
    ds_read_b128 v[84:87], v135 offset:0
    s_waitcnt lgkmcnt(7)
    v_mfma_f32_16x16x32_bf16 v[8:11], v[104:107], v[68:71], v[8:11]
    ds_read_b64_tr_b16 v[116:117], v141 offset:20480
    v_mfma_f32_16x16x32_bf16 v[20:23], v[100:103], v[72:75], v[20:23]
    ds_read_b64_tr_b16 v[118:119], v141 offset:20992
    v_mfma_f32_16x16x32_bf16 v[24:27], v[104:107], v[72:75], v[24:27]
    ds_read_b128 v[88:91], v135 offset:2048
    s_waitcnt lgkmcnt(7)
    v_mfma_f32_16x16x32_bf16 v[12:15], v[108:111], v[68:71], v[12:15]
    ds_read_b64_tr_b16 v[120:121], v141 offset:20736
    v_mfma_f32_16x16x32_bf16 v[36:39], v[100:103], v[76:79], v[36:39]
    ds_read_b64_tr_b16 v[122:123], v141 offset:21248
    v_mfma_f32_16x16x32_bf16 v[28:31], v[108:111], v[72:75], v[28:31]
    ds_read_b128 v[92:95], v135 offset:4096
    v_mfma_f32_16x16x32_bf16 v[40:43], v[104:107], v[76:79], v[40:43]
    ds_read_b64_tr_b16 v[124:125], v141 offset:28672
    v_mfma_f32_16x16x32_bf16 v[44:47], v[108:111], v[76:79], v[44:47]
    ds_read_b64_tr_b16 v[126:127], v141 offset:29184
    s_waitcnt lgkmcnt(9)
    v_mfma_f32_16x16x32_bf16 v[16:19], v[112:115], v[68:71], v[16:19]
    ds_read_b128 v[96:99], v135 offset:6144
    v_mfma_f32_16x16x32_bf16 v[52:55], v[100:103], v[80:83], v[52:55]
    ds_read_b64_tr_b16 v[128:129], v141 offset:28928
    v_mfma_f32_16x16x32_bf16 v[32:35], v[112:115], v[72:75], v[32:35]
    ds_read_b64_tr_b16 v[130:131], v141 offset:29440
    v_mfma_f32_16x16x32_bf16 v[56:59], v[104:107], v[80:83], v[56:59]
    v_mfma_f32_16x16x32_bf16 v[48:51], v[112:115], v[76:79], v[48:51]
    v_mfma_f32_16x16x32_bf16 v[60:63], v[108:111], v[80:83], v[60:63]
    v_mfma_f32_16x16x32_bf16 v[64:67], v[112:115], v[80:83], v[64:67]
    s_waitcnt lgkmcnt(9)
    v_mfma_f32_16x16x32_bf16 v[4:7], v[116:119], v[84:87], v[4:7]
    s_waitcnt lgkmcnt(0)
    s_barrier
    ds_read_b128 v[68:71], v136 offset:0
    v_mfma_f32_16x16x32_bf16 v[8:11], v[120:123], v[84:87], v[8:11]
    ds_read_b64_tr_b16 v[100:101], v142 offset:16384
    v_mfma_f32_16x16x32_bf16 v[20:23], v[116:119], v[88:91], v[20:23]
    ds_read_b64_tr_b16 v[102:103], v142 offset:16896
    v_mfma_f32_16x16x32_bf16 v[24:27], v[120:123], v[88:91], v[24:27]
    ds_read_b128 v[72:75], v136 offset:2048
    v_mfma_f32_16x16x32_bf16 v[12:15], v[124:127], v[84:87], v[12:15]
    ds_read_b64_tr_b16 v[104:105], v142 offset:16640
    v_mfma_f32_16x16x32_bf16 v[36:39], v[116:119], v[92:95], v[36:39]
    ds_read_b64_tr_b16 v[106:107], v142 offset:17152
    v_mfma_f32_16x16x32_bf16 v[28:31], v[124:127], v[88:91], v[28:31]
    ds_read_b128 v[76:79], v136 offset:4096
    v_mfma_f32_16x16x32_bf16 v[40:43], v[120:123], v[92:95], v[40:43]
    ds_read_b64_tr_b16 v[108:109], v142 offset:24576
    v_mfma_f32_16x16x32_bf16 v[44:47], v[124:127], v[92:95], v[44:47]
    ds_read_b64_tr_b16 v[110:111], v142 offset:25088
    v_mfma_f32_16x16x32_bf16 v[16:19], v[128:131], v[84:87], v[16:19]
    ds_read_b128 v[80:83], v136 offset:6144
    v_mfma_f32_16x16x32_bf16 v[52:55], v[116:119], v[96:99], v[52:55]
    ds_read_b64_tr_b16 v[112:113], v142 offset:24832
    v_mfma_f32_16x16x32_bf16 v[32:35], v[128:131], v[88:91], v[32:35]
    ds_read_b64_tr_b16 v[114:115], v142 offset:25344
    v_mfma_f32_16x16x32_bf16 v[56:59], v[120:123], v[96:99], v[56:59]
    v_mfma_f32_16x16x32_bf16 v[48:51], v[128:131], v[92:95], v[48:51]
    v_mfma_f32_16x16x32_bf16 v[60:63], v[124:127], v[96:99], v[60:63]
    v_mfma_f32_16x16x32_bf16 v[64:67], v[128:131], v[96:99], v[64:67]
    s_waitcnt lgkmcnt(9)
    v_mfma_f32_16x16x32_bf16 v[4:7], v[100:103], v[68:71], v[4:7]
    ds_read_b128 v[84:87], v137 offset:0
    s_waitcnt lgkmcnt(7)
    v_mfma_f32_16x16x32_bf16 v[8:11], v[104:107], v[68:71], v[8:11]
    ds_read_b64_tr_b16 v[116:117], v142 offset:20480
    v_mfma_f32_16x16x32_bf16 v[20:23], v[100:103], v[72:75], v[20:23]
    ds_read_b64_tr_b16 v[118:119], v142 offset:20992
    v_mfma_f32_16x16x32_bf16 v[24:27], v[104:107], v[72:75], v[24:27]
    ds_read_b128 v[88:91], v137 offset:2048
    s_waitcnt lgkmcnt(7)
    v_mfma_f32_16x16x32_bf16 v[12:15], v[108:111], v[68:71], v[12:15]
    ds_read_b64_tr_b16 v[120:121], v142 offset:20736
    v_mfma_f32_16x16x32_bf16 v[36:39], v[100:103], v[76:79], v[36:39]
    ds_read_b64_tr_b16 v[122:123], v142 offset:21248
    v_mfma_f32_16x16x32_bf16 v[28:31], v[108:111], v[72:75], v[28:31]
    ds_read_b128 v[92:95], v137 offset:4096
    v_mfma_f32_16x16x32_bf16 v[40:43], v[104:107], v[76:79], v[40:43]
    ds_read_b64_tr_b16 v[124:125], v142 offset:28672
    v_mfma_f32_16x16x32_bf16 v[44:47], v[108:111], v[76:79], v[44:47]
    ds_read_b64_tr_b16 v[126:127], v142 offset:29184
    s_waitcnt lgkmcnt(9)
    v_mfma_f32_16x16x32_bf16 v[16:19], v[112:115], v[68:71], v[16:19]
    ds_read_b128 v[96:99], v137 offset:6144
    v_mfma_f32_16x16x32_bf16 v[52:55], v[100:103], v[80:83], v[52:55]
    ds_read_b64_tr_b16 v[128:129], v142 offset:28928
    v_mfma_f32_16x16x32_bf16 v[32:35], v[112:115], v[72:75], v[32:35]
    ds_read_b64_tr_b16 v[130:131], v142 offset:29440
    v_mfma_f32_16x16x32_bf16 v[56:59], v[104:107], v[80:83], v[56:59]
    v_mfma_f32_16x16x32_bf16 v[48:51], v[112:115], v[76:79], v[48:51]
    v_mfma_f32_16x16x32_bf16 v[60:63], v[108:111], v[80:83], v[60:63]
    v_mfma_f32_16x16x32_bf16 v[64:67], v[112:115], v[80:83], v[64:67]
    s_waitcnt lgkmcnt(9)
    v_mfma_f32_16x16x32_bf16 v[4:7], v[116:119], v[84:87], v[4:7]
    s_waitcnt lgkmcnt(0)
    s_barrier
    ds_read_b128 v[68:71], v138 offset:0
    v_mfma_f32_16x16x32_bf16 v[8:11], v[120:123], v[84:87], v[8:11]
    ds_read_b64_tr_b16 v[100:101], v143 offset:16384
    v_mfma_f32_16x16x32_bf16 v[20:23], v[116:119], v[88:91], v[20:23]
    ds_read_b64_tr_b16 v[102:103], v143 offset:16896
    v_mfma_f32_16x16x32_bf16 v[24:27], v[120:123], v[88:91], v[24:27]
    ds_read_b128 v[72:75], v138 offset:2048
    v_mfma_f32_16x16x32_bf16 v[12:15], v[124:127], v[84:87], v[12:15]
    ds_read_b64_tr_b16 v[104:105], v143 offset:16640
    v_mfma_f32_16x16x32_bf16 v[36:39], v[116:119], v[92:95], v[36:39]
    ds_read_b64_tr_b16 v[106:107], v143 offset:17152
    v_mfma_f32_16x16x32_bf16 v[28:31], v[124:127], v[88:91], v[28:31]
    ds_read_b128 v[76:79], v138 offset:4096
    v_mfma_f32_16x16x32_bf16 v[40:43], v[120:123], v[92:95], v[40:43]
    ds_read_b64_tr_b16 v[108:109], v143 offset:24576
    v_mfma_f32_16x16x32_bf16 v[44:47], v[124:127], v[92:95], v[44:47]
    ds_read_b64_tr_b16 v[110:111], v143 offset:25088
    v_mfma_f32_16x16x32_bf16 v[16:19], v[128:131], v[84:87], v[16:19]
    ds_read_b128 v[80:83], v138 offset:6144
    v_mfma_f32_16x16x32_bf16 v[52:55], v[116:119], v[96:99], v[52:55]
    ds_read_b64_tr_b16 v[112:113], v143 offset:24832
    v_mfma_f32_16x16x32_bf16 v[32:35], v[128:131], v[88:91], v[32:35]
    ds_read_b64_tr_b16 v[114:115], v143 offset:25344
    v_mfma_f32_16x16x32_bf16 v[56:59], v[120:123], v[96:99], v[56:59]
    v_mfma_f32_16x16x32_bf16 v[48:51], v[128:131], v[92:95], v[48:51]
    v_mfma_f32_16x16x32_bf16 v[60:63], v[124:127], v[96:99], v[60:63]
    v_mfma_f32_16x16x32_bf16 v[64:67], v[128:131], v[96:99], v[64:67]
    s_waitcnt lgkmcnt(9)
    v_mfma_f32_16x16x32_bf16 v[4:7], v[100:103], v[68:71], v[4:7]
    ds_read_b128 v[84:87], v139 offset:0
    s_waitcnt lgkmcnt(7)
    v_mfma_f32_16x16x32_bf16 v[8:11], v[104:107], v[68:71], v[8:11]
    ds_read_b64_tr_b16 v[116:117], v143 offset:20480
    v_mfma_f32_16x16x32_bf16 v[20:23], v[100:103], v[72:75], v[20:23]
    ds_read_b64_tr_b16 v[118:119], v143 offset:20992
    v_mfma_f32_16x16x32_bf16 v[24:27], v[104:107], v[72:75], v[24:27]
    ds_read_b128 v[88:91], v139 offset:2048
    s_waitcnt lgkmcnt(7)
    v_mfma_f32_16x16x32_bf16 v[12:15], v[108:111], v[68:71], v[12:15]
    ds_read_b64_tr_b16 v[120:121], v143 offset:20736
    v_mfma_f32_16x16x32_bf16 v[36:39], v[100:103], v[76:79], v[36:39]
    ds_read_b64_tr_b16 v[122:123], v143 offset:21248
    v_mfma_f32_16x16x32_bf16 v[28:31], v[108:111], v[72:75], v[28:31]
    ds_read_b128 v[92:95], v139 offset:4096
    v_mfma_f32_16x16x32_bf16 v[40:43], v[104:107], v[76:79], v[40:43]
    ds_read_b64_tr_b16 v[124:125], v143 offset:28672
    v_mfma_f32_16x16x32_bf16 v[44:47], v[108:111], v[76:79], v[44:47]
    ds_read_b64_tr_b16 v[126:127], v143 offset:29184
    s_waitcnt lgkmcnt(9)
    v_mfma_f32_16x16x32_bf16 v[16:19], v[112:115], v[68:71], v[16:19]
    ds_read_b128 v[96:99], v139 offset:6144
    v_mfma_f32_16x16x32_bf16 v[52:55], v[100:103], v[80:83], v[52:55]
    ds_read_b64_tr_b16 v[128:129], v143 offset:28928
    v_mfma_f32_16x16x32_bf16 v[32:35], v[112:115], v[72:75], v[32:35]
    ds_read_b64_tr_b16 v[130:131], v143 offset:29440
    v_mfma_f32_16x16x32_bf16 v[56:59], v[104:107], v[80:83], v[56:59]
    v_mfma_f32_16x16x32_bf16 v[48:51], v[112:115], v[76:79], v[48:51]
    v_mfma_f32_16x16x32_bf16 v[60:63], v[108:111], v[80:83], v[60:63]
    v_mfma_f32_16x16x32_bf16 v[64:67], v[112:115], v[80:83], v[64:67]
    s_waitcnt lgkmcnt(9)
    v_mfma_f32_16x16x32_bf16 v[4:7], v[116:119], v[84:87], v[4:7]
    s_waitcnt lgkmcnt(6)
    v_mfma_f32_16x16x32_bf16 v[8:11], v[120:123], v[84:87], v[8:11]
    v_mfma_f32_16x16x32_bf16 v[20:23], v[116:119], v[88:91], v[20:23]
    v_mfma_f32_16x16x32_bf16 v[24:27], v[120:123], v[88:91], v[24:27]
    s_waitcnt lgkmcnt(3)
    v_mfma_f32_16x16x32_bf16 v[12:15], v[124:127], v[84:87], v[12:15]
    v_mfma_f32_16x16x32_bf16 v[36:39], v[116:119], v[92:95], v[36:39]
    v_mfma_f32_16x16x32_bf16 v[28:31], v[124:127], v[88:91], v[28:31]
    v_mfma_f32_16x16x32_bf16 v[40:43], v[120:123], v[92:95], v[40:43]
    v_mfma_f32_16x16x32_bf16 v[44:47], v[124:127], v[92:95], v[44:47]
    s_waitcnt lgkmcnt(0)
    v_mfma_f32_16x16x32_bf16 v[16:19], v[128:131], v[84:87], v[16:19]
    v_mfma_f32_16x16x32_bf16 v[52:55], v[116:119], v[96:99], v[52:55]
    v_mfma_f32_16x16x32_bf16 v[32:35], v[128:131], v[88:91], v[32:35]
    v_mfma_f32_16x16x32_bf16 v[56:59], v[120:123], v[96:99], v[56:59]
    v_mfma_f32_16x16x32_bf16 v[48:51], v[128:131], v[92:95], v[48:51]
    v_mfma_f32_16x16x32_bf16 v[60:63], v[124:127], v[96:99], v[60:63]
    v_mfma_f32_16x16x32_bf16 v[64:67], v[128:131], v[96:99], v[64:67]
    s_lshl_b32 s31, s29, 3
    s_add_u32 s31, s31, s30
    s_lshl_b32 s31, s31, 2
    s_add_u32 s31, s31, s43
    s_cmp_eq_u32 s42, s68
    s_cbranch_scc1 keep_1013
    s_lshl_b32 s32, s68, 1
    s_add_u32 s31, s31, s32
    s_lshl_b32 s32, s31, 14
    s_add_u32 s32, s32, 46137344
    v_lshl_add_u32 v164, v0, 4, s32
    s_mov_b32 s33, 0
    buffer_store_dwordx4 v[4:7], v164, s[24:27], s33 offen sc0 sc1
    s_mov_b32 s33, 1024
    buffer_store_dwordx4 v[8:11], v164, s[24:27], s33 offen sc0 sc1
    s_mov_b32 s33, 2048
    buffer_store_dwordx4 v[12:15], v164, s[24:27], s33 offen sc0 sc1
    s_mov_b32 s33, 3072
    buffer_store_dwordx4 v[16:19], v164, s[24:27], s33 offen sc0 sc1
    s_mov_b32 s33, 4096
    buffer_store_dwordx4 v[20:23], v164, s[24:27], s33 offen sc0 sc1
    s_mov_b32 s33, 5120
    buffer_store_dwordx4 v[24:27], v164, s[24:27], s33 offen sc0 sc1
    s_mov_b32 s33, 6144
    buffer_store_dwordx4 v[28:31], v164, s[24:27], s33 offen sc0 sc1
    s_mov_b32 s33, 7168
    buffer_store_dwordx4 v[32:35], v164, s[24:27], s33 offen sc0 sc1
    s_mov_b32 s33, 8192
    buffer_store_dwordx4 v[36:39], v164, s[24:27], s33 offen sc0 sc1
    s_mov_b32 s33, 9216
    buffer_store_dwordx4 v[40:43], v164, s[24:27], s33 offen sc0 sc1
    s_mov_b32 s33, 10240
    buffer_store_dwordx4 v[44:47], v164, s[24:27], s33 offen sc0 sc1
    s_mov_b32 s33, 11264
    buffer_store_dwordx4 v[48:51], v164, s[24:27], s33 offen sc0 sc1
    s_mov_b32 s33, 12288
    buffer_store_dwordx4 v[52:55], v164, s[24:27], s33 offen sc0 sc1
    s_mov_b32 s33, 13312
    buffer_store_dwordx4 v[56:59], v164, s[24:27], s33 offen sc0 sc1
    s_mov_b32 s33, 14336
    buffer_store_dwordx4 v[60:63], v164, s[24:27], s33 offen sc0 sc1
    s_mov_b32 s33, 15360
    buffer_store_dwordx4 v[64:67], v164, s[24:27], s33 offen sc0 sc1
    s_lshl_b32 s32, s31, 7
    s_add_u32 s32, s32, 32522240
    v_mov_b32 v165, 0x80000000
    v_mov_b32 v166, s32
    v_cmp_eq_u32 vcc, 0, v0
    s_nop 1
    v_cndmask_b32 v165, v165, v166, vcc
    v_mov_b32 v166, s65
    s_waitcnt vmcnt(0)
    buffer_store_dword v166, v165, s[24:27], 0 offen sc0 sc1
    s_branch join_1014
keep_1013:
    s_xor_b32 s32, s68, 1
    s_lshl_b32 s32, s32, 1
    s_add_u32 s31, s31, s32
    s_lshl_b32 s32, s31, 14
    s_add_u32 s32, s32, 46137344
    v_lshl_add_u32 v164, v0, 4, s32
    s_lshl_b32 s32, s31, 7
    s_add_u32 s32, s32, 32522240
    s_mov_b32 s79, 40000
    v_and_b32 v165, 0, v0
    v_lshl_add_u32 v165, v165, 2, s32
poll_1015:
    buffer_load_dword v166, v165, s[24:27], 0 offen sc0 sc1
    s_waitcnt vmcnt(0)
    v_cmp_ne_u32 vcc, s65, v166
    s_nop 2
    s_cmp_eq_u64 vcc, 0
    s_cbranch_scc1 poll_1015_ok
    s_sleep 6
    s_sub_u32 s79, s79, 1
    s_cmp_lg_u32 s79, 0
    s_cbranch_scc1 poll_1015
poll_1015_ok:
    s_mov_b32 s33, 0
    buffer_load_dwordx4 v[68:71], v164, s[24:27], s33 offen sc0 sc1
    s_mov_b32 s33, 1024
    buffer_load_dwordx4 v[72:75], v164, s[24:27], s33 offen sc0 sc1
    s_mov_b32 s33, 2048
    buffer_load_dwordx4 v[76:79], v164, s[24:27], s33 offen sc0 sc1
    s_mov_b32 s33, 3072
    buffer_load_dwordx4 v[80:83], v164, s[24:27], s33 offen sc0 sc1
    s_mov_b32 s33, 4096
    buffer_load_dwordx4 v[84:87], v164, s[24:27], s33 offen sc0 sc1
    s_mov_b32 s33, 5120
    buffer_load_dwordx4 v[88:91], v164, s[24:27], s33 offen sc0 sc1
    s_mov_b32 s33, 6144
    buffer_load_dwordx4 v[92:95], v164, s[24:27], s33 offen sc0 sc1
    s_mov_b32 s33, 7168
    buffer_load_dwordx4 v[96:99], v164, s[24:27], s33 offen sc0 sc1
    s_mov_b32 s33, 8192
    buffer_load_dwordx4 v[100:103], v164, s[24:27], s33 offen sc0 sc1
    s_mov_b32 s33, 9216
    buffer_load_dwordx4 v[104:107], v164, s[24:27], s33 offen sc0 sc1
    s_mov_b32 s33, 10240
    buffer_load_dwordx4 v[108:111], v164, s[24:27], s33 offen sc0 sc1
    s_mov_b32 s33, 11264
    buffer_load_dwordx4 v[112:115], v164, s[24:27], s33 offen sc0 sc1
    s_mov_b32 s33, 12288
    buffer_load_dwordx4 v[116:119], v164, s[24:27], s33 offen sc0 sc1
    s_mov_b32 s33, 13312
    buffer_load_dwordx4 v[120:123], v164, s[24:27], s33 offen sc0 sc1
    s_mov_b32 s33, 14336
    buffer_load_dwordx4 v[124:127], v164, s[24:27], s33 offen sc0 sc1
    s_mov_b32 s33, 15360
    buffer_load_dwordx4 v[128:131], v164, s[24:27], s33 offen sc0 sc1
    v_and_b32 v167, 15, v0
    v_mul_u32_u24 v167, 272, v167
    v_lshrrev_b32 v166, 4, v0
    v_lshl_add_u32 v167, v166, 3, v167
    s_lshl_b32 s33, s43, 5
    s_add_u32 s33, s33, 0
    v_add_u32 v167, s33, v167
    s_waitcnt vmcnt(15)
    v_add_f32 v4, v4, v68
    v_add_f32 v5, v5, v69
    v_add_f32 v6, v6, v70
    v_add_f32 v7, v7, v71
    v_cvt_pk_bf16_f32 v4, v4, v5
    v_cvt_pk_bf16_f32 v5, v6, v7
    ds_write_b64 v167, v[4:5] offset:0
    s_waitcnt vmcnt(14)
    v_add_f32 v8, v8, v72
    v_add_f32 v9, v9, v73
    v_add_f32 v10, v10, v74
    v_add_f32 v11, v11, v75
    v_cvt_pk_bf16_f32 v8, v8, v9
    v_cvt_pk_bf16_f32 v9, v10, v11
    ds_write_b64 v167, v[8:9] offset:64
    s_waitcnt vmcnt(13)
    v_add_f32 v12, v12, v76
    v_add_f32 v13, v13, v77
    v_add_f32 v14, v14, v78
    v_add_f32 v15, v15, v79
    v_cvt_pk_bf16_f32 v12, v12, v13
    v_cvt_pk_bf16_f32 v13, v14, v15
    ds_write_b64 v167, v[12:13] offset:128
    s_waitcnt vmcnt(12)
    v_add_f32 v16, v16, v80
    v_add_f32 v17, v17, v81
    v_add_f32 v18, v18, v82
    v_add_f32 v19, v19, v83
    v_cvt_pk_bf16_f32 v16, v16, v17
    v_cvt_pk_bf16_f32 v17, v18, v19
    ds_write_b64 v167, v[16:17] offset:192
    s_waitcnt vmcnt(11)
    v_add_f32 v20, v20, v84
    v_add_f32 v21, v21, v85
    v_add_f32 v22, v22, v86
    v_add_f32 v23, v23, v87
    v_cvt_pk_bf16_f32 v20, v20, v21
    v_cvt_pk_bf16_f32 v21, v22, v23
    ds_write_b64 v167, v[20:21] offset:4352
    s_waitcnt vmcnt(10)
    v_add_f32 v24, v24, v88
    v_add_f32 v25, v25, v89
    v_add_f32 v26, v26, v90
    v_add_f32 v27, v27, v91
    v_cvt_pk_bf16_f32 v24, v24, v25
    v_cvt_pk_bf16_f32 v25, v26, v27
    ds_write_b64 v167, v[24:25] offset:4416
    s_waitcnt vmcnt(9)
    v_add_f32 v28, v28, v92
    v_add_f32 v29, v29, v93
    v_add_f32 v30, v30, v94
    v_add_f32 v31, v31, v95
    v_cvt_pk_bf16_f32 v28, v28, v29
    v_cvt_pk_bf16_f32 v29, v30, v31
    ds_write_b64 v167, v[28:29] offset:4480
    s_waitcnt vmcnt(8)
    v_add_f32 v32, v32, v96
    v_add_f32 v33, v33, v97
    v_add_f32 v34, v34, v98
    v_add_f32 v35, v35, v99
    v_cvt_pk_bf16_f32 v32, v32, v33
    v_cvt_pk_bf16_f32 v33, v34, v35
    ds_write_b64 v167, v[32:33] offset:4544
    s_waitcnt vmcnt(7)
    v_add_f32 v36, v36, v100
    v_add_f32 v37, v37, v101
    v_add_f32 v38, v38, v102
    v_add_f32 v39, v39, v103
    v_cvt_pk_bf16_f32 v36, v36, v37
    v_cvt_pk_bf16_f32 v37, v38, v39
    ds_write_b64 v167, v[36:37] offset:8704
    s_waitcnt vmcnt(6)
    v_add_f32 v40, v40, v104
    v_add_f32 v41, v41, v105
    v_add_f32 v42, v42, v106
    v_add_f32 v43, v43, v107
    v_cvt_pk_bf16_f32 v40, v40, v41
    v_cvt_pk_bf16_f32 v41, v42, v43
    ds_write_b64 v167, v[40:41] offset:8768
    s_waitcnt vmcnt(5)
    v_add_f32 v44, v44, v108
    v_add_f32 v45, v45, v109
    v_add_f32 v46, v46, v110
    v_add_f32 v47, v47, v111
    v_cvt_pk_bf16_f32 v44, v44, v45
    v_cvt_pk_bf16_f32 v45, v46, v47
    ds_write_b64 v167, v[44:45] offset:8832
    s_waitcnt vmcnt(4)
    v_add_f32 v48, v48, v112
    v_add_f32 v49, v49, v113
    v_add_f32 v50, v50, v114
    v_add_f32 v51, v51, v115
    v_cvt_pk_bf16_f32 v48, v48, v49
    v_cvt_pk_bf16_f32 v49, v50, v51
    ds_write_b64 v167, v[48:49] offset:8896
    s_waitcnt vmcnt(3)
    v_add_f32 v52, v52, v116
    v_add_f32 v53, v53, v117
    v_add_f32 v54, v54, v118
    v_add_f32 v55, v55, v119
    v_cvt_pk_bf16_f32 v52, v52, v53
    v_cvt_pk_bf16_f32 v53, v54, v55
    ds_write_b64 v167, v[52:53] offset:13056
    s_waitcnt vmcnt(2)
    v_add_f32 v56, v56, v120
    v_add_f32 v57, v57, v121
    v_add_f32 v58, v58, v122
    v_add_f32 v59, v59, v123
    v_cvt_pk_bf16_f32 v56, v56, v57
    v_cvt_pk_bf16_f32 v57, v58, v59
    ds_write_b64 v167, v[56:57] offset:13120
    s_waitcnt vmcnt(1)
    v_add_f32 v60, v60, v124
    v_add_f32 v61, v61, v125
    v_add_f32 v62, v62, v126
    v_add_f32 v63, v63, v127
    v_cvt_pk_bf16_f32 v60, v60, v61
    v_cvt_pk_bf16_f32 v61, v62, v63
    ds_write_b64 v167, v[60:61] offset:13184
    s_waitcnt vmcnt(0)
    v_add_f32 v64, v64, v128
    v_add_f32 v65, v65, v129
    v_add_f32 v66, v66, v130
    v_add_f32 v67, v67, v131
    v_cvt_pk_bf16_f32 v64, v64, v65
    v_cvt_pk_bf16_f32 v65, v66, v67
    ds_write_b64 v167, v[64:65] offset:13248
join_1014:
    s_waitcnt lgkmcnt(0)
    s_barrier
    v_add_u32 v146, 0, v146
    ds_read_b128 v[68:71], v146 offset:0
    ds_read_b128 v[72:75], v146 offset:4352
    ds_read_b128 v[76:79], v146 offset:8704
    ds_read_b128 v[80:83], v146 offset:13056
    s_waitcnt vmcnt(0)
    s_waitcnt lgkmcnt(3)
    v_lshlrev_b32 v84, 16, v68
    v_lshlrev_b32 v92, 16, v148
    v_add_f32 v84, v84, v92
    v_and_b32 v85, 0xffff0000, v68
    v_and_b32 v93, 0xffff0000, v148
    v_add_f32 v85, v85, v93
    v_cvt_pk_bf16_f32 v68, v84, v85
    v_lshlrev_b32 v86, 16, v69
    v_lshlrev_b32 v92, 16, v149
    v_add_f32 v86, v86, v92
    v_and_b32 v87, 0xffff0000, v69
    v_and_b32 v93, 0xffff0000, v149
    v_add_f32 v87, v87, v93
    v_cvt_pk_bf16_f32 v69, v86, v87
    v_lshlrev_b32 v88, 16, v70
    v_lshlrev_b32 v92, 16, v150
    v_add_f32 v88, v88, v92
    v_and_b32 v89, 0xffff0000, v70
    v_and_b32 v93, 0xffff0000, v150
    v_add_f32 v89, v89, v93
    v_cvt_pk_bf16_f32 v70, v88, v89
    v_lshlrev_b32 v90, 16, v71
    v_lshlrev_b32 v92, 16, v151
    v_add_f32 v90, v90, v92
    v_and_b32 v91, 0xffff0000, v71
    v_and_b32 v93, 0xffff0000, v151
    v_add_f32 v91, v91, v93
    v_cvt_pk_bf16_f32 v71, v90, v91
    s_mov_b32 s31, 0
    buffer_store_dwordx4 v[68:71], v145, s[16:19], s31 offen sc1
    s_waitcnt lgkmcnt(2)
    v_lshlrev_b32 v84, 16, v72
    v_lshlrev_b32 v92, 16, v152
    v_add_f32 v84, v84, v92
    v_and_b32 v85, 0xffff0000, v72
    v_and_b32 v93, 0xffff0000, v152
    v_add_f32 v85, v85, v93
    v_cvt_pk_bf16_f32 v72, v84, v85
    v_lshlrev_b32 v86, 16, v73
    v_lshlrev_b32 v92, 16, v153
    v_add_f32 v86, v86, v92
    v_and_b32 v87, 0xffff0000, v73
    v_and_b32 v93, 0xffff0000, v153
    v_add_f32 v87, v87, v93
    v_cvt_pk_bf16_f32 v73, v86, v87
    v_lshlrev_b32 v88, 16, v74
    v_lshlrev_b32 v92, 16, v154
    v_add_f32 v88, v88, v92
    v_and_b32 v89, 0xffff0000, v74
    v_and_b32 v93, 0xffff0000, v154
    v_add_f32 v89, v89, v93
    v_cvt_pk_bf16_f32 v74, v88, v89
    v_lshlrev_b32 v90, 16, v75
    v_lshlrev_b32 v92, 16, v155
    v_add_f32 v90, v90, v92
    v_and_b32 v91, 0xffff0000, v75
    v_and_b32 v93, 0xffff0000, v155
    v_add_f32 v91, v91, v93
    v_cvt_pk_bf16_f32 v75, v90, v91
    s_mov_b32 s31, 32768
    buffer_store_dwordx4 v[72:75], v145, s[16:19], s31 offen sc1
    s_waitcnt lgkmcnt(1)
    v_lshlrev_b32 v84, 16, v76
    v_lshlrev_b32 v92, 16, v156
    v_add_f32 v84, v84, v92
    v_and_b32 v85, 0xffff0000, v76
    v_and_b32 v93, 0xffff0000, v156
    v_add_f32 v85, v85, v93
    v_cvt_pk_bf16_f32 v76, v84, v85
    v_lshlrev_b32 v86, 16, v77
    v_lshlrev_b32 v92, 16, v157
    v_add_f32 v86, v86, v92
    v_and_b32 v87, 0xffff0000, v77
    v_and_b32 v93, 0xffff0000, v157
    v_add_f32 v87, v87, v93
    v_cvt_pk_bf16_f32 v77, v86, v87
    v_lshlrev_b32 v88, 16, v78
    v_lshlrev_b32 v92, 16, v158
    v_add_f32 v88, v88, v92
    v_and_b32 v89, 0xffff0000, v78
    v_and_b32 v93, 0xffff0000, v158
    v_add_f32 v89, v89, v93
    v_cvt_pk_bf16_f32 v78, v88, v89
    v_lshlrev_b32 v90, 16, v79
    v_lshlrev_b32 v92, 16, v159
    v_add_f32 v90, v90, v92
    v_and_b32 v91, 0xffff0000, v79
    v_and_b32 v93, 0xffff0000, v159
    v_add_f32 v91, v91, v93
    v_cvt_pk_bf16_f32 v79, v90, v91
    s_mov_b32 s31, 65536
    buffer_store_dwordx4 v[76:79], v145, s[16:19], s31 offen sc1
    s_waitcnt lgkmcnt(0)
    v_lshlrev_b32 v84, 16, v80
    v_lshlrev_b32 v92, 16, v160
    v_add_f32 v84, v84, v92
    v_and_b32 v85, 0xffff0000, v80
    v_and_b32 v93, 0xffff0000, v160
    v_add_f32 v85, v85, v93
    v_cvt_pk_bf16_f32 v80, v84, v85
    v_lshlrev_b32 v86, 16, v81
    v_lshlrev_b32 v92, 16, v161
    v_add_f32 v86, v86, v92
    v_and_b32 v87, 0xffff0000, v81
    v_and_b32 v93, 0xffff0000, v161
    v_add_f32 v87, v87, v93
    v_cvt_pk_bf16_f32 v81, v86, v87
    v_lshlrev_b32 v88, 16, v82
    v_lshlrev_b32 v92, 16, v162
    v_add_f32 v88, v88, v92
    v_and_b32 v89, 0xffff0000, v82
    v_and_b32 v93, 0xffff0000, v162
    v_add_f32 v89, v89, v93
    v_cvt_pk_bf16_f32 v82, v88, v89
    v_lshlrev_b32 v90, 16, v83
    v_lshlrev_b32 v92, 16, v163
    v_add_f32 v90, v90, v92
    v_and_b32 v91, 0xffff0000, v83
    v_and_b32 v93, 0xffff0000, v163
    v_add_f32 v91, v91, v93
    v_cvt_pk_bf16_f32 v83, v90, v91
    s_mov_b32 s31, 98304
    buffer_store_dwordx4 v[80:83], v145, s[16:19], s31 offen sc1
    s_endpgm
sequential_preLN__linear_kernel_hedgehog__dense_activation_relu__prompt_kernel_loader:
    v_lshlrev_b32 v1, 2, v0
    v_add_u32 v1, 161792, v1
    v_mov_b32 v2, 0
    s_mov_b64 exec, 0x7fff
    ds_write_b32 v1, v2
    s_mov_b64 exec, -1
    s_cmp_ge_u32 s2, 8
    s_cbranch_scc1 notlb_5001
    s_cmp_lg_u32 s28, 7
    s_cbranch_scc1 notlb_5001
    v_lshlrev_b32 v1, 21, v0
    v_mov_b32 v2, 0x80000000
    v_cmp_gt_u32 vcc, 28, v0
    s_nop 1
    v_cndmask_b32 v1, v2, v1, vcc
    buffer_load_dword v250, v1, s[24:27], 0 offen
    s_mov_b32 s16, s50
    s_mov_b32 s17, s51
    s_mov_b32 s18, 2097152
    s_mov_b32 s19, 0x20000
    v_lshlrev_b32 v1, 21, v0
    buffer_load_dword v250, v1, s[16:19], 0 offen
    s_mov_b32 s16, s54
    s_mov_b32 s17, s55
    s_mov_b32 s18, 7340032
    s_mov_b32 s19, 0x20000
    v_lshlrev_b32 v1, 21, v0
    buffer_load_dword v250, v1, s[16:19], 0 offen
    s_mov_b32 s16, s56
    s_mov_b32 s17, s57
    s_mov_b32 s18, 7340032
    s_mov_b32 s19, 0x20000
    v_lshlrev_b32 v1, 21, v0
    buffer_load_dword v250, v1, s[16:19], 0 offen
    s_mov_b32 s16, s58
    s_mov_b32 s17, s59
    s_mov_b32 s18, 4194304
    s_mov_b32 s19, 0x20000
    v_lshlrev_b32 v1, 21, v0
    buffer_load_dword v250, v1, s[16:19], 0 offen
notlb_5001:
    s_and_b32 s31, s2, 7
    s_lshr_b32 s32, s2, 3
    s_lshr_b32 s33, s31, 2
    s_and_b32 s34, s31, 3
    s_mul_i32 s29, s32, 8193
    s_lshr_b32 s29, s29, 16
    s_mul_i32 s30, s29, 8
    s_sub_u32 s30, s32, s30
    s_mul_i32 s33, s33, 4
    s_add_u32 s29, s29, s33
    s_mul_i32 s34, s34, 8
    s_add_u32 s30, s30, s34
    s_mul_i32 s35, s29, 524288
    s_add_u32 s4, s44, s35
    s_addc_u32 s5, s45, 0
    s_sub_u32 s6, 4194304, s35
    s_mov_b32 s7, 0x20000
    s_lshl_b32 s35, s30, 6
    s_add_u32 s8, s46, s35
    s_addc_u32 s9, s47, 0
    s_sub_u32 s10, 6291456, s35
    s_mov_b32 s11, 0x20000
    s_and_b32 s67, s30, 7
    s_lshl_b32 s67, s67, 1
    s_and_b32 s35, s29, 3
    s_lshl_b32 s35, s35, 2
    s_add_u32 s67, s67, s35
    s_and_b32 s67, s67, 15
    s_mov_b32 s64, 0x3fb8aa3b
    s_sub_u32 s41, s28, 4
    v_lshrrev_b32 v1, 3, v0
    s_lshl_b32 s31, s41, 3
    v_add_u32 v1, s31, v1
    s_mov_b32 s31, 2048
    v_mul_lo_u32 v1, v1, s31
    v_bfe_u32 v2, v0, 4, 2
    s_and_b32 s32, s41, 1
    s_lshl_b32 s33, s32, 2
    v_add_u32 v2, s33, v2
    v_and_b32 v3, 7, v0
    v_xor_b32 v2, v2, v3
    v_lshl_add_u32 v4, v2, 4, v1
    v_add_u32 v5, 65536, v4
    v_add_u32 v6, 131072, v4
    v_add_u32 v7, 196608, v4
    v_add_u32 v8, 262144, v4
    v_add_u32 v9, 327680, v4
    v_add_u32 v10, 393216, v4
    v_add_u32 v11, 458752, v4
    s_mov_b32 s31, 6144
    v_lshrrev_b32 v1, 4, v0
    v_lshlrev_b32 v1, 2, v1
    v_bfe_u32 v2, v0, 2, 2
    v_add_u32 v1, v1, v2
    s_lshl_b32 s33, s41, 4
    v_add_u32 v1, s33, v1
    v_mul_lo_u32 v1, v1, s31
    v_and_b32 v2, 3, v0
    v_lshrrev_b32 v3, 5, v0
    v_lshlrev_b32 v3, 1, v3
    v_xor_b32 v2, v2, v3
    v_lshl_add_u32 v16, v2, 4, v1
    v_add_u32 v12, 0, v16
    v_add_u32 v13, 2048, v16
    v_add_u32 v14, 4096, v16
    s_mul_i32 s39, s67, 128
    s_mul_i32 s40, s67, 393216
    s_lshl_b32 s37, s41, 10
    s_add_u32 m0, s37, 0
    s_nop 0
    buffer_load_dwordx4 v4, s[4:7], s39 offen lds
    s_add_u32 s70, s39, 128
    s_add_u32 s71, s40, 393216
    s_cmp_eq_u32 s70, 2048
    s_cselect_b32 s70, 0, s70
    s_cselect_b32 s71, 0, s71
    s_add_u32 m0, s37, 4096
    s_nop 0
    buffer_load_dwordx4 v5, s[4:7], s39 offen lds
    s_add_u32 m0, s37, 8192
    s_nop 0
    buffer_load_dwordx4 v6, s[4:7], s39 offen lds
    s_add_u32 m0, s37, 12288
    s_nop 0
    buffer_load_dwordx4 v7, s[4:7], s39 offen lds
    s_add_u32 m0, s37, 16384
    s_nop 0
    buffer_load_dwordx4 v8, s[4:7], s39 offen lds
    s_add_u32 m0, s37, 20480
    s_nop 0
    buffer_load_dwordx4 v9, s[4:7], s39 offen lds
    s_add_u32 m0, s37, 24576
    s_nop 0
    buffer_load_dwordx4 v10, s[4:7], s39 offen lds
    s_add_u32 m0, s37, 28672
    s_nop 0
    buffer_load_dwordx4 v11, s[4:7], s39 offen lds
    s_add_u32 m0, s37, 32768
    s_nop 0
    buffer_load_dwordx4 v12, s[8:11], s40 offen lds
    s_add_u32 m0, s37, 36864
    s_nop 0
    buffer_load_dwordx4 v13, s[8:11], s40 offen lds
    s_add_u32 m0, s37, 40960
    s_nop 0
    buffer_load_dwordx4 v14, s[8:11], s40 offen lds
    s_add_u32 m0, s37, 45056
    s_nop 0
    buffer_load_dwordx4 v4, s[4:7], s70 offen lds
    s_add_u32 s39, s70, 128
    s_add_u32 s40, s71, 393216
    s_cmp_eq_u32 s39, 2048
    s_cselect_b32 s39, 0, s39
    s_cselect_b32 s40, 0, s40
    s_add_u32 m0, s37, 49152
    s_nop 0
    buffer_load_dwordx4 v5, s[4:7], s70 offen lds
    s_add_u32 m0, s37, 53248
    s_nop 0
    buffer_load_dwordx4 v6, s[4:7], s70 offen lds
    s_add_u32 m0, s37, 57344
    s_nop 0
    buffer_load_dwordx4 v7, s[4:7], s70 offen lds
    s_add_u32 m0, s37, 61440
    s_nop 0
    buffer_load_dwordx4 v8, s[4:7], s70 offen lds
    s_add_u32 m0, s37, 65536
    s_nop 0
    buffer_load_dwordx4 v9, s[4:7], s70 offen lds
    s_add_u32 m0, s37, 69632
    s_nop 0
    buffer_load_dwordx4 v10, s[4:7], s70 offen lds
    s_add_u32 m0, s37, 73728
    s_nop 0
    buffer_load_dwordx4 v11, s[4:7], s70 offen lds
    s_add_u32 m0, s37, 77824
    s_nop 0
    buffer_load_dwordx4 v12, s[8:11], s71 offen lds
    s_add_u32 m0, s37, 81920
    s_nop 0
    buffer_load_dwordx4 v13, s[8:11], s71 offen lds
    s_add_u32 m0, s37, 86016
    s_nop 0
    buffer_load_dwordx4 v14, s[8:11], s71 offen lds
    s_mov_b32 s38, 2
p1_lloop:
    s_waitcnt vmcnt(11)
    s_barrier
    s_add_u32 m0, s37, 90112
    s_nop 0
    buffer_load_dwordx4 v4, s[4:7], s39 offen lds
    s_add_u32 s70, s39, 128
    s_add_u32 s71, s40, 393216
    s_cmp_eq_u32 s70, 2048
    s_cselect_b32 s70, 0, s70
    s_cselect_b32 s71, 0, s71
    s_add_u32 m0, s37, 94208
    s_nop 0
    buffer_load_dwordx4 v5, s[4:7], s39 offen lds
    s_add_u32 m0, s37, 98304
    s_nop 0
    buffer_load_dwordx4 v6, s[4:7], s39 offen lds
    s_add_u32 m0, s37, 102400
    s_nop 0
    buffer_load_dwordx4 v7, s[4:7], s39 offen lds
    s_add_u32 m0, s37, 106496
    s_nop 0
    buffer_load_dwordx4 v8, s[4:7], s39 offen lds
    s_add_u32 m0, s37, 110592
    s_nop 0
    buffer_load_dwordx4 v9, s[4:7], s39 offen lds
    s_add_u32 m0, s37, 114688
    s_nop 0
    buffer_load_dwordx4 v10, s[4:7], s39 offen lds
    s_add_u32 m0, s37, 118784
    s_nop 0
    buffer_load_dwordx4 v11, s[4:7], s39 offen lds
    s_add_u32 m0, s37, 122880
    s_nop 0
    buffer_load_dwordx4 v12, s[8:11], s40 offen lds
    s_add_u32 m0, s37, 126976
    s_nop 0
    buffer_load_dwordx4 v13, s[8:11], s40 offen lds
    s_add_u32 m0, s37, 131072
    s_nop 0
    buffer_load_dwordx4 v14, s[8:11], s40 offen lds
    s_waitcnt vmcnt(11)
    s_barrier
    s_add_u32 m0, s37, 0
    s_nop 0
    buffer_load_dwordx4 v4, s[4:7], s70 offen lds
    s_add_u32 s39, s70, 128
    s_add_u32 s40, s71, 393216
    s_cmp_eq_u32 s39, 2048
    s_cselect_b32 s39, 0, s39
    s_cselect_b32 s40, 0, s40
    s_add_u32 m0, s37, 4096
    s_nop 0
    buffer_load_dwordx4 v5, s[4:7], s70 offen lds
    s_add_u32 m0, s37, 8192
    s_nop 0
    buffer_load_dwordx4 v6, s[4:7], s70 offen lds
    s_add_u32 m0, s37, 12288
    s_nop 0
    buffer_load_dwordx4 v7, s[4:7], s70 offen lds
    s_add_u32 m0, s37, 16384
    s_nop 0
    buffer_load_dwordx4 v8, s[4:7], s70 offen lds
    s_add_u32 m0, s37, 20480
    s_nop 0
    buffer_load_dwordx4 v9, s[4:7], s70 offen lds
    s_add_u32 m0, s37, 24576
    s_nop 0
    buffer_load_dwordx4 v10, s[4:7], s70 offen lds
    s_add_u32 m0, s37, 28672
    s_nop 0
    buffer_load_dwordx4 v11, s[4:7], s70 offen lds
    s_add_u32 m0, s37, 32768
    s_nop 0
    buffer_load_dwordx4 v12, s[8:11], s71 offen lds
    s_add_u32 m0, s37, 36864
    s_nop 0
    buffer_load_dwordx4 v13, s[8:11], s71 offen lds
    s_add_u32 m0, s37, 40960
    s_nop 0
    buffer_load_dwordx4 v14, s[8:11], s71 offen lds
    s_waitcnt vmcnt(11)
    s_barrier
    s_add_u32 m0, s37, 45056
    s_nop 0
    buffer_load_dwordx4 v4, s[4:7], s39 offen lds
    s_add_u32 s70, s39, 128
    s_add_u32 s71, s40, 393216
    s_cmp_eq_u32 s70, 2048
    s_cselect_b32 s70, 0, s70
    s_cselect_b32 s71, 0, s71
    s_add_u32 m0, s37, 49152
    s_nop 0
    buffer_load_dwordx4 v5, s[4:7], s39 offen lds
    s_add_u32 m0, s37, 53248
    s_nop 0
    buffer_load_dwordx4 v6, s[4:7], s39 offen lds
    s_add_u32 m0, s37, 57344
    s_nop 0
    buffer_load_dwordx4 v7, s[4:7], s39 offen lds
    s_add_u32 m0, s37, 61440
    s_nop 0
    buffer_load_dwordx4 v8, s[4:7], s39 offen lds
    s_add_u32 m0, s37, 65536
    s_nop 0
    buffer_load_dwordx4 v9, s[4:7], s39 offen lds
    s_add_u32 m0, s37, 69632
    s_nop 0
    buffer_load_dwordx4 v10, s[4:7], s39 offen lds
    s_add_u32 m0, s37, 73728
    s_nop 0
    buffer_load_dwordx4 v11, s[4:7], s39 offen lds
    s_add_u32 m0, s37, 77824
    s_nop 0
    buffer_load_dwordx4 v12, s[8:11], s40 offen lds
    s_add_u32 m0, s37, 81920
    s_nop 0
    buffer_load_dwordx4 v13, s[8:11], s40 offen lds
    s_add_u32 m0, s37, 86016
    s_nop 0
    buffer_load_dwordx4 v14, s[8:11], s40 offen lds
    s_waitcnt vmcnt(11)
    s_barrier
    s_add_u32 m0, s37, 90112
    s_nop 0
    buffer_load_dwordx4 v4, s[4:7], s70 offen lds
    s_add_u32 s39, s70, 128
    s_add_u32 s40, s71, 393216
    s_cmp_eq_u32 s39, 2048
    s_cselect_b32 s39, 0, s39
    s_cselect_b32 s40, 0, s40
    s_add_u32 m0, s37, 94208
    s_nop 0
    buffer_load_dwordx4 v5, s[4:7], s70 offen lds
    s_add_u32 m0, s37, 98304
    s_nop 0
    buffer_load_dwordx4 v6, s[4:7], s70 offen lds
    s_add_u32 m0, s37, 102400
    s_nop 0
    buffer_load_dwordx4 v7, s[4:7], s70 offen lds
    s_add_u32 m0, s37, 106496
    s_nop 0
    buffer_load_dwordx4 v8, s[4:7], s70 offen lds
    s_add_u32 m0, s37, 110592
    s_nop 0
    buffer_load_dwordx4 v9, s[4:7], s70 offen lds
    s_add_u32 m0, s37, 114688
    s_nop 0
    buffer_load_dwordx4 v10, s[4:7], s70 offen lds
    s_add_u32 m0, s37, 118784
    s_nop 0
    buffer_load_dwordx4 v11, s[4:7], s70 offen lds
    s_add_u32 m0, s37, 122880
    s_nop 0
    buffer_load_dwordx4 v12, s[8:11], s71 offen lds
    s_add_u32 m0, s37, 126976
    s_nop 0
    buffer_load_dwordx4 v13, s[8:11], s71 offen lds
    s_add_u32 m0, s37, 131072
    s_nop 0
    buffer_load_dwordx4 v14, s[8:11], s71 offen lds
    s_waitcnt vmcnt(11)
    s_barrier
    s_add_u32 m0, s37, 0
    s_nop 0
    buffer_load_dwordx4 v4, s[4:7], s39 offen lds
    s_add_u32 s70, s39, 128
    s_add_u32 s71, s40, 393216
    s_cmp_eq_u32 s70, 2048
    s_cselect_b32 s70, 0, s70
    s_cselect_b32 s71, 0, s71
    s_add_u32 m0, s37, 4096
    s_nop 0
    buffer_load_dwordx4 v5, s[4:7], s39 offen lds
    s_add_u32 m0, s37, 8192
    s_nop 0
    buffer_load_dwordx4 v6, s[4:7], s39 offen lds
    s_add_u32 m0, s37, 12288
    s_nop 0
    buffer_load_dwordx4 v7, s[4:7], s39 offen lds
    s_add_u32 m0, s37, 16384
    s_nop 0
    buffer_load_dwordx4 v8, s[4:7], s39 offen lds
    s_add_u32 m0, s37, 20480
    s_nop 0
    buffer_load_dwordx4 v9, s[4:7], s39 offen lds
    s_add_u32 m0, s37, 24576
    s_nop 0
    buffer_load_dwordx4 v10, s[4:7], s39 offen lds
    s_add_u32 m0, s37, 28672
    s_nop 0
    buffer_load_dwordx4 v11, s[4:7], s39 offen lds
    s_add_u32 m0, s37, 32768
    s_nop 0
    buffer_load_dwordx4 v12, s[8:11], s40 offen lds
    s_add_u32 m0, s37, 36864
    s_nop 0
    buffer_load_dwordx4 v13, s[8:11], s40 offen lds
    s_add_u32 m0, s37, 40960
    s_nop 0
    buffer_load_dwordx4 v14, s[8:11], s40 offen lds
    s_waitcnt vmcnt(11)
    s_barrier
    s_add_u32 m0, s37, 45056
    s_nop 0
    buffer_load_dwordx4 v4, s[4:7], s70 offen lds
    s_add_u32 s39, s70, 128
    s_add_u32 s40, s71, 393216
    s_cmp_eq_u32 s39, 2048
    s_cselect_b32 s39, 0, s39
    s_cselect_b32 s40, 0, s40
    s_add_u32 m0, s37, 49152
    s_nop 0
    buffer_load_dwordx4 v5, s[4:7], s70 offen lds
    s_add_u32 m0, s37, 53248
    s_nop 0
    buffer_load_dwordx4 v6, s[4:7], s70 offen lds
    s_add_u32 m0, s37, 57344
    s_nop 0
    buffer_load_dwordx4 v7, s[4:7], s70 offen lds
    s_add_u32 m0, s37, 61440
    s_nop 0
    buffer_load_dwordx4 v8, s[4:7], s70 offen lds
    s_add_u32 m0, s37, 65536
    s_nop 0
    buffer_load_dwordx4 v9, s[4:7], s70 offen lds
    s_add_u32 m0, s37, 69632
    s_nop 0
    buffer_load_dwordx4 v10, s[4:7], s70 offen lds
    s_add_u32 m0, s37, 73728
    s_nop 0
    buffer_load_dwordx4 v11, s[4:7], s70 offen lds
    s_add_u32 m0, s37, 77824
    s_nop 0
    buffer_load_dwordx4 v12, s[8:11], s71 offen lds
    s_add_u32 m0, s37, 81920
    s_nop 0
    buffer_load_dwordx4 v13, s[8:11], s71 offen lds
    s_add_u32 m0, s37, 86016
    s_nop 0
    buffer_load_dwordx4 v14, s[8:11], s71 offen lds
    s_sub_u32 s38, s38, 1
    s_cmp_lg_u32 s38, 0
    s_cbranch_scc1 p1_lloop
    s_waitcnt vmcnt(11)
    s_barrier
    s_add_u32 m0, s37, 90112
    s_nop 0
    buffer_load_dwordx4 v4, s[4:7], s39 offen lds
    s_add_u32 s70, s39, 128
    s_add_u32 s71, s40, 393216
    s_cmp_eq_u32 s70, 2048
    s_cselect_b32 s70, 0, s70
    s_cselect_b32 s71, 0, s71
    s_add_u32 m0, s37, 94208
    s_nop 0
    buffer_load_dwordx4 v5, s[4:7], s39 offen lds
    s_add_u32 m0, s37, 98304
    s_nop 0
    buffer_load_dwordx4 v6, s[4:7], s39 offen lds
    s_add_u32 m0, s37, 102400
    s_nop 0
    buffer_load_dwordx4 v7, s[4:7], s39 offen lds
    s_add_u32 m0, s37, 106496
    s_nop 0
    buffer_load_dwordx4 v8, s[4:7], s39 offen lds
    s_add_u32 m0, s37, 110592
    s_nop 0
    buffer_load_dwordx4 v9, s[4:7], s39 offen lds
    s_add_u32 m0, s37, 114688
    s_nop 0
    buffer_load_dwordx4 v10, s[4:7], s39 offen lds
    s_add_u32 m0, s37, 118784
    s_nop 0
    buffer_load_dwordx4 v11, s[4:7], s39 offen lds
    s_add_u32 m0, s37, 122880
    s_nop 0
    buffer_load_dwordx4 v12, s[8:11], s40 offen lds
    s_add_u32 m0, s37, 126976
    s_nop 0
    buffer_load_dwordx4 v13, s[8:11], s40 offen lds
    s_add_u32 m0, s37, 131072
    s_nop 0
    buffer_load_dwordx4 v14, s[8:11], s40 offen lds
    s_waitcnt vmcnt(11)
    s_barrier
    s_add_u32 m0, s37, 0
    s_nop 0
    buffer_load_dwordx4 v4, s[4:7], s70 offen lds
    s_add_u32 s39, s70, 128
    s_add_u32 s40, s71, 393216
    s_cmp_eq_u32 s39, 2048
    s_cselect_b32 s39, 0, s39
    s_cselect_b32 s40, 0, s40
    s_add_u32 m0, s37, 4096
    s_nop 0
    buffer_load_dwordx4 v5, s[4:7], s70 offen lds
    s_add_u32 m0, s37, 8192
    s_nop 0
    buffer_load_dwordx4 v6, s[4:7], s70 offen lds
    s_add_u32 m0, s37, 12288
    s_nop 0
    buffer_load_dwordx4 v7, s[4:7], s70 offen lds
    s_add_u32 m0, s37, 16384
    s_nop 0
    buffer_load_dwordx4 v8, s[4:7], s70 offen lds
    s_add_u32 m0, s37, 20480
    s_nop 0
    buffer_load_dwordx4 v9, s[4:7], s70 offen lds
    s_add_u32 m0, s37, 24576
    s_nop 0
    buffer_load_dwordx4 v10, s[4:7], s70 offen lds
    s_add_u32 m0, s37, 28672
    s_nop 0
    buffer_load_dwordx4 v11, s[4:7], s70 offen lds
    s_add_u32 m0, s37, 32768
    s_nop 0
    buffer_load_dwordx4 v12, s[8:11], s71 offen lds
    s_add_u32 m0, s37, 36864
    s_nop 0
    buffer_load_dwordx4 v13, s[8:11], s71 offen lds
    s_add_u32 m0, s37, 40960
    s_nop 0
    buffer_load_dwordx4 v14, s[8:11], s71 offen lds
    s_waitcnt vmcnt(11)
    s_barrier
    s_waitcnt vmcnt(0)
    s_barrier
    v_lshrrev_b32 v2, 4, v0
    v_and_b32 v3, 15, v0
    v_bfe_u32 v4, v0, 2, 2
    v_and_b32 v5, 3, v0
    v_mov_b32 v6, 161852
    ds_read_b32 v8, v6
    s_waitcnt lgkmcnt(0)
    v_readfirstlane_b32 s65, v8
    s_barrier
    s_mov_b32 s16, s50
    s_mov_b32 s17, s51
    s_mov_b32 s18, 2097152
    s_mov_b32 s19, 0x20000
    s_lshl_b32 s31, s41, 6
    v_add_u32 v6, s31, v0
    v_lshlrev_b32 v6, 4, v6
    s_mul_i32 s31, s2, 8192
    buffer_load_dwordx4 v[8:11], v6, s[16:19], s31 offen
    s_add_u32 s31, s31, 4096
    buffer_load_dwordx4 v[8:11], v6, s[16:19], s31 offen
    s_add_u32 s31, s31, 4096
    s_mov_b32 s16, s54
    s_mov_b32 s17, s55
    s_mov_b32 s18, 7340032
    s_mov_b32 s19, 0x20000
    s_lshl_b32 s31, s41, 6
    v_add_u32 v6, s31, v0
    v_lshlrev_b32 v6, 4, v6
    s_mul_i32 s31, s2, 28672
    buffer_load_dwordx4 v[8:11], v6, s[16:19], s31 offen
    s_add_u32 s31, s31, 4096
    buffer_load_dwordx4 v[8:11], v6, s[16:19], s31 offen
    s_add_u32 s31, s31, 4096
    buffer_load_dwordx4 v[8:11], v6, s[16:19], s31 offen
    s_add_u32 s31, s31, 4096
    buffer_load_dwordx4 v[8:11], v6, s[16:19], s31 offen
    s_add_u32 s31, s31, 4096
    buffer_load_dwordx4 v[8:11], v6, s[16:19], s31 offen
    s_add_u32 s31, s31, 4096
    buffer_load_dwordx4 v[8:11], v6, s[16:19], s31 offen
    s_add_u32 s31, s31, 4096
    buffer_load_dwordx4 v[8:11], v6, s[16:19], s31 offen
    s_add_u32 s31, s31, 4096
    s_getpc_b64 s[74:75]
fa_5002:
    s_add_u32 s74, s74, feat_sub-fa_5002
    s_addc_u32 s75, s75, 0
    v_lshl_add_u32 v44, v2, 2, v4
    v_lshlrev_b32 v44, 6, v44
    v_lshl_add_u32 v44, v5, 3, v44
    v_add_u32 v44, 135168, v44
    ds_read_b64_tr_b16 v[200:201], v44 offset:0
    ds_read_b64_tr_b16 v[202:203], v44 offset:1024
    ds_read_b64_tr_b16 v[204:205], v44 offset:32
    ds_read_b64_tr_b16 v[206:207], v44 offset:1056
    s_lshl_b32 s31, s41, 6
    v_add_u32 v45, s31, v3
    v_mul_u32_u24 v45, 144, v45
    v_lshl_add_u32 v45, v2, 3, v45
    v_add_u32 v45, 69632, v45
    s_lshl_b32 s31, s41, 11
    s_add_u32 s31, s31, 61440
    v_lshl_add_u32 v46, v0, 4, s31
    s_lshl_b32 s31, s41, 12
    s_add_u32 s31, s31, 45056
    v_lshl_add_u32 v47, v0, 4, s31
    s_waitcnt lgkmcnt(0)
    s_barrier
    ds_read_b128 v[48:51], v46 offset:0
    ds_read_b128 v[52:55], v46 offset:1024
    ds_read_b128 v[56:59], v47 offset:0
    ds_read_b128 v[60:63], v47 offset:1024
    ds_read_b128 v[64:67], v47 offset:2048
    ds_read_b128 v[68:71], v47 offset:3072
    s_waitcnt lgkmcnt(4)
    v_mov_b32 v208, v48
    v_mov_b32 v209, v49
    v_mov_b32 v210, v50
    v_mov_b32 v211, v51
    s_swappc_b64 s[72:73], s[74:75]
    ds_write_b64 v45, v[244:245] offset:4608
    ds_write_b64 v45, v[248:249] offset:4672
    ds_write_b64 v45, v[246:247] offset:4640
    ds_write_b64 v45, v[250:251] offset:4704
    v_mov_b32 v208, v52
    v_mov_b32 v209, v53
    v_mov_b32 v210, v54
    v_mov_b32 v211, v55
    s_swappc_b64 s[72:73], s[74:75]
    ds_write_b64 v45, v[244:245] offset:6912
    ds_write_b64 v45, v[248:249] offset:6976
    ds_write_b64 v45, v[246:247] offset:6944
    ds_write_b64 v45, v[250:251] offset:7008
    s_waitcnt lgkmcnt(0)
    s_barrier
    v_mov_b32 v208, v56
    v_mov_b32 v209, v57
    v_mov_b32 v210, v58
    v_mov_b32 v211, v59
    s_swappc_b64 s[72:73], s[74:75]
    v_mov_b32 v72, v244
    v_mov_b32 v76, v248
    v_mov_b32 v73, v245
    v_mov_b32 v77, v249
    v_mov_b32 v74, v246
    v_mov_b32 v78, v250
    v_mov_b32 v75, v247
    v_mov_b32 v79, v251
    v_mov_b32 v208, v60
    v_mov_b32 v209, v61
    v_mov_b32 v210, v62
    v_mov_b32 v211, v63
    s_swappc_b64 s[72:73], s[74:75]
    v_mov_b32 v80, v244
    v_mov_b32 v84, v248
    v_mov_b32 v81, v245
    v_mov_b32 v85, v249
    v_mov_b32 v82, v246
    v_mov_b32 v86, v250
    v_mov_b32 v83, v247
    v_mov_b32 v87, v251
    v_mov_b32 v208, v64
    v_mov_b32 v209, v65
    v_mov_b32 v210, v66
    v_mov_b32 v211, v67
    s_swappc_b64 s[72:73], s[74:75]
    v_mov_b32 v88, v244
    v_mov_b32 v92, v248
    v_mov_b32 v89, v245
    v_mov_b32 v93, v249
    v_mov_b32 v90, v246
    v_mov_b32 v94, v250
    v_mov_b32 v91, v247
    v_mov_b32 v95, v251
    v_mov_b32 v208, v68
    v_mov_b32 v209, v69
    v_mov_b32 v210, v70
    v_mov_b32 v211, v71
    s_swappc_b64 s[72:73], s[74:75]
    v_mov_b32 v96, v244
    v_mov_b32 v100, v248
    v_mov_b32 v97, v245
    v_mov_b32 v101, v249
    v_mov_b32 v98, v246
    v_mov_b32 v102, v250
    v_mov_b32 v99, v247
    v_mov_b32 v103, v251
    s_lshl_b32 s32, s30, 7
    s_add_u32 s32, s32, 32505856
    s_cmp_lg_u32 s41, 0
    s_cbranch_scc1 pw_5003_w
    s_mov_b32 s79, 40000
    v_and_b32 v104, 31, v0
    v_lshl_add_u32 v104, v104, 2, s32
poll_5004:
    buffer_load_dword v105, v104, s[24:27], 0 offen sc0 sc1
    s_waitcnt vmcnt(0)
    v_cmp_ne_u32 vcc, s65, v105
    s_nop 2
    s_cmp_eq_u64 vcc, 0
    s_cbranch_scc1 poll_5004_ok
    s_sleep 6
    s_sub_u32 s79, s79, 1
    s_cmp_lg_u32 s79, 0
    s_cbranch_scc1 poll_5004
poll_5004_ok:
    v_mov_b32 v104, 161792
    v_mov_b32 v105, 1
    ds_write_b32 v104, v105
    s_waitcnt lgkmcnt(0)
    s_branch pw_5003_done
pw_5003_w:
    v_mov_b32 v104, 161792
    s_mov_b32 s79, 640000
pw_5003_l:
    ds_read_b32 v105, v104
    s_waitcnt lgkmcnt(0)
    v_readfirstlane_b32 s31, v105
    s_nop 2
    s_cmp_eq_u32 s31, 1
    s_cbranch_scc1 pw_5003_done
    s_sleep 1
    s_sub_u32 s79, s79, 1
    s_cmp_lg_u32 s79, 0
    s_cbranch_scc1 pw_5003_l
pw_5003_done:
    s_waitcnt vmcnt(0)
    s_lshl_b32 s32, s41, 6
    v_add_u32 v106, s32, v0
    s_mul_i32 s31, s30, 67584
    s_add_u32 s31, s31, 29360128
    v_lshl_add_u32 v104, v106, 4, s31
    v_add_u32 v108, 4096, v104
    v_add_u32 v109, 8192, v104
    v_mov_b32 v105, 0x80000000
    v_cmp_gt_u32 vcc, 16, v106
    s_nop 1
    v_cndmask_b32 v109, v105, v109, vcc
    s_mov_b32 s32, 0
    buffer_load_dwordx4 v[12:15], v104, s[24:27], s32 offen sc0 sc1
    s_mov_b32 s32, 8448
    buffer_load_dwordx4 v[16:19], v104, s[24:27], s32 offen sc0 sc1
    s_mov_b32 s32, 16896
    buffer_load_dwordx4 v[20:23], v104, s[24:27], s32 offen sc0 sc1
    s_mov_b32 s32, 25344
    buffer_load_dwordx4 v[24:27], v104, s[24:27], s32 offen sc0 sc1
    s_mov_b32 s32, 33792
    buffer_load_dwordx4 v[28:31], v104, s[24:27], s32 offen sc0 sc1
    s_mov_b32 s32, 42240
    buffer_load_dwordx4 v[32:35], v104, s[24:27], s32 offen sc0 sc1
    s_mov_b32 s32, 50688
    buffer_load_dwordx4 v[36:39], v104, s[24:27], s32 offen sc0 sc1
    s_mov_b32 s32, 59136
    buffer_load_dwordx4 v[40:43], v104, s[24:27], s32 offen sc0 sc1
    s_mov_b32 s32, 0
    buffer_load_dwordx4 v[112:115], v108, s[24:27], s32 offen sc0 sc1
    s_mov_b32 s32, 8448
    buffer_load_dwordx4 v[116:119], v108, s[24:27], s32 offen sc0 sc1
    s_mov_b32 s32, 16896
    buffer_load_dwordx4 v[120:123], v108, s[24:27], s32 offen sc0 sc1
    s_mov_b32 s32, 25344
    buffer_load_dwordx4 v[124:127], v108, s[24:27], s32 offen sc0 sc1
    s_mov_b32 s32, 33792
    buffer_load_dwordx4 v[128:131], v108, s[24:27], s32 offen sc0 sc1
    s_mov_b32 s32, 42240
    buffer_load_dwordx4 v[132:135], v108, s[24:27], s32 offen sc0 sc1
    s_mov_b32 s32, 50688
    buffer_load_dwordx4 v[136:139], v108, s[24:27], s32 offen sc0 sc1
    s_mov_b32 s32, 59136
    buffer_load_dwordx4 v[140:143], v108, s[24:27], s32 offen sc0 sc1
    s_mov_b32 s32, 0
    buffer_load_dwordx4 v[144:147], v109, s[24:27], s32 offen sc0 sc1
    s_mov_b32 s32, 8448
    buffer_load_dwordx4 v[148:151], v109, s[24:27], s32 offen sc0 sc1
    s_mov_b32 s32, 16896
    buffer_load_dwordx4 v[152:155], v109, s[24:27], s32 offen sc0 sc1
    s_mov_b32 s32, 25344
    buffer_load_dwordx4 v[156:159], v109, s[24:27], s32 offen sc0 sc1
    s_mov_b32 s32, 33792
    buffer_load_dwordx4 v[160:163], v109, s[24:27], s32 offen sc0 sc1
    s_mov_b32 s32, 42240
    buffer_load_dwordx4 v[164:167], v109, s[24:27], s32 offen sc0 sc1
    s_mov_b32 s32, 50688
    buffer_load_dwordx4 v[168:171], v109, s[24:27], s32 offen sc0 sc1
    s_mov_b32 s32, 59136
    buffer_load_dwordx4 v[172:175], v109, s[24:27], s32 offen sc0 sc1
    v_lshlrev_b32 v107, 3, v106
    v_add_u32 v107, 137216, v107
    s_waitcnt vmcnt(16)
    v_add_f32 v12, v12, v16
    v_add_f32 v13, v13, v17
    v_add_f32 v14, v14, v18
    v_add_f32 v15, v15, v19
    v_add_f32 v12, v12, v20
    v_add_f32 v13, v13, v21
    v_add_f32 v14, v14, v22
    v_add_f32 v15, v15, v23
    v_add_f32 v12, v12, v24
    v_add_f32 v13, v13, v25
    v_add_f32 v14, v14, v26
    v_add_f32 v15, v15, v27
    v_add_f32 v12, v12, v28
    v_add_f32 v13, v13, v29
    v_add_f32 v14, v14, v30
    v_add_f32 v15, v15, v31
    v_add_f32 v12, v12, v32
    v_add_f32 v13, v13, v33
    v_add_f32 v14, v14, v34
    v_add_f32 v15, v15, v35
    v_add_f32 v12, v12, v36
    v_add_f32 v13, v13, v37
    v_add_f32 v14, v14, v38
    v_add_f32 v15, v15, v39
    v_add_f32 v12, v12, v40
    v_add_f32 v13, v13, v41
    v_add_f32 v14, v14, v42
    v_add_f32 v15, v15, v43
    v_cvt_pk_bf16_f32 v12, v12, v13
    v_cvt_pk_bf16_f32 v13, v14, v15
    ds_write_b64 v107, v[12:13] offset:0
    s_waitcnt vmcnt(8)
    v_add_f32 v112, v112, v116
    v_add_f32 v113, v113, v117
    v_add_f32 v114, v114, v118
    v_add_f32 v115, v115, v119
    v_add_f32 v112, v112, v120
    v_add_f32 v113, v113, v121
    v_add_f32 v114, v114, v122
    v_add_f32 v115, v115, v123
    v_add_f32 v112, v112, v124
    v_add_f32 v113, v113, v125
    v_add_f32 v114, v114, v126
    v_add_f32 v115, v115, v127
    v_add_f32 v112, v112, v128
    v_add_f32 v113, v113, v129
    v_add_f32 v114, v114, v130
    v_add_f32 v115, v115, v131
    v_add_f32 v112, v112, v132
    v_add_f32 v113, v113, v133
    v_add_f32 v114, v114, v134
    v_add_f32 v115, v115, v135
    v_add_f32 v112, v112, v136
    v_add_f32 v113, v113, v137
    v_add_f32 v114, v114, v138
    v_add_f32 v115, v115, v139
    v_add_f32 v112, v112, v140
    v_add_f32 v113, v113, v141
    v_add_f32 v114, v114, v142
    v_add_f32 v115, v115, v143
    v_cvt_pk_bf16_f32 v112, v112, v113
    v_cvt_pk_bf16_f32 v113, v114, v115
    ds_write_b64 v107, v[112:113] offset:2048
    s_waitcnt vmcnt(0)
    v_add_f32 v144, v144, v148
    v_add_f32 v145, v145, v149
    v_add_f32 v146, v146, v150
    v_add_f32 v147, v147, v151
    v_add_f32 v144, v144, v152
    v_add_f32 v145, v145, v153
    v_add_f32 v146, v146, v154
    v_add_f32 v147, v147, v155
    v_add_f32 v144, v144, v156
    v_add_f32 v145, v145, v157
    v_add_f32 v146, v146, v158
    v_add_f32 v147, v147, v159
    v_add_f32 v144, v144, v160
    v_add_f32 v145, v145, v161
    v_add_f32 v146, v146, v162
    v_add_f32 v147, v147, v163
    v_add_f32 v144, v144, v164
    v_add_f32 v145, v145, v165
    v_add_f32 v146, v146, v166
    v_add_f32 v147, v147, v167
    v_add_f32 v144, v144, v168
    v_add_f32 v145, v145, v169
    v_add_f32 v146, v146, v170
    v_add_f32 v147, v147, v171
    v_add_f32 v144, v144, v172
    v_add_f32 v145, v145, v173
    v_add_f32 v146, v146, v174
    v_add_f32 v147, v147, v175
    v_cvt_pk_bf16_f32 v144, v144, v145
    v_cvt_pk_bf16_f32 v145, v146, v147
    v_cmp_gt_u32 vcc, 16, v106
    s_nop 2
    s_and_saveexec_b64 s[66:67], vcc
    s_cbranch_execz noz_5005
    ds_write_b64 v107, v[144:145] offset:4096
noz_5005:
    s_mov_b64 exec, s[66:67]
    s_waitcnt lgkmcnt(0)
    s_barrier
    ds_read_b64_tr_b16 v[112:113], v44 offset:2048
    ds_read_b64_tr_b16 v[114:115], v44 offset:3072
    ds_read_b64_tr_b16 v[116:117], v44 offset:4096
    ds_read_b64_tr_b16 v[118:119], v44 offset:5120
    ds_read_b64_tr_b16 v[120:121], v44 offset:2080
    ds_read_b64_tr_b16 v[122:123], v44 offset:3104
    ds_read_b64_tr_b16 v[124:125], v44 offset:4128
    ds_read_b64_tr_b16 v[126:127], v44 offset:5152
    v_lshlrev_b32 v105, 3, v2
    v_add_u32 v105, 141312, v105
    ds_read_b64 v[128:129], v105 offset:0
    ds_read_b64 v[130:131], v105 offset:32
    ds_read_b64 v[132:133], v105 offset:64
    ds_read_b64 v[134:135], v105 offset:96
    s_lshl_b32 s31, s29, 5
    s_add_u32 s31, s31, s30
    s_lshl_b32 s31, s31, 14
    s_lshl_b32 s32, s41, 12
    s_add_u32 s31, s31, s32
    s_add_u32 s31, s31, 4194304
    v_lshlrev_b32 v107, 6, v3
    v_and_b32 v6, 1, v2
    v_lshl_add_u32 v107, v6, 5, v107
    v_lshrrev_b32 v6, 1, v2
    v_lshl_add_u32 v107, v6, 4, v107
    v_add_u32 v107, s31, v107
    s_waitcnt lgkmcnt(0)
    v_mfma_f32_16x16x32_bf16 v[144:147], v[112:115], v[72:75], 0
    v_mfma_f32_16x16x32_bf16 v[148:151], v[120:123], v[72:75], 0
    v_mfma_f32_16x16x32_bf16 v[12:15], v[128:131], v[72:75], 0
    v_mfma_f32_16x16x32_bf16 v[152:155], v[112:115], v[80:83], 0
    v_mfma_f32_16x16x32_bf16 v[156:159], v[120:123], v[80:83], 0
    v_mfma_f32_16x16x32_bf16 v[16:19], v[128:131], v[80:83], 0
    v_mfma_f32_16x16x32_bf16 v[160:163], v[112:115], v[88:91], 0
    v_mfma_f32_16x16x32_bf16 v[164:167], v[120:123], v[88:91], 0
    v_mfma_f32_16x16x32_bf16 v[20:23], v[128:131], v[88:91], 0
    v_mfma_f32_16x16x32_bf16 v[168:171], v[112:115], v[96:99], 0
    v_mfma_f32_16x16x32_bf16 v[172:175], v[120:123], v[96:99], 0
    v_mfma_f32_16x16x32_bf16 v[24:27], v[128:131], v[96:99], 0
    v_mfma_f32_16x16x32_bf16 v[144:147], v[116:119], v[76:79], v[144:147]
    v_mfma_f32_16x16x32_bf16 v[148:151], v[124:127], v[76:79], v[148:151]
    v_mfma_f32_16x16x32_bf16 v[12:15], v[132:135], v[76:79], v[12:15]
    v_mfma_f32_16x16x32_bf16 v[152:155], v[116:119], v[84:87], v[152:155]
    v_mfma_f32_16x16x32_bf16 v[156:159], v[124:127], v[84:87], v[156:159]
    v_mfma_f32_16x16x32_bf16 v[16:19], v[132:135], v[84:87], v[16:19]
    v_mfma_f32_16x16x32_bf16 v[160:163], v[116:119], v[92:95], v[160:163]
    v_mfma_f32_16x16x32_bf16 v[164:167], v[124:127], v[92:95], v[164:167]
    v_mfma_f32_16x16x32_bf16 v[20:23], v[132:135], v[92:95], v[20:23]
    v_mfma_f32_16x16x32_bf16 v[168:171], v[116:119], v[100:103], v[168:171]
    v_mfma_f32_16x16x32_bf16 v[172:175], v[124:127], v[100:103], v[172:175]
    v_mfma_f32_16x16x32_bf16 v[24:27], v[132:135], v[100:103], v[24:27]
    v_cvt_pk_bf16_f32 v12, v12, v12
    v_lshlrev_b32 v12, 16, v12
    v_add_f32 v12, 0x358637bd, v12
    v_cvt_pk_bf16_f32 v12, v12, v12
    v_lshlrev_b32 v12, 16, v12
    v_rcp_f32 v12, v12
    v_cvt_pk_bf16_f32 v16, v16, v16
    v_lshlrev_b32 v16, 16, v16
    v_add_f32 v16, 0x358637bd, v16
    v_cvt_pk_bf16_f32 v16, v16, v16
    v_lshlrev_b32 v16, 16, v16
    v_rcp_f32 v16, v16
    v_cvt_pk_bf16_f32 v20, v20, v20
    v_lshlrev_b32 v20, 16, v20
    v_add_f32 v20, 0x358637bd, v20
    v_cvt_pk_bf16_f32 v20, v20, v20
    v_lshlrev_b32 v20, 16, v20
    v_rcp_f32 v20, v20
    v_cvt_pk_bf16_f32 v24, v24, v24
    v_lshlrev_b32 v24, 16, v24
    v_add_f32 v24, 0x358637bd, v24
    v_cvt_pk_bf16_f32 v24, v24, v24
    v_lshlrev_b32 v24, 16, v24
    v_rcp_f32 v24, v24
    v_cvt_pk_bf16_f32 v232, v144, v145
    v_cvt_pk_bf16_f32 v233, v146, v147
    v_lshlrev_b32 v144, 16, v232
    v_and_b32 v145, 0xffff0000, v232
    v_lshlrev_b32 v146, 16, v233
    v_and_b32 v147, 0xffff0000, v233
    v_mul_f32 v144, v144, v12
    v_mul_f32 v145, v145, v12
    v_mul_f32 v146, v146, v12
    v_mul_f32 v147, v147, v12
    v_cvt_pk_bf16_f32 v232, v148, v149
    v_cvt_pk_bf16_f32 v233, v150, v151
    v_lshlrev_b32 v148, 16, v232
    v_and_b32 v149, 0xffff0000, v232
    v_lshlrev_b32 v150, 16, v233
    v_and_b32 v151, 0xffff0000, v233
    v_mul_f32 v148, v148, v12
    v_mul_f32 v149, v149, v12
    v_mul_f32 v150, v150, v12
    v_mul_f32 v151, v151, v12
    v_cvt_pk_bf16_f32 v144, v144, v145
    v_cvt_pk_bf16_f32 v145, v146, v147
    v_cvt_pk_bf16_f32 v146, v148, v149
    v_cvt_pk_bf16_f32 v147, v150, v151
    s_nop 0
    v_permlane16_swap_b32 v144, v146
    v_permlane16_swap_b32 v145, v147
    buffer_store_dwordx4 v[144:147], v107, s[24:27], 0 offen offset:0 sc0 sc1
    v_cvt_pk_bf16_f32 v232, v152, v153
    v_cvt_pk_bf16_f32 v233, v154, v155
    v_lshlrev_b32 v152, 16, v232
    v_and_b32 v153, 0xffff0000, v232
    v_lshlrev_b32 v154, 16, v233
    v_and_b32 v155, 0xffff0000, v233
    v_mul_f32 v152, v152, v16
    v_mul_f32 v153, v153, v16
    v_mul_f32 v154, v154, v16
    v_mul_f32 v155, v155, v16
    v_cvt_pk_bf16_f32 v232, v156, v157
    v_cvt_pk_bf16_f32 v233, v158, v159
    v_lshlrev_b32 v156, 16, v232
    v_and_b32 v157, 0xffff0000, v232
    v_lshlrev_b32 v158, 16, v233
    v_and_b32 v159, 0xffff0000, v233
    v_mul_f32 v156, v156, v16
    v_mul_f32 v157, v157, v16
    v_mul_f32 v158, v158, v16
    v_mul_f32 v159, v159, v16
    v_cvt_pk_bf16_f32 v152, v152, v153
    v_cvt_pk_bf16_f32 v153, v154, v155
    v_cvt_pk_bf16_f32 v154, v156, v157
    v_cvt_pk_bf16_f32 v155, v158, v159
    s_nop 0
    v_permlane16_swap_b32 v152, v154
    v_permlane16_swap_b32 v153, v155
    buffer_store_dwordx4 v[152:155], v107, s[24:27], 0 offen offset:1024 sc0 sc1
    v_cvt_pk_bf16_f32 v232, v160, v161
    v_cvt_pk_bf16_f32 v233, v162, v163
    v_lshlrev_b32 v160, 16, v232
    v_and_b32 v161, 0xffff0000, v232
    v_lshlrev_b32 v162, 16, v233
    v_and_b32 v163, 0xffff0000, v233
    v_mul_f32 v160, v160, v20
    v_mul_f32 v161, v161, v20
    v_mul_f32 v162, v162, v20
    v_mul_f32 v163, v163, v20
    v_cvt_pk_bf16_f32 v232, v164, v165
    v_cvt_pk_bf16_f32 v233, v166, v167
    v_lshlrev_b32 v164, 16, v232
    v_and_b32 v165, 0xffff0000, v232
    v_lshlrev_b32 v166, 16, v233
    v_and_b32 v167, 0xffff0000, v233
    v_mul_f32 v164, v164, v20
    v_mul_f32 v165, v165, v20
    v_mul_f32 v166, v166, v20
    v_mul_f32 v167, v167, v20
    v_cvt_pk_bf16_f32 v160, v160, v161
    v_cvt_pk_bf16_f32 v161, v162, v163
    v_cvt_pk_bf16_f32 v162, v164, v165
    v_cvt_pk_bf16_f32 v163, v166, v167
    s_nop 0
    v_permlane16_swap_b32 v160, v162
    v_permlane16_swap_b32 v161, v163
    buffer_store_dwordx4 v[160:163], v107, s[24:27], 0 offen offset:2048 sc0 sc1
    v_cvt_pk_bf16_f32 v232, v168, v169
    v_cvt_pk_bf16_f32 v233, v170, v171
    v_lshlrev_b32 v168, 16, v232
    v_and_b32 v169, 0xffff0000, v232
    v_lshlrev_b32 v170, 16, v233
    v_and_b32 v171, 0xffff0000, v233
    v_mul_f32 v168, v168, v24
    v_mul_f32 v169, v169, v24
    v_mul_f32 v170, v170, v24
    v_mul_f32 v171, v171, v24
    v_cvt_pk_bf16_f32 v232, v172, v173
    v_cvt_pk_bf16_f32 v233, v174, v175
    v_lshlrev_b32 v172, 16, v232
    v_and_b32 v173, 0xffff0000, v232
    v_lshlrev_b32 v174, 16, v233
    v_and_b32 v175, 0xffff0000, v233
    v_mul_f32 v172, v172, v24
    v_mul_f32 v173, v173, v24
    v_mul_f32 v174, v174, v24
    v_mul_f32 v175, v175, v24
    v_cvt_pk_bf16_f32 v168, v168, v169
    v_cvt_pk_bf16_f32 v169, v170, v171
    v_cvt_pk_bf16_f32 v170, v172, v173
    v_cvt_pk_bf16_f32 v171, v174, v175
    s_nop 0
    v_permlane16_swap_b32 v168, v170
    v_permlane16_swap_b32 v169, v171
    buffer_store_dwordx4 v[168:171], v107, s[24:27], 0 offen offset:3072 sc0 sc1
    s_lshl_b32 s32, s29, 9
    s_lshl_b32 s33, s30, 4
    s_add_u32 s32, s32, s33
    s_lshl_b32 s33, s41, 2
    s_add_u32 s32, s32, s33
    s_add_u32 s32, s32, 32509952
    v_mov_b32 v107, 0x80000000
    v_mov_b32 v105, s32
    v_cmp_eq_u32 vcc, 0, v0
    s_nop 1
    v_cndmask_b32 v107, v107, v105, vcc
    v_mov_b32 v105, s65
    s_waitcnt vmcnt(0)
    buffer_store_dword v105, v107, s[24:27], 0 offen sc0 sc1
    s_and_b32 s31, s2, 7
    s_lshr_b32 s32, s2, 3
    s_lshr_b32 s33, s31, 1
    s_and_b32 s34, s31, 1
    s_mul_i32 s29, s32, 8193
    s_lshr_b32 s29, s29, 16
    s_mul_i32 s30, s29, 8
    s_sub_u32 s30, s32, s30
    s_mul_i32 s33, s33, 4
    s_add_u32 s29, s29, s33
    s_mul_i32 s34, s34, 8
    s_add_u32 s30, s30, s34
    s_lshr_b32 s35, s29, 1
    s_lshl_b32 s35, s35, 19
    s_and_b32 s36, s29, 1
    s_lshl_b32 s36, s36, 13
    s_add_u32 s35, s35, s36
    s_add_u32 s4, s62, s35
    s_addc_u32 s5, s63, 0
    s_add_u32 s4, s4, 4194304
    s_addc_u32 s5, s5, 0
    s_sub_u32 s6, 4194304, s35
    s_mov_b32 s7, 0x20000
    s_lshl_b32 s35, s30, 7
    s_add_u32 s8, s50, s35
    s_addc_u32 s9, s51, 0
    s_sub_u32 s10, 2097152, s35
    s_mov_b32 s11, 0x20000
    s_sub_u32 s41, s28, 4
    v_lshrrev_b32 v1, 3, v0
    s_lshl_b32 s31, s41, 3
    v_add_u32 v1, s31, v1
    s_mov_b32 s31, 64
    v_mul_lo_u32 v1, v1, s31
    v_bfe_u32 v2, v0, 4, 2
    s_and_b32 s32, s41, 1
    s_lshl_b32 s33, s32, 2
    v_add_u32 v2, s33, v2
    v_and_b32 v3, 7, v0
    v_xor_b32 v2, v2, v3
    v_and_b32 v3, 3, v2
    v_lshl_add_u32 v1, v3, 4, v1
    v_lshrrev_b32 v2, 2, v2
    v_mul_u32_u24 v2, 16384, v2
    v_add_u32 v4, v2, v1
    v_add_u32 v5, 2048, v4
    v_add_u32 v6, 4096, v4
    v_add_u32 v7, 6144, v4
    s_mov_b32 s31, 2048
    v_lshrrev_b32 v1, 5, v0
    v_lshlrev_b32 v1, 2, v1
    v_bfe_u32 v2, v0, 2, 2
    v_add_u32 v1, v1, v2
    s_lshl_b32 s33, s41, 3
    v_add_u32 v1, s33, v1
    v_mul_lo_u32 v1, v1, s31
    v_and_b32 v2, 3, v0
    s_lshl_b32 s33, s32, 1
    v_xor_b32 v2, s33, v2
    v_lshlrev_b32 v2, 4, v2
    v_bfe_u32 v3, v0, 4, 1
    v_lshl_add_u32 v2, v3, 6, v2
    v_add_u32 v10, v1, v2
    v_add_u32 v8, 0, v10
    v_add_u32 v9, 65536, v10
    s_mov_b32 s39, 0
    s_mov_b32 s40, 0
    s_lshl_b32 s37, s41, 10
    s_mov_b32 s31, 0
    s_add_u32 m0, s37, 16384
    s_nop 0
    buffer_load_dwordx4 v8, s[8:11], s31 offen lds
    s_add_u32 m0, s37, 20480
    s_nop 0
    buffer_load_dwordx4 v9, s[8:11], s31 offen lds
    s_mov_b32 s31, 131072
    s_add_u32 m0, s37, 40960
    s_nop 0
    buffer_load_dwordx4 v8, s[8:11], s31 offen lds
    s_add_u32 m0, s37, 45056
    s_nop 0
    buffer_load_dwordx4 v9, s[8:11], s31 offen lds
    s_mov_b32 s31, 262144
    s_add_u32 m0, s37, 65536
    s_nop 0
    buffer_load_dwordx4 v8, s[8:11], s31 offen lds
    s_add_u32 m0, s37, 69632
    s_nop 0
    buffer_load_dwordx4 v9, s[8:11], s31 offen lds
    s_lshr_b32 s32, s29, 1
    s_lshl_b32 s32, s32, 9
    s_add_u32 s32, s32, 32509952
    s_mov_b32 s99, s32
    s_mov_b32 s96, 0
    s_mov_b32 s98, 0
    v_lshl_add_u32 v30, v0, 3, s99
    v_mov_b32 v31, 161832
    s_waitcnt vmcnt(0)
    s_lshl_b32 s97, s98, 2
    s_add_u32 s97, s97, 4
    s_add_u32 s98, s98, 1
    s_cmp_ge_u32 s96, s97
    s_cbranch_scc1 pe_5006_ok
    s_mov_b32 s79, 40000
    s_cmp_lg_u32 s41, 0
    s_cbranch_scc1 pe_5006_w
pe_5006_p:
    buffer_load_dwordx2 v[32:33], v30, s[24:27], 0 offen sc0 sc1
    s_waitcnt vmcnt(0)
    v_xor_b32 v32, s65, v32
    v_xor_b32 v33, s65, v33
    v_or_b32 v32, v32, v33
    v_cmp_ne_u32 vcc, 0, v32
    s_nop 2
    s_ff1_i32_b64 s96, vcc
    v_mov_b32 v32, s96
    ds_write_b32 v31, v32
    s_waitcnt lgkmcnt(0)
    s_cmp_ge_u32 s96, s97
    s_cbranch_scc1 pe_5006_ok
    s_sleep 6
    s_sub_u32 s79, s79, 1
    s_cmp_lg_u32 s79, 0
    s_cbranch_scc1 pe_5006_p
    s_branch pe_5006_ok
pe_5006_w:
    s_mov_b32 s79, 640000
pe_5006_l:
    ds_read_b32 v32, v31
    s_waitcnt lgkmcnt(0)
    v_readfirstlane_b32 s96, v32
    s_nop 2
    s_cmp_ge_u32 s96, s97
    s_cbranch_scc1 pe_5006_ok
    s_sleep 1
    s_sub_u32 s79, s79, 1
    s_cmp_lg_u32 s79, 0
    s_cbranch_scc1 pe_5006_l
pe_5006_ok:
    s_mov_b32 s31, 0
    s_add_u32 m0, s37, 0
    s_nop 0
    buffer_load_dwordx4 v4, s[4:7], s31 offen lds
    s_add_u32 m0, s37, 4096
    s_nop 0
    buffer_load_dwordx4 v5, s[4:7], s31 offen lds
    s_add_u32 m0, s37, 8192
    s_nop 0
    buffer_load_dwordx4 v6, s[4:7], s31 offen lds
    s_add_u32 m0, s37, 12288
    s_nop 0
    buffer_load_dwordx4 v7, s[4:7], s31 offen lds
    s_lshl_b32 s97, s98, 2
    s_add_u32 s97, s97, 4
    s_add_u32 s98, s98, 1
    s_cmp_ge_u32 s96, s97
    s_cbranch_scc1 pe_5007_ok
    s_mov_b32 s79, 40000
    s_cmp_lg_u32 s41, 0
    s_cbranch_scc1 pe_5007_w
pe_5007_p:
    buffer_load_dwordx2 v[32:33], v30, s[24:27], 0 offen sc0 sc1
    s_waitcnt vmcnt(0)
    v_xor_b32 v32, s65, v32
    v_xor_b32 v33, s65, v33
    v_or_b32 v32, v32, v33
    v_cmp_ne_u32 vcc, 0, v32
    s_nop 2
    s_ff1_i32_b64 s96, vcc
    v_mov_b32 v32, s96
    ds_write_b32 v31, v32
    s_waitcnt lgkmcnt(0)
    s_cmp_ge_u32 s96, s97
    s_cbranch_scc1 pe_5007_ok
    s_sleep 6
    s_sub_u32 s79, s79, 1
    s_cmp_lg_u32 s79, 0
    s_cbranch_scc1 pe_5007_p
    s_branch pe_5007_ok
pe_5007_w:
    s_mov_b32 s79, 640000
pe_5007_l:
    ds_read_b32 v32, v31
    s_waitcnt lgkmcnt(0)
    v_readfirstlane_b32 s96, v32
    s_nop 2
    s_cmp_ge_u32 s96, s97
    s_cbranch_scc1 pe_5007_ok
    s_sleep 1
    s_sub_u32 s79, s79, 1
    s_cmp_lg_u32 s79, 0
    s_cbranch_scc1 pe_5007_l
pe_5007_ok:
    s_mov_b32 s31, 32768
    s_add_u32 m0, s37, 24576
    s_nop 0
    buffer_load_dwordx4 v4, s[4:7], s31 offen lds
    s_add_u32 m0, s37, 28672
    s_nop 0
    buffer_load_dwordx4 v5, s[4:7], s31 offen lds
    s_add_u32 m0, s37, 32768
    s_nop 0
    buffer_load_dwordx4 v6, s[4:7], s31 offen lds
    s_add_u32 m0, s37, 36864
    s_nop 0
    buffer_load_dwordx4 v7, s[4:7], s31 offen lds
    s_lshl_b32 s97, s98, 2
    s_add_u32 s97, s97, 4
    s_add_u32 s98, s98, 1
    s_cmp_ge_u32 s96, s97
    s_cbranch_scc1 pe_5008_ok
    s_mov_b32 s79, 40000
    s_cmp_lg_u32 s41, 0
    s_cbranch_scc1 pe_5008_w
pe_5008_p:
    buffer_load_dwordx2 v[32:33], v30, s[24:27], 0 offen sc0 sc1
    s_waitcnt vmcnt(0)
    v_xor_b32 v32, s65, v32
    v_xor_b32 v33, s65, v33
    v_or_b32 v32, v32, v33
    v_cmp_ne_u32 vcc, 0, v32
    s_nop 2
    s_ff1_i32_b64 s96, vcc
    v_mov_b32 v32, s96
    ds_write_b32 v31, v32
    s_waitcnt lgkmcnt(0)
    s_cmp_ge_u32 s96, s97
    s_cbranch_scc1 pe_5008_ok
    s_sleep 6
    s_sub_u32 s79, s79, 1
    s_cmp_lg_u32 s79, 0
    s_cbranch_scc1 pe_5008_p
    s_branch pe_5008_ok
pe_5008_w:
    s_mov_b32 s79, 640000
pe_5008_l:
    ds_read_b32 v32, v31
    s_waitcnt lgkmcnt(0)
    v_readfirstlane_b32 s96, v32
    s_nop 2
    s_cmp_ge_u32 s96, s97
    s_cbranch_scc1 pe_5008_ok
    s_sleep 1
    s_sub_u32 s79, s79, 1
    s_cmp_lg_u32 s79, 0
    s_cbranch_scc1 pe_5008_l
pe_5008_ok:
    s_mov_b32 s31, 65536
    s_add_u32 m0, s37, 49152
    s_nop 0
    buffer_load_dwordx4 v4, s[4:7], s31 offen lds
    s_add_u32 m0, s37, 53248
    s_nop 0
    buffer_load_dwordx4 v5, s[4:7], s31 offen lds
    s_add_u32 m0, s37, 57344
    s_nop 0
    buffer_load_dwordx4 v6, s[4:7], s31 offen lds
    s_add_u32 m0, s37, 61440
    s_nop 0
    buffer_load_dwordx4 v7, s[4:7], s31 offen lds
    s_mov_b32 s39, 98304
    s_mov_b32 s40, 393216
    s_waitcnt vmcnt(8)
    s_barrier
    s_lshl_b32 s97, s98, 2
    s_add_u32 s97, s97, 4
    s_add_u32 s98, s98, 1
    s_cmp_ge_u32 s96, s97
    s_cbranch_scc1 pe_5009_ok
    s_mov_b32 s79, 40000
    s_cmp_lg_u32 s41, 0
    s_cbranch_scc1 pe_5009_w
pe_5009_p:
    buffer_load_dwordx2 v[32:33], v30, s[24:27], 0 offen sc0 sc1
    s_waitcnt vmcnt(0)
    v_xor_b32 v32, s65, v32
    v_xor_b32 v33, s65, v33
    v_or_b32 v32, v32, v33
    v_cmp_ne_u32 vcc, 0, v32
    s_nop 2
    s_ff1_i32_b64 s96, vcc
    v_mov_b32 v32, s96
    ds_write_b32 v31, v32
    s_waitcnt lgkmcnt(0)
    s_cmp_ge_u32 s96, s97
    s_cbranch_scc1 pe_5009_ok
    s_sleep 6
    s_sub_u32 s79, s79, 1
    s_cmp_lg_u32 s79, 0
    s_cbranch_scc1 pe_5009_p
    s_branch pe_5009_ok
pe_5009_w:
    s_mov_b32 s79, 640000
pe_5009_l:
    ds_read_b32 v32, v31
    s_waitcnt lgkmcnt(0)
    v_readfirstlane_b32 s96, v32
    s_nop 2
    s_cmp_ge_u32 s96, s97
    s_cbranch_scc1 pe_5009_ok
    s_sleep 1
    s_sub_u32 s79, s79, 1
    s_cmp_lg_u32 s79, 0
    s_cbranch_scc1 pe_5009_l
pe_5009_ok:
    s_add_u32 m0, s37, 73728
    s_nop 0
    buffer_load_dwordx4 v4, s[4:7], s39 offen lds
    s_add_u32 s70, s39, 32768
    s_add_u32 s71, s40, 131072
    s_add_u32 m0, s37, 77824
    s_nop 0
    buffer_load_dwordx4 v5, s[4:7], s39 offen lds
    s_add_u32 m0, s37, 81920
    s_nop 0
    buffer_load_dwordx4 v6, s[4:7], s39 offen lds
    s_add_u32 m0, s37, 86016
    s_nop 0
    buffer_load_dwordx4 v7, s[4:7], s39 offen lds
    s_add_u32 m0, s37, 90112
    s_nop 0
    buffer_load_dwordx4 v8, s[8:11], s40 offen lds
    s_add_u32 m0, s37, 94208
    s_nop 0
    buffer_load_dwordx4 v9, s[8:11], s40 offen lds
    s_waitcnt vmcnt(10)
    s_barrier
    s_lshl_b32 s97, s98, 2
    s_add_u32 s97, s97, 4
    s_add_u32 s98, s98, 1
    s_cmp_ge_u32 s96, s97
    s_cbranch_scc1 pe_5010_ok
    s_mov_b32 s79, 40000
    s_cmp_lg_u32 s41, 0
    s_cbranch_scc1 pe_5010_w
pe_5010_p:
    buffer_load_dwordx2 v[32:33], v30, s[24:27], 0 offen sc0 sc1
    s_waitcnt vmcnt(0)
    v_xor_b32 v32, s65, v32
    v_xor_b32 v33, s65, v33
    v_or_b32 v32, v32, v33
    v_cmp_ne_u32 vcc, 0, v32
    s_nop 2
    s_ff1_i32_b64 s96, vcc
    v_mov_b32 v32, s96
    ds_write_b32 v31, v32
    s_waitcnt lgkmcnt(0)
    s_cmp_ge_u32 s96, s97
    s_cbranch_scc1 pe_5010_ok
    s_sleep 6
    s_sub_u32 s79, s79, 1
    s_cmp_lg_u32 s79, 0
    s_cbranch_scc1 pe_5010_p
    s_branch pe_5010_ok
pe_5010_w:
    s_mov_b32 s79, 640000
pe_5010_l:
    ds_read_b32 v32, v31
    s_waitcnt lgkmcnt(0)
    v_readfirstlane_b32 s96, v32
    s_nop 2
    s_cmp_ge_u32 s96, s97
    s_cbranch_scc1 pe_5010_ok
    s_sleep 1
    s_sub_u32 s79, s79, 1
    s_cmp_lg_u32 s79, 0
    s_cbranch_scc1 pe_5010_l
pe_5010_ok:
    s_add_u32 m0, s37, 0
    s_nop 0
    buffer_load_dwordx4 v4, s[4:7], s70 offen lds
    s_add_u32 s39, s70, 32768
    s_add_u32 s40, s71, 131072
    s_add_u32 m0, s37, 4096
    s_nop 0
    buffer_load_dwordx4 v5, s[4:7], s70 offen lds
    s_add_u32 m0, s37, 8192
    s_nop 0
    buffer_load_dwordx4 v6, s[4:7], s70 offen lds
    s_add_u32 m0, s37, 12288
    s_nop 0
    buffer_load_dwordx4 v7, s[4:7], s70 offen lds
    s_add_u32 m0, s37, 16384
    s_nop 0
    buffer_load_dwordx4 v8, s[8:11], s71 offen lds
    s_add_u32 m0, s37, 20480
    s_nop 0
    buffer_load_dwordx4 v9, s[8:11], s71 offen lds
    s_waitcnt vmcnt(12)
    s_barrier
    s_lshl_b32 s97, s98, 2
    s_add_u32 s97, s97, 4
    s_add_u32 s98, s98, 1
    s_cmp_ge_u32 s96, s97
    s_cbranch_scc1 pe_5011_ok
    s_mov_b32 s79, 40000
    s_cmp_lg_u32 s41, 0
    s_cbranch_scc1 pe_5011_w
pe_5011_p:
    buffer_load_dwordx2 v[32:33], v30, s[24:27], 0 offen sc0 sc1
    s_waitcnt vmcnt(0)
    v_xor_b32 v32, s65, v32
    v_xor_b32 v33, s65, v33
    v_or_b32 v32, v32, v33
    v_cmp_ne_u32 vcc, 0, v32
    s_nop 2
    s_ff1_i32_b64 s96, vcc
    v_mov_b32 v32, s96
    ds_write_b32 v31, v32
    s_waitcnt lgkmcnt(0)
    s_cmp_ge_u32 s96, s97
    s_cbranch_scc1 pe_5011_ok
    s_sleep 6
    s_sub_u32 s79, s79, 1
    s_cmp_lg_u32 s79, 0
    s_cbranch_scc1 pe_5011_p
    s_branch pe_5011_ok
pe_5011_w:
    s_mov_b32 s79, 640000
pe_5011_l:
    ds_read_b32 v32, v31
    s_waitcnt lgkmcnt(0)
    v_readfirstlane_b32 s96, v32
    s_nop 2
    s_cmp_ge_u32 s96, s97
    s_cbranch_scc1 pe_5011_ok
    s_sleep 1
    s_sub_u32 s79, s79, 1
    s_cmp_lg_u32 s79, 0
    s_cbranch_scc1 pe_5011_l
pe_5011_ok:
    s_add_u32 m0, s37, 24576
    s_nop 0
    buffer_load_dwordx4 v4, s[4:7], s39 offen lds
    s_add_u32 s70, s39, 32768
    s_add_u32 s71, s40, 131072
    s_add_u32 m0, s37, 28672
    s_nop 0
    buffer_load_dwordx4 v5, s[4:7], s39 offen lds
    s_add_u32 m0, s37, 32768
    s_nop 0
    buffer_load_dwordx4 v6, s[4:7], s39 offen lds
    s_add_u32 m0, s37, 36864
    s_nop 0
    buffer_load_dwordx4 v7, s[4:7], s39 offen lds
    s_add_u32 m0, s37, 40960
    s_nop 0
    buffer_load_dwordx4 v8, s[8:11], s40 offen lds
    s_add_u32 m0, s37, 45056
    s_nop 0
    buffer_load_dwordx4 v9, s[8:11], s40 offen lds
    s_mov_b32 s38, 2
p2_lloop:
    s_waitcnt vmcnt(12)
    s_barrier
    s_lshl_b32 s97, s98, 2
    s_add_u32 s97, s97, 4
    s_add_u32 s98, s98, 1
    s_cmp_ge_u32 s96, s97
    s_cbranch_scc1 pe_5012_ok
    s_mov_b32 s79, 40000
    s_cmp_lg_u32 s41, 0
    s_cbranch_scc1 pe_5012_w
pe_5012_p:
    buffer_load_dwordx2 v[32:33], v30, s[24:27], 0 offen sc0 sc1
    s_waitcnt vmcnt(0)
    v_xor_b32 v32, s65, v32
    v_xor_b32 v33, s65, v33
    v_or_b32 v32, v32, v33
    v_cmp_ne_u32 vcc, 0, v32
    s_nop 2
    s_ff1_i32_b64 s96, vcc
    v_mov_b32 v32, s96
    ds_write_b32 v31, v32
    s_waitcnt lgkmcnt(0)
    s_cmp_ge_u32 s96, s97
    s_cbranch_scc1 pe_5012_ok
    s_sleep 6
    s_sub_u32 s79, s79, 1
    s_cmp_lg_u32 s79, 0
    s_cbranch_scc1 pe_5012_p
    s_branch pe_5012_ok
pe_5012_w:
    s_mov_b32 s79, 640000
pe_5012_l:
    ds_read_b32 v32, v31
    s_waitcnt lgkmcnt(0)
    v_readfirstlane_b32 s96, v32
    s_nop 2
    s_cmp_ge_u32 s96, s97
    s_cbranch_scc1 pe_5012_ok
    s_sleep 1
    s_sub_u32 s79, s79, 1
    s_cmp_lg_u32 s79, 0
    s_cbranch_scc1 pe_5012_l
pe_5012_ok:
    s_add_u32 m0, s37, 49152
    s_nop 0
    buffer_load_dwordx4 v4, s[4:7], s70 offen lds
    s_add_u32 s39, s70, 32768
    s_add_u32 s40, s71, 131072
    s_add_u32 m0, s37, 53248
    s_nop 0
    buffer_load_dwordx4 v5, s[4:7], s70 offen lds
    s_add_u32 m0, s37, 57344
    s_nop 0
    buffer_load_dwordx4 v6, s[4:7], s70 offen lds
    s_add_u32 m0, s37, 61440
    s_nop 0
    buffer_load_dwordx4 v7, s[4:7], s70 offen lds
    s_add_u32 m0, s37, 65536
    s_nop 0
    buffer_load_dwordx4 v8, s[8:11], s71 offen lds
    s_add_u32 m0, s37, 69632
    s_nop 0
    buffer_load_dwordx4 v9, s[8:11], s71 offen lds
    s_waitcnt vmcnt(12)
    s_barrier
    s_lshl_b32 s97, s98, 2
    s_add_u32 s97, s97, 4
    s_add_u32 s98, s98, 1
    s_cmp_ge_u32 s96, s97
    s_cbranch_scc1 pe_5013_ok
    s_mov_b32 s79, 40000
    s_cmp_lg_u32 s41, 0
    s_cbranch_scc1 pe_5013_w
pe_5013_p:
    buffer_load_dwordx2 v[32:33], v30, s[24:27], 0 offen sc0 sc1
    s_waitcnt vmcnt(0)
    v_xor_b32 v32, s65, v32
    v_xor_b32 v33, s65, v33
    v_or_b32 v32, v32, v33
    v_cmp_ne_u32 vcc, 0, v32
    s_nop 2
    s_ff1_i32_b64 s96, vcc
    v_mov_b32 v32, s96
    ds_write_b32 v31, v32
    s_waitcnt lgkmcnt(0)
    s_cmp_ge_u32 s96, s97
    s_cbranch_scc1 pe_5013_ok
    s_sleep 6
    s_sub_u32 s79, s79, 1
    s_cmp_lg_u32 s79, 0
    s_cbranch_scc1 pe_5013_p
    s_branch pe_5013_ok
pe_5013_w:
    s_mov_b32 s79, 640000
pe_5013_l:
    ds_read_b32 v32, v31
    s_waitcnt lgkmcnt(0)
    v_readfirstlane_b32 s96, v32
    s_nop 2
    s_cmp_ge_u32 s96, s97
    s_cbranch_scc1 pe_5013_ok
    s_sleep 1
    s_sub_u32 s79, s79, 1
    s_cmp_lg_u32 s79, 0
    s_cbranch_scc1 pe_5013_l
pe_5013_ok:
    s_add_u32 m0, s37, 73728
    s_nop 0
    buffer_load_dwordx4 v4, s[4:7], s39 offen lds
    s_add_u32 s70, s39, 32768
    s_add_u32 s71, s40, 131072
    s_add_u32 m0, s37, 77824
    s_nop 0
    buffer_load_dwordx4 v5, s[4:7], s39 offen lds
    s_add_u32 m0, s37, 81920
    s_nop 0
    buffer_load_dwordx4 v6, s[4:7], s39 offen lds
    s_add_u32 m0, s37, 86016
    s_nop 0
    buffer_load_dwordx4 v7, s[4:7], s39 offen lds
    s_add_u32 m0, s37, 90112
    s_nop 0
    buffer_load_dwordx4 v8, s[8:11], s40 offen lds
    s_add_u32 m0, s37, 94208
    s_nop 0
    buffer_load_dwordx4 v9, s[8:11], s40 offen lds
    s_waitcnt vmcnt(12)
    s_barrier
    s_lshl_b32 s97, s98, 2
    s_add_u32 s97, s97, 4
    s_add_u32 s98, s98, 1
    s_cmp_ge_u32 s96, s97
    s_cbranch_scc1 pe_5014_ok
    s_mov_b32 s79, 40000
    s_cmp_lg_u32 s41, 0
    s_cbranch_scc1 pe_5014_w
pe_5014_p:
    buffer_load_dwordx2 v[32:33], v30, s[24:27], 0 offen sc0 sc1
    s_waitcnt vmcnt(0)
    v_xor_b32 v32, s65, v32
    v_xor_b32 v33, s65, v33
    v_or_b32 v32, v32, v33
    v_cmp_ne_u32 vcc, 0, v32
    s_nop 2
    s_ff1_i32_b64 s96, vcc
    v_mov_b32 v32, s96
    ds_write_b32 v31, v32
    s_waitcnt lgkmcnt(0)
    s_cmp_ge_u32 s96, s97
    s_cbranch_scc1 pe_5014_ok
    s_sleep 6
    s_sub_u32 s79, s79, 1
    s_cmp_lg_u32 s79, 0
    s_cbranch_scc1 pe_5014_p
    s_branch pe_5014_ok
pe_5014_w:
    s_mov_b32 s79, 640000
pe_5014_l:
    ds_read_b32 v32, v31
    s_waitcnt lgkmcnt(0)
    v_readfirstlane_b32 s96, v32
    s_nop 2
    s_cmp_ge_u32 s96, s97
    s_cbranch_scc1 pe_5014_ok
    s_sleep 1
    s_sub_u32 s79, s79, 1
    s_cmp_lg_u32 s79, 0
    s_cbranch_scc1 pe_5014_l
pe_5014_ok:
    s_add_u32 m0, s37, 0
    s_nop 0
    buffer_load_dwordx4 v4, s[4:7], s70 offen lds
    s_add_u32 s39, s70, 32768
    s_add_u32 s40, s71, 131072
    s_add_u32 m0, s37, 4096
    s_nop 0
    buffer_load_dwordx4 v5, s[4:7], s70 offen lds
    s_add_u32 m0, s37, 8192
    s_nop 0
    buffer_load_dwordx4 v6, s[4:7], s70 offen lds
    s_add_u32 m0, s37, 12288
    s_nop 0
    buffer_load_dwordx4 v7, s[4:7], s70 offen lds
    s_add_u32 m0, s37, 16384
    s_nop 0
    buffer_load_dwordx4 v8, s[8:11], s71 offen lds
    s_add_u32 m0, s37, 20480
    s_nop 0
    buffer_load_dwordx4 v9, s[8:11], s71 offen lds
    s_waitcnt vmcnt(12)
    s_barrier
    s_lshl_b32 s97, s98, 2
    s_add_u32 s97, s97, 4
    s_add_u32 s98, s98, 1
    s_cmp_ge_u32 s96, s97
    s_cbranch_scc1 pe_5015_ok
    s_mov_b32 s79, 40000
    s_cmp_lg_u32 s41, 0
    s_cbranch_scc1 pe_5015_w
pe_5015_p:
    buffer_load_dwordx2 v[32:33], v30, s[24:27], 0 offen sc0 sc1
    s_waitcnt vmcnt(0)
    v_xor_b32 v32, s65, v32
    v_xor_b32 v33, s65, v33
    v_or_b32 v32, v32, v33
    v_cmp_ne_u32 vcc, 0, v32
    s_nop 2
    s_ff1_i32_b64 s96, vcc
    v_mov_b32 v32, s96
    ds_write_b32 v31, v32
    s_waitcnt lgkmcnt(0)
    s_cmp_ge_u32 s96, s97
    s_cbranch_scc1 pe_5015_ok
    s_sleep 6
    s_sub_u32 s79, s79, 1
    s_cmp_lg_u32 s79, 0
    s_cbranch_scc1 pe_5015_p
    s_branch pe_5015_ok
pe_5015_w:
    s_mov_b32 s79, 640000
pe_5015_l:
    ds_read_b32 v32, v31
    s_waitcnt lgkmcnt(0)
    v_readfirstlane_b32 s96, v32
    s_nop 2
    s_cmp_ge_u32 s96, s97
    s_cbranch_scc1 pe_5015_ok
    s_sleep 1
    s_sub_u32 s79, s79, 1
    s_cmp_lg_u32 s79, 0
    s_cbranch_scc1 pe_5015_l
pe_5015_ok:
    s_add_u32 m0, s37, 24576
    s_nop 0
    buffer_load_dwordx4 v4, s[4:7], s39 offen lds
    s_add_u32 s70, s39, 32768
    s_add_u32 s71, s40, 131072
    s_add_u32 m0, s37, 28672
    s_nop 0
    buffer_load_dwordx4 v5, s[4:7], s39 offen lds
    s_add_u32 m0, s37, 32768
    s_nop 0
    buffer_load_dwordx4 v6, s[4:7], s39 offen lds
    s_add_u32 m0, s37, 36864
    s_nop 0
    buffer_load_dwordx4 v7, s[4:7], s39 offen lds
    s_add_u32 m0, s37, 40960
    s_nop 0
    buffer_load_dwordx4 v8, s[8:11], s40 offen lds
    s_add_u32 m0, s37, 45056
    s_nop 0
    buffer_load_dwordx4 v9, s[8:11], s40 offen lds
    s_sub_u32 s38, s38, 1
    s_cmp_lg_u32 s38, 0
    s_cbranch_scc1 p2_lloop
    s_waitcnt vmcnt(12)
    s_barrier
    s_lshl_b32 s97, s98, 2
    s_add_u32 s97, s97, 4
    s_add_u32 s98, s98, 1
    s_cmp_ge_u32 s96, s97
    s_cbranch_scc1 pe_5016_ok
    s_mov_b32 s79, 40000
    s_cmp_lg_u32 s41, 0
    s_cbranch_scc1 pe_5016_w
pe_5016_p:
    buffer_load_dwordx2 v[32:33], v30, s[24:27], 0 offen sc0 sc1
    s_waitcnt vmcnt(0)
    v_xor_b32 v32, s65, v32
    v_xor_b32 v33, s65, v33
    v_or_b32 v32, v32, v33
    v_cmp_ne_u32 vcc, 0, v32
    s_nop 2
    s_ff1_i32_b64 s96, vcc
    v_mov_b32 v32, s96
    ds_write_b32 v31, v32
    s_waitcnt lgkmcnt(0)
    s_cmp_ge_u32 s96, s97
    s_cbranch_scc1 pe_5016_ok
    s_sleep 6
    s_sub_u32 s79, s79, 1
    s_cmp_lg_u32 s79, 0
    s_cbranch_scc1 pe_5016_p
    s_branch pe_5016_ok
pe_5016_w:
    s_mov_b32 s79, 640000
pe_5016_l:
    ds_read_b32 v32, v31
    s_waitcnt lgkmcnt(0)
    v_readfirstlane_b32 s96, v32
    s_nop 2
    s_cmp_ge_u32 s96, s97
    s_cbranch_scc1 pe_5016_ok
    s_sleep 1
    s_sub_u32 s79, s79, 1
    s_cmp_lg_u32 s79, 0
    s_cbranch_scc1 pe_5016_l
pe_5016_ok:
    s_add_u32 m0, s37, 49152
    s_nop 0
    buffer_load_dwordx4 v4, s[4:7], s70 offen lds
    s_add_u32 s39, s70, 32768
    s_add_u32 s40, s71, 131072
    s_add_u32 m0, s37, 53248
    s_nop 0
    buffer_load_dwordx4 v5, s[4:7], s70 offen lds
    s_add_u32 m0, s37, 57344
    s_nop 0
    buffer_load_dwordx4 v6, s[4:7], s70 offen lds
    s_add_u32 m0, s37, 61440
    s_nop 0
    buffer_load_dwordx4 v7, s[4:7], s70 offen lds
    s_add_u32 m0, s37, 65536
    s_nop 0
    buffer_load_dwordx4 v8, s[8:11], s71 offen lds
    s_add_u32 m0, s37, 69632
    s_nop 0
    buffer_load_dwordx4 v9, s[8:11], s71 offen lds
    s_waitcnt vmcnt(12)
    s_barrier
    s_lshl_b32 s97, s98, 2
    s_add_u32 s97, s97, 4
    s_add_u32 s98, s98, 1
    s_cmp_ge_u32 s96, s97
    s_cbranch_scc1 pe_5017_ok
    s_mov_b32 s79, 40000
    s_cmp_lg_u32 s41, 0
    s_cbranch_scc1 pe_5017_w
pe_5017_p:
    buffer_load_dwordx2 v[32:33], v30, s[24:27], 0 offen sc0 sc1
    s_waitcnt vmcnt(0)
    v_xor_b32 v32, s65, v32
    v_xor_b32 v33, s65, v33
    v_or_b32 v32, v32, v33
    v_cmp_ne_u32 vcc, 0, v32
    s_nop 2
    s_ff1_i32_b64 s96, vcc
    v_mov_b32 v32, s96
    ds_write_b32 v31, v32
    s_waitcnt lgkmcnt(0)
    s_cmp_ge_u32 s96, s97
    s_cbranch_scc1 pe_5017_ok
    s_sleep 6
    s_sub_u32 s79, s79, 1
    s_cmp_lg_u32 s79, 0
    s_cbranch_scc1 pe_5017_p
    s_branch pe_5017_ok
pe_5017_w:
    s_mov_b32 s79, 640000
pe_5017_l:
    ds_read_b32 v32, v31
    s_waitcnt lgkmcnt(0)
    v_readfirstlane_b32 s96, v32
    s_nop 2
    s_cmp_ge_u32 s96, s97
    s_cbranch_scc1 pe_5017_ok
    s_sleep 1
    s_sub_u32 s79, s79, 1
    s_cmp_lg_u32 s79, 0
    s_cbranch_scc1 pe_5017_l
pe_5017_ok:
    s_add_u32 m0, s37, 73728
    s_nop 0
    buffer_load_dwordx4 v4, s[4:7], s39 offen lds
    s_add_u32 s70, s39, 32768
    s_add_u32 s71, s40, 131072
    s_add_u32 m0, s37, 77824
    s_nop 0
    buffer_load_dwordx4 v5, s[4:7], s39 offen lds
    s_add_u32 m0, s37, 81920
    s_nop 0
    buffer_load_dwordx4 v6, s[4:7], s39 offen lds
    s_add_u32 m0, s37, 86016
    s_nop 0
    buffer_load_dwordx4 v7, s[4:7], s39 offen lds
    s_add_u32 m0, s37, 90112
    s_nop 0
    buffer_load_dwordx4 v8, s[8:11], s40 offen lds
    s_add_u32 m0, s37, 94208
    s_nop 0
    buffer_load_dwordx4 v9, s[8:11], s40 offen lds
    s_waitcnt vmcnt(12)
    s_barrier
    s_waitcnt vmcnt(6)
    s_barrier
    s_waitcnt vmcnt(0)
    s_barrier
    s_mov_b32 s16, s56
    s_mov_b32 s17, s57
    s_mov_b32 s18, 7340032
    s_mov_b32 s19, 0x20000
    s_lshl_b32 s31, s41, 6
    v_add_u32 v30, s31, v0
    v_lshlrev_b32 v30, 4, v30
    s_mul_i32 s31, s2, 28672
    buffer_load_dwordx4 v[32:35], v30, s[16:19], s31 offen
    s_add_u32 s31, s31, 4096
    buffer_load_dwordx4 v[32:35], v30, s[16:19], s31 offen
    s_add_u32 s31, s31, 4096
    buffer_load_dwordx4 v[32:35], v30, s[16:19], s31 offen
    s_add_u32 s31, s31, 4096
    buffer_load_dwordx4 v[32:35], v30, s[16:19], s31 offen
    s_add_u32 s31, s31, 4096
    buffer_load_dwordx4 v[32:35], v30, s[16:19], s31 offen
    s_add_u32 s31, s31, 4096
    buffer_load_dwordx4 v[32:35], v30, s[16:19], s31 offen
    s_add_u32 s31, s31, 4096
    buffer_load_dwordx4 v[32:35], v30, s[16:19], s31 offen
    s_add_u32 s31, s31, 4096
    s_barrier
    s_and_b32 s31, s2, 7
    s_lshr_b32 s32, s2, 3
    s_lshr_b32 s33, s31, 2
    s_and_b32 s34, s31, 3
    s_mul_i32 s29, s32, 16385
    s_lshr_b32 s29, s29, 16
    s_mul_i32 s30, s29, 4
    s_sub_u32 s30, s32, s30
    s_mul_i32 s33, s33, 8
    s_add_u32 s29, s29, s33
    s_mul_i32 s34, s34, 4
    s_add_u32 s30, s30, s34
    s_mul_i32 s35, s29, 262144
    s_add_u32 s4, s62, s35
    s_addc_u32 s5, s63, 0
    s_add_u32 s4, s4, 8388608
    s_addc_u32 s5, s5, 0
    s_sub_u32 s6, 4194304, s35
    s_mov_b32 s7, 0x20000
    s_mul_i32 s35, s30, 448
    s_add_u32 s8, s54, s35
    s_addc_u32 s9, s55, 0
    s_sub_u32 s10, 7340032, s35
    s_mov_b32 s11, 0x20000
    s_sub_u32 s41, s28, 4
    v_lshrrev_b32 v1, 3, v0
    s_lshl_b32 s31, s41, 3
    v_add_u32 v1, s31, v1
    s_mov_b32 s31, 64
    v_mul_lo_u32 v1, v1, s31
    v_bfe_u32 v2, v0, 4, 2
    s_and_b32 s32, s41, 1
    s_lshl_b32 s33, s32, 2
    v_add_u32 v2, s33, v2
    v_and_b32 v3, 7, v0
    v_xor_b32 v2, v2, v3
    v_and_b32 v3, 3, v2
    v_lshl_add_u32 v1, v3, 4, v1
    v_lshrrev_b32 v2, 2, v2
    v_mul_u32_u24 v2, 8192, v2
    v_add_u32 v4, v2, v1
    v_add_u32 v5, 2048, v4
    v_add_u32 v6, 4096, v4
    v_add_u32 v7, 6144, v4
    s_mov_b32 s31, 7168
    v_lshrrev_b32 v1, 5, v0
    v_lshlrev_b32 v1, 2, v1
    v_bfe_u32 v2, v0, 2, 2
    v_add_u32 v1, v1, v2
    s_lshl_b32 s33, s41, 3
    v_add_u32 v1, s33, v1
    v_mul_lo_u32 v1, v1, s31
    v_and_b32 v2, 3, v0
    s_lshl_b32 s33, s32, 1
    v_xor_b32 v2, s33, v2
    v_lshlrev_b32 v2, 4, v2
    v_bfe_u32 v3, v0, 4, 1
    v_lshl_add_u32 v2, v3, 6, v2
    v_add_u32 v15, v1, v2
    v_lshrrev_b32 v1, 4, v0
    v_lshlrev_b32 v1, 2, v1
    v_bfe_u32 v2, v0, 2, 2
    v_add_u32 v1, v1, v2
    s_lshl_b32 s33, s41, 4
    v_add_u32 v1, s33, v1
    v_mul_lo_u32 v1, v1, s31
    v_and_b32 v2, 3, v0
    v_lshrrev_b32 v3, 5, v0
    v_lshlrev_b32 v3, 1, v3
    v_xor_b32 v2, v2, v3
    v_lshl_add_u32 v16, v2, 4, v1
    v_add_u32 v8, 0, v15
    v_add_u32 v9, 229376, v15
    v_add_u32 v10, 128, v15
    v_add_u32 v11, 229504, v15
    v_add_u32 v12, 256, v15
    v_add_u32 v13, 229632, v15
    v_add_u32 v14, 384, v16
    s_mov_b32 s39, 0
    s_mov_b32 s40, 0
    s_lshl_b32 s37, s41, 10
    s_mov_b32 s31, 0
    s_add_u32 m0, s37, 16384
    s_nop 0
    buffer_load_dwordx4 v8, s[8:11], s31 offen lds
    s_add_u32 m0, s37, 20480
    s_nop 0
    buffer_load_dwordx4 v9, s[8:11], s31 offen lds
    s_add_u32 m0, s37, 24576
    s_nop 0
    buffer_load_dwordx4 v10, s[8:11], s31 offen lds
    s_add_u32 m0, s37, 28672
    s_nop 0
    buffer_load_dwordx4 v11, s[8:11], s31 offen lds
    s_add_u32 m0, s37, 32768
    s_nop 0
    buffer_load_dwordx4 v12, s[8:11], s31 offen lds
    s_add_u32 m0, s37, 36864
    s_nop 0
    buffer_load_dwordx4 v13, s[8:11], s31 offen lds
    s_add_u32 m0, s37, 40960
    s_nop 0
    buffer_load_dwordx4 v14, s[8:11], s31 offen lds
    s_mov_b32 s31, 458752
    s_add_u32 m0, s37, 61440
    s_nop 0
    buffer_load_dwordx4 v8, s[8:11], s31 offen lds
    s_add_u32 m0, s37, 65536
    s_nop 0
    buffer_load_dwordx4 v9, s[8:11], s31 offen lds
    s_add_u32 m0, s37, 69632
    s_nop 0
    buffer_load_dwordx4 v10, s[8:11], s31 offen lds
    s_add_u32 m0, s37, 73728
    s_nop 0
    buffer_load_dwordx4 v11, s[8:11], s31 offen lds
    s_add_u32 m0, s37, 77824
    s_nop 0
    buffer_load_dwordx4 v12, s[8:11], s31 offen lds
    s_add_u32 m0, s37, 81920
    s_nop 0
    buffer_load_dwordx4 v13, s[8:11], s31 offen lds
    s_add_u32 m0, s37, 86016
    s_nop 0
    buffer_load_dwordx4 v14, s[8:11], s31 offen lds
    s_lshl_b32 s32, s30, 8
    s_add_u32 s32, s32, 32587776
    s_cmp_lg_u32 s41, 0
    s_cbranch_scc1 pw_5018_w
    s_mov_b32 s79, 40000
    v_and_b32 v30, 63, v0
    v_lshl_add_u32 v30, v30, 2, s32
poll_5019:
    buffer_load_dword v32, v30, s[24:27], 0 offen sc0 sc1
    s_waitcnt vmcnt(0)
    v_cmp_ne_u32 vcc, s65, v32
    s_nop 2
    s_cmp_eq_u64 vcc, 0
    s_cbranch_scc1 poll_5019_ok
    s_sleep 6
    s_sub_u32 s79, s79, 1
    s_cmp_lg_u32 s79, 0
    s_cbranch_scc1 poll_5019
poll_5019_ok:
    v_mov_b32 v30, 161796
    v_mov_b32 v32, 1
    ds_write_b32 v30, v32
    s_waitcnt lgkmcnt(0)
    s_branch pw_5018_done
pw_5018_w:
    v_mov_b32 v30, 161796
    s_mov_b32 s79, 640000
pw_5018_l:
    ds_read_b32 v32, v30
    s_waitcnt lgkmcnt(0)
    v_readfirstlane_b32 s31, v32
    s_nop 2
    s_cmp_eq_u32 s31, 1
    s_cbranch_scc1 pw_5018_done
    s_sleep 1
    s_sub_u32 s79, s79, 1
    s_cmp_lg_u32 s79, 0
    s_cbranch_scc1 pw_5018_l
pw_5018_done:
    s_waitcnt vmcnt(0)
    s_lshl_b32 s31, s41, 6
    v_add_u32 v102, s31, v0
    s_mul_i32 s31, s30, 224
    v_add_u32 v103, s31, v102
    v_lshlrev_b32 v103, 2, v103
    v_add_u32 v103, 33030144, v103
    v_mov_b32 v100, 0x80000000
    v_cmp_gt_u32 vcc, 224, v102
    s_nop 1
    v_cndmask_b32 v103, v100, v103, vcc
    s_mov_b32 s31, 0
    buffer_load_dword v104, v103, s[24:27], s31 offen sc0 sc1
    s_mov_b32 s31, 14336
    buffer_load_dword v105, v103, s[24:27], s31 offen sc0 sc1
    s_mov_b32 s31, 28672
    buffer_load_dword v106, v103, s[24:27], s31 offen sc0 sc1
    s_mov_b32 s31, 43008
    buffer_load_dword v107, v103, s[24:27], s31 offen sc0 sc1
    s_mov_b32 s31, 57344
    buffer_load_dword v108, v103, s[24:27], s31 offen sc0 sc1
    s_mov_b32 s31, 71680
    buffer_load_dword v109, v103, s[24:27], s31 offen sc0 sc1
    s_mov_b32 s31, 86016
    buffer_load_dword v110, v103, s[24:27], s31 offen sc0 sc1
    s_mov_b32 s31, 100352
    buffer_load_dword v111, v103, s[24:27], s31 offen sc0 sc1
    s_mov_b32 s31, 114688
    buffer_load_dword v112, v103, s[24:27], s31 offen sc0 sc1
    s_mov_b32 s31, 129024
    buffer_load_dword v113, v103, s[24:27], s31 offen sc0 sc1
    s_mov_b32 s31, 143360
    buffer_load_dword v114, v103, s[24:27], s31 offen sc0 sc1
    s_mov_b32 s31, 157696
    buffer_load_dword v115, v103, s[24:27], s31 offen sc0 sc1
    s_mov_b32 s31, 172032
    buffer_load_dword v116, v103, s[24:27], s31 offen sc0 sc1
    s_mov_b32 s31, 186368
    buffer_load_dword v117, v103, s[24:27], s31 offen sc0 sc1
    s_mov_b32 s31, 200704
    buffer_load_dword v118, v103, s[24:27], s31 offen sc0 sc1
    s_mov_b32 s31, 215040
    buffer_load_dword v119, v103, s[24:27], s31 offen sc0 sc1
    s_mov_b32 s31, 229376
    buffer_load_dword v120, v103, s[24:27], s31 offen sc0 sc1
    s_mov_b32 s31, 243712
    buffer_load_dword v121, v103, s[24:27], s31 offen sc0 sc1
    s_mov_b32 s31, 258048
    buffer_load_dword v122, v103, s[24:27], s31 offen sc0 sc1
    s_mov_b32 s31, 272384
    buffer_load_dword v123, v103, s[24:27], s31 offen sc0 sc1
    s_mov_b32 s31, 286720
    buffer_load_dword v124, v103, s[24:27], s31 offen sc0 sc1
    s_mov_b32 s31, 301056
    buffer_load_dword v125, v103, s[24:27], s31 offen sc0 sc1
    s_mov_b32 s31, 315392
    buffer_load_dword v126, v103, s[24:27], s31 offen sc0 sc1
    s_mov_b32 s31, 329728
    buffer_load_dword v127, v103, s[24:27], s31 offen sc0 sc1
    s_mov_b32 s31, 344064
    buffer_load_dword v128, v103, s[24:27], s31 offen sc0 sc1
    s_mov_b32 s31, 358400
    buffer_load_dword v129, v103, s[24:27], s31 offen sc0 sc1
    s_mov_b32 s31, 372736
    buffer_load_dword v130, v103, s[24:27], s31 offen sc0 sc1
    s_mov_b32 s31, 387072
    buffer_load_dword v131, v103, s[24:27], s31 offen sc0 sc1
    s_mov_b32 s31, 401408
    buffer_load_dword v132, v103, s[24:27], s31 offen sc0 sc1
    s_mov_b32 s31, 415744
    buffer_load_dword v133, v103, s[24:27], s31 offen sc0 sc1
    s_mov_b32 s31, 430080
    buffer_load_dword v134, v103, s[24:27], s31 offen sc0 sc1
    s_mov_b32 s31, 444416
    buffer_load_dword v135, v103, s[24:27], s31 offen sc0 sc1
    v_lshlrev_b32 v102, 2, v102
    v_add_u32 v102, 136192, v102
    s_waitcnt vmcnt(0)
    v_add_f32 v104, v104, v105
    v_add_f32 v104, v104, v106
    v_add_f32 v104, v104, v107
    v_add_f32 v104, v104, v108
    v_add_f32 v104, v104, v109
    v_add_f32 v104, v104, v110
    v_add_f32 v104, v104, v111
    v_add_f32 v104, v104, v112
    v_add_f32 v104, v104, v113
    v_add_f32 v104, v104, v114
    v_add_f32 v104, v104, v115
    v_add_f32 v104, v104, v116
    v_add_f32 v104, v104, v117
    v_add_f32 v104, v104, v118
    v_add_f32 v104, v104, v119
    v_add_f32 v104, v104, v120
    v_add_f32 v104, v104, v121
    v_add_f32 v104, v104, v122
    v_add_f32 v104, v104, v123
    v_add_f32 v104, v104, v124
    v_add_f32 v104, v104, v125
    v_add_f32 v104, v104, v126
    v_add_f32 v104, v104, v127
    v_add_f32 v104, v104, v128
    v_add_f32 v104, v104, v129
    v_add_f32 v104, v104, v130
    v_add_f32 v104, v104, v131
    v_add_f32 v104, v104, v132
    v_add_f32 v104, v104, v133
    v_add_f32 v104, v104, v134
    v_add_f32 v104, v104, v135
    ds_write_b32 v102, v104
    s_waitcnt lgkmcnt(0)
    s_lshl_b32 s32, s29, 8
    s_add_u32 s32, s32, 32514048
    s_mov_b32 s99, s32
    s_mov_b32 s96, 0
    s_mov_b32 s98, 0
    v_and_b32 v30, 63, v0
    v_lshl_add_u32 v30, v30, 2, s99
    v_mov_b32 v31, 161836
    s_waitcnt vmcnt(0)
    s_lshl_b32 s97, s98, 2
    s_add_u32 s97, s97, 4
    s_add_u32 s98, s98, 1
    s_cmp_ge_u32 s96, s97
    s_cbranch_scc1 pe_5020_ok
    s_mov_b32 s79, 40000
    s_cmp_lg_u32 s41, 0
    s_cbranch_scc1 pe_5020_w
pe_5020_p:
    buffer_load_dword v32, v30, s[24:27], 0 offen sc0 sc1
    s_waitcnt vmcnt(0)
    v_cmp_ne_u32 vcc, s65, v32
    s_nop 2
    s_ff1_i32_b64 s96, vcc
    v_mov_b32 v32, s96
    ds_write_b32 v31, v32
    s_waitcnt lgkmcnt(0)
    s_cmp_ge_u32 s96, s97
    s_cbranch_scc1 pe_5020_ok
    s_sleep 6
    s_sub_u32 s79, s79, 1
    s_cmp_lg_u32 s79, 0
    s_cbranch_scc1 pe_5020_p
    s_branch pe_5020_ok
pe_5020_w:
    s_mov_b32 s79, 640000
pe_5020_l:
    ds_read_b32 v32, v31
    s_waitcnt lgkmcnt(0)
    v_readfirstlane_b32 s96, v32
    s_nop 2
    s_cmp_ge_u32 s96, s97
    s_cbranch_scc1 pe_5020_ok
    s_sleep 1
    s_sub_u32 s79, s79, 1
    s_cmp_lg_u32 s79, 0
    s_cbranch_scc1 pe_5020_l
pe_5020_ok:
    s_mov_b32 s31, 0
    s_add_u32 m0, s37, 0
    s_nop 0
    buffer_load_dwordx4 v4, s[4:7], s31 offen lds
    s_add_u32 m0, s37, 4096
    s_nop 0
    buffer_load_dwordx4 v5, s[4:7], s31 offen lds
    s_add_u32 m0, s37, 8192
    s_nop 0
    buffer_load_dwordx4 v6, s[4:7], s31 offen lds
    s_add_u32 m0, s37, 12288
    s_nop 0
    buffer_load_dwordx4 v7, s[4:7], s31 offen lds
    s_lshl_b32 s97, s98, 2
    s_add_u32 s97, s97, 4
    s_add_u32 s98, s98, 1
    s_cmp_ge_u32 s96, s97
    s_cbranch_scc1 pe_5021_ok
    s_mov_b32 s79, 40000
    s_cmp_lg_u32 s41, 0
    s_cbranch_scc1 pe_5021_w
pe_5021_p:
    buffer_load_dword v32, v30, s[24:27], 0 offen sc0 sc1
    s_waitcnt vmcnt(0)
    v_cmp_ne_u32 vcc, s65, v32
    s_nop 2
    s_ff1_i32_b64 s96, vcc
    v_mov_b32 v32, s96
    ds_write_b32 v31, v32
    s_waitcnt lgkmcnt(0)
    s_cmp_ge_u32 s96, s97
    s_cbranch_scc1 pe_5021_ok
    s_sleep 6
    s_sub_u32 s79, s79, 1
    s_cmp_lg_u32 s79, 0
    s_cbranch_scc1 pe_5021_p
    s_branch pe_5021_ok
pe_5021_w:
    s_mov_b32 s79, 640000
pe_5021_l:
    ds_read_b32 v32, v31
    s_waitcnt lgkmcnt(0)
    v_readfirstlane_b32 s96, v32
    s_nop 2
    s_cmp_ge_u32 s96, s97
    s_cbranch_scc1 pe_5021_ok
    s_sleep 1
    s_sub_u32 s79, s79, 1
    s_cmp_lg_u32 s79, 0
    s_cbranch_scc1 pe_5021_l
pe_5021_ok:
    s_mov_b32 s31, 16384
    s_add_u32 m0, s37, 45056
    s_nop 0
    buffer_load_dwordx4 v4, s[4:7], s31 offen lds
    s_add_u32 m0, s37, 49152
    s_nop 0
    buffer_load_dwordx4 v5, s[4:7], s31 offen lds
    s_add_u32 m0, s37, 53248
    s_nop 0
    buffer_load_dwordx4 v6, s[4:7], s31 offen lds
    s_add_u32 m0, s37, 57344
    s_nop 0
    buffer_load_dwordx4 v7, s[4:7], s31 offen lds
    s_mov_b32 s39, 32768
    s_mov_b32 s40, 917504
    s_waitcnt vmcnt(4)
    s_barrier
    s_lshl_b32 s97, s98, 2
    s_add_u32 s97, s97, 4
    s_add_u32 s98, s98, 1
    s_cmp_ge_u32 s96, s97
    s_cbranch_scc1 pe_5022_ok
    s_mov_b32 s79, 40000
    s_cmp_lg_u32 s41, 0
    s_cbranch_scc1 pe_5022_w
pe_5022_p:
    buffer_load_dword v32, v30, s[24:27], 0 offen sc0 sc1
    s_waitcnt vmcnt(0)
    v_cmp_ne_u32 vcc, s65, v32
    s_nop 2
    s_ff1_i32_b64 s96, vcc
    v_mov_b32 v32, s96
    ds_write_b32 v31, v32
    s_waitcnt lgkmcnt(0)
    s_cmp_ge_u32 s96, s97
    s_cbranch_scc1 pe_5022_ok
    s_sleep 6
    s_sub_u32 s79, s79, 1
    s_cmp_lg_u32 s79, 0
    s_cbranch_scc1 pe_5022_p
    s_branch pe_5022_ok
pe_5022_w:
    s_mov_b32 s79, 640000
pe_5022_l:
    ds_read_b32 v32, v31
    s_waitcnt lgkmcnt(0)
    v_readfirstlane_b32 s96, v32
    s_nop 2
    s_cmp_ge_u32 s96, s97
    s_cbranch_scc1 pe_5022_ok
    s_sleep 1
    s_sub_u32 s79, s79, 1
    s_cmp_lg_u32 s79, 0
    s_cbranch_scc1 pe_5022_l
pe_5022_ok:
    s_add_u32 m0, s37, 90112
    s_nop 0
    buffer_load_dwordx4 v4, s[4:7], s39 offen lds
    s_add_u32 s70, s39, 16384
    s_add_u32 s71, s40, 458752
    s_add_u32 m0, s37, 94208
    s_nop 0
    buffer_load_dwordx4 v5, s[4:7], s39 offen lds
    s_add_u32 m0, s37, 98304
    s_nop 0
    buffer_load_dwordx4 v6, s[4:7], s39 offen lds
    s_add_u32 m0, s37, 102400
    s_nop 0
    buffer_load_dwordx4 v7, s[4:7], s39 offen lds
    s_add_u32 m0, s37, 106496
    s_nop 0
    buffer_load_dwordx4 v8, s[8:11], s40 offen lds
    s_add_u32 m0, s37, 110592
    s_nop 0
    buffer_load_dwordx4 v9, s[8:11], s40 offen lds
    s_add_u32 m0, s37, 114688
    s_nop 0
    buffer_load_dwordx4 v10, s[8:11], s40 offen lds
    s_add_u32 m0, s37, 118784
    s_nop 0
    buffer_load_dwordx4 v11, s[8:11], s40 offen lds
    s_add_u32 m0, s37, 122880
    s_nop 0
    buffer_load_dwordx4 v12, s[8:11], s40 offen lds
    s_add_u32 m0, s37, 126976
    s_nop 0
    buffer_load_dwordx4 v13, s[8:11], s40 offen lds
    s_add_u32 m0, s37, 131072
    s_nop 0
    buffer_load_dwordx4 v14, s[8:11], s40 offen lds
    s_waitcnt vmcnt(11)
    s_barrier
    s_lshl_b32 s97, s98, 2
    s_add_u32 s97, s97, 4
    s_add_u32 s98, s98, 1
    s_cmp_ge_u32 s96, s97
    s_cbranch_scc1 pe_5023_ok
    s_mov_b32 s79, 40000
    s_cmp_lg_u32 s41, 0
    s_cbranch_scc1 pe_5023_w
pe_5023_p:
    buffer_load_dword v32, v30, s[24:27], 0 offen sc0 sc1
    s_waitcnt vmcnt(0)
    v_cmp_ne_u32 vcc, s65, v32
    s_nop 2
    s_ff1_i32_b64 s96, vcc
    v_mov_b32 v32, s96
    ds_write_b32 v31, v32
    s_waitcnt lgkmcnt(0)
    s_cmp_ge_u32 s96, s97
    s_cbranch_scc1 pe_5023_ok
    s_sleep 6
    s_sub_u32 s79, s79, 1
    s_cmp_lg_u32 s79, 0
    s_cbranch_scc1 pe_5023_p
    s_branch pe_5023_ok
pe_5023_w:
    s_mov_b32 s79, 640000
pe_5023_l:
    ds_read_b32 v32, v31
    s_waitcnt lgkmcnt(0)
    v_readfirstlane_b32 s96, v32
    s_nop 2
    s_cmp_ge_u32 s96, s97
    s_cbranch_scc1 pe_5023_ok
    s_sleep 1
    s_sub_u32 s79, s79, 1
    s_cmp_lg_u32 s79, 0
    s_cbranch_scc1 pe_5023_l
pe_5023_ok:
    s_add_u32 m0, s37, 0
    s_nop 0
    buffer_load_dwordx4 v4, s[4:7], s70 offen lds
    s_add_u32 s39, s70, 16384
    s_add_u32 s40, s71, 458752
    s_add_u32 m0, s37, 4096
    s_nop 0
    buffer_load_dwordx4 v5, s[4:7], s70 offen lds
    s_add_u32 m0, s37, 8192
    s_nop 0
    buffer_load_dwordx4 v6, s[4:7], s70 offen lds
    s_add_u32 m0, s37, 12288
    s_nop 0
    buffer_load_dwordx4 v7, s[4:7], s70 offen lds
    s_add_u32 m0, s37, 16384
    s_nop 0
    buffer_load_dwordx4 v8, s[8:11], s71 offen lds
    s_add_u32 m0, s37, 20480
    s_nop 0
    buffer_load_dwordx4 v9, s[8:11], s71 offen lds
    s_add_u32 m0, s37, 24576
    s_nop 0
    buffer_load_dwordx4 v10, s[8:11], s71 offen lds
    s_add_u32 m0, s37, 28672
    s_nop 0
    buffer_load_dwordx4 v11, s[8:11], s71 offen lds
    s_add_u32 m0, s37, 32768
    s_nop 0
    buffer_load_dwordx4 v12, s[8:11], s71 offen lds
    s_add_u32 m0, s37, 36864
    s_nop 0
    buffer_load_dwordx4 v13, s[8:11], s71 offen lds
    s_add_u32 m0, s37, 40960
    s_nop 0
    buffer_load_dwordx4 v14, s[8:11], s71 offen lds
    s_mov_b32 s38, 2
p3_lloop:
    s_waitcnt vmcnt(11)
    s_barrier
    s_lshl_b32 s97, s98, 2
    s_add_u32 s97, s97, 4
    s_add_u32 s98, s98, 1
    s_cmp_ge_u32 s96, s97
    s_cbranch_scc1 pe_5024_ok
    s_mov_b32 s79, 40000
    s_cmp_lg_u32 s41, 0
    s_cbranch_scc1 pe_5024_w
pe_5024_p:
    buffer_load_dword v32, v30, s[24:27], 0 offen sc0 sc1
    s_waitcnt vmcnt(0)
    v_cmp_ne_u32 vcc, s65, v32
    s_nop 2
    s_ff1_i32_b64 s96, vcc
    v_mov_b32 v32, s96
    ds_write_b32 v31, v32
    s_waitcnt lgkmcnt(0)
    s_cmp_ge_u32 s96, s97
    s_cbranch_scc1 pe_5024_ok
    s_sleep 6
    s_sub_u32 s79, s79, 1
    s_cmp_lg_u32 s79, 0
    s_cbranch_scc1 pe_5024_p
    s_branch pe_5024_ok
pe_5024_w:
    s_mov_b32 s79, 640000
pe_5024_l:
    ds_read_b32 v32, v31
    s_waitcnt lgkmcnt(0)
    v_readfirstlane_b32 s96, v32
    s_nop 2
    s_cmp_ge_u32 s96, s97
    s_cbranch_scc1 pe_5024_ok
    s_sleep 1
    s_sub_u32 s79, s79, 1
    s_cmp_lg_u32 s79, 0
    s_cbranch_scc1 pe_5024_l
pe_5024_ok:
    s_add_u32 m0, s37, 45056
    s_nop 0
    buffer_load_dwordx4 v4, s[4:7], s39 offen lds
    s_add_u32 s70, s39, 16384
    s_add_u32 s71, s40, 458752
    s_add_u32 m0, s37, 49152
    s_nop 0
    buffer_load_dwordx4 v5, s[4:7], s39 offen lds
    s_add_u32 m0, s37, 53248
    s_nop 0
    buffer_load_dwordx4 v6, s[4:7], s39 offen lds
    s_add_u32 m0, s37, 57344
    s_nop 0
    buffer_load_dwordx4 v7, s[4:7], s39 offen lds
    s_add_u32 m0, s37, 61440
    s_nop 0
    buffer_load_dwordx4 v8, s[8:11], s40 offen lds
    s_add_u32 m0, s37, 65536
    s_nop 0
    buffer_load_dwordx4 v9, s[8:11], s40 offen lds
    s_add_u32 m0, s37, 69632
    s_nop 0
    buffer_load_dwordx4 v10, s[8:11], s40 offen lds
    s_add_u32 m0, s37, 73728
    s_nop 0
    buffer_load_dwordx4 v11, s[8:11], s40 offen lds
    s_add_u32 m0, s37, 77824
    s_nop 0
    buffer_load_dwordx4 v12, s[8:11], s40 offen lds
    s_add_u32 m0, s37, 81920
    s_nop 0
    buffer_load_dwordx4 v13, s[8:11], s40 offen lds
    s_add_u32 m0, s37, 86016
    s_nop 0
    buffer_load_dwordx4 v14, s[8:11], s40 offen lds
    s_waitcnt vmcnt(11)
    s_barrier
    s_lshl_b32 s97, s98, 2
    s_add_u32 s97, s97, 4
    s_add_u32 s98, s98, 1
    s_cmp_ge_u32 s96, s97
    s_cbranch_scc1 pe_5025_ok
    s_mov_b32 s79, 40000
    s_cmp_lg_u32 s41, 0
    s_cbranch_scc1 pe_5025_w
pe_5025_p:
    buffer_load_dword v32, v30, s[24:27], 0 offen sc0 sc1
    s_waitcnt vmcnt(0)
    v_cmp_ne_u32 vcc, s65, v32
    s_nop 2
    s_ff1_i32_b64 s96, vcc
    v_mov_b32 v32, s96
    ds_write_b32 v31, v32
    s_waitcnt lgkmcnt(0)
    s_cmp_ge_u32 s96, s97
    s_cbranch_scc1 pe_5025_ok
    s_sleep 6
    s_sub_u32 s79, s79, 1
    s_cmp_lg_u32 s79, 0
    s_cbranch_scc1 pe_5025_p
    s_branch pe_5025_ok
pe_5025_w:
    s_mov_b32 s79, 640000
pe_5025_l:
    ds_read_b32 v32, v31
    s_waitcnt lgkmcnt(0)
    v_readfirstlane_b32 s96, v32
    s_nop 2
    s_cmp_ge_u32 s96, s97
    s_cbranch_scc1 pe_5025_ok
    s_sleep 1
    s_sub_u32 s79, s79, 1
    s_cmp_lg_u32 s79, 0
    s_cbranch_scc1 pe_5025_l
pe_5025_ok:
    s_add_u32 m0, s37, 90112
    s_nop 0
    buffer_load_dwordx4 v4, s[4:7], s70 offen lds
    s_add_u32 s39, s70, 16384
    s_add_u32 s40, s71, 458752
    s_add_u32 m0, s37, 94208
    s_nop 0
    buffer_load_dwordx4 v5, s[4:7], s70 offen lds
    s_add_u32 m0, s37, 98304
    s_nop 0
    buffer_load_dwordx4 v6, s[4:7], s70 offen lds
    s_add_u32 m0, s37, 102400
    s_nop 0
    buffer_load_dwordx4 v7, s[4:7], s70 offen lds
    s_add_u32 m0, s37, 106496
    s_nop 0
    buffer_load_dwordx4 v8, s[8:11], s71 offen lds
    s_add_u32 m0, s37, 110592
    s_nop 0
    buffer_load_dwordx4 v9, s[8:11], s71 offen lds
    s_add_u32 m0, s37, 114688
    s_nop 0
    buffer_load_dwordx4 v10, s[8:11], s71 offen lds
    s_add_u32 m0, s37, 118784
    s_nop 0
    buffer_load_dwordx4 v11, s[8:11], s71 offen lds
    s_add_u32 m0, s37, 122880
    s_nop 0
    buffer_load_dwordx4 v12, s[8:11], s71 offen lds
    s_add_u32 m0, s37, 126976
    s_nop 0
    buffer_load_dwordx4 v13, s[8:11], s71 offen lds
    s_add_u32 m0, s37, 131072
    s_nop 0
    buffer_load_dwordx4 v14, s[8:11], s71 offen lds
    s_waitcnt vmcnt(11)
    s_barrier
    s_lshl_b32 s97, s98, 2
    s_add_u32 s97, s97, 4
    s_add_u32 s98, s98, 1
    s_cmp_ge_u32 s96, s97
    s_cbranch_scc1 pe_5026_ok
    s_mov_b32 s79, 40000
    s_cmp_lg_u32 s41, 0
    s_cbranch_scc1 pe_5026_w
pe_5026_p:
    buffer_load_dword v32, v30, s[24:27], 0 offen sc0 sc1
    s_waitcnt vmcnt(0)
    v_cmp_ne_u32 vcc, s65, v32
    s_nop 2
    s_ff1_i32_b64 s96, vcc
    v_mov_b32 v32, s96
    ds_write_b32 v31, v32
    s_waitcnt lgkmcnt(0)
    s_cmp_ge_u32 s96, s97
    s_cbranch_scc1 pe_5026_ok
    s_sleep 6
    s_sub_u32 s79, s79, 1
    s_cmp_lg_u32 s79, 0
    s_cbranch_scc1 pe_5026_p
    s_branch pe_5026_ok
pe_5026_w:
    s_mov_b32 s79, 640000
pe_5026_l:
    ds_read_b32 v32, v31
    s_waitcnt lgkmcnt(0)
    v_readfirstlane_b32 s96, v32
    s_nop 2
    s_cmp_ge_u32 s96, s97
    s_cbranch_scc1 pe_5026_ok
    s_sleep 1
    s_sub_u32 s79, s79, 1
    s_cmp_lg_u32 s79, 0
    s_cbranch_scc1 pe_5026_l
pe_5026_ok:
    s_add_u32 m0, s37, 0
    s_nop 0
    buffer_load_dwordx4 v4, s[4:7], s39 offen lds
    s_add_u32 s70, s39, 16384
    s_add_u32 s71, s40, 458752
    s_add_u32 m0, s37, 4096
    s_nop 0
    buffer_load_dwordx4 v5, s[4:7], s39 offen lds
    s_add_u32 m0, s37, 8192
    s_nop 0
    buffer_load_dwordx4 v6, s[4:7], s39 offen lds
    s_add_u32 m0, s37, 12288
    s_nop 0
    buffer_load_dwordx4 v7, s[4:7], s39 offen lds
    s_add_u32 m0, s37, 16384
    s_nop 0
    buffer_load_dwordx4 v8, s[8:11], s40 offen lds
    s_add_u32 m0, s37, 20480
    s_nop 0
    buffer_load_dwordx4 v9, s[8:11], s40 offen lds
    s_add_u32 m0, s37, 24576
    s_nop 0
    buffer_load_dwordx4 v10, s[8:11], s40 offen lds
    s_add_u32 m0, s37, 28672
    s_nop 0
    buffer_load_dwordx4 v11, s[8:11], s40 offen lds
    s_add_u32 m0, s37, 32768
    s_nop 0
    buffer_load_dwordx4 v12, s[8:11], s40 offen lds
    s_add_u32 m0, s37, 36864
    s_nop 0
    buffer_load_dwordx4 v13, s[8:11], s40 offen lds
    s_add_u32 m0, s37, 40960
    s_nop 0
    buffer_load_dwordx4 v14, s[8:11], s40 offen lds
    s_waitcnt vmcnt(11)
    s_barrier
    s_lshl_b32 s97, s98, 2
    s_add_u32 s97, s97, 4
    s_add_u32 s98, s98, 1
    s_cmp_ge_u32 s96, s97
    s_cbranch_scc1 pe_5027_ok
    s_mov_b32 s79, 40000
    s_cmp_lg_u32 s41, 0
    s_cbranch_scc1 pe_5027_w
pe_5027_p:
    buffer_load_dword v32, v30, s[24:27], 0 offen sc0 sc1
    s_waitcnt vmcnt(0)
    v_cmp_ne_u32 vcc, s65, v32
    s_nop 2
    s_ff1_i32_b64 s96, vcc
    v_mov_b32 v32, s96
    ds_write_b32 v31, v32
    s_waitcnt lgkmcnt(0)
    s_cmp_ge_u32 s96, s97
    s_cbranch_scc1 pe_5027_ok
    s_sleep 6
    s_sub_u32 s79, s79, 1
    s_cmp_lg_u32 s79, 0
    s_cbranch_scc1 pe_5027_p
    s_branch pe_5027_ok
pe_5027_w:
    s_mov_b32 s79, 640000
pe_5027_l:
    ds_read_b32 v32, v31
    s_waitcnt lgkmcnt(0)
    v_readfirstlane_b32 s96, v32
    s_nop 2
    s_cmp_ge_u32 s96, s97
    s_cbranch_scc1 pe_5027_ok
    s_sleep 1
    s_sub_u32 s79, s79, 1
    s_cmp_lg_u32 s79, 0
    s_cbranch_scc1 pe_5027_l
pe_5027_ok:
    s_add_u32 m0, s37, 45056
    s_nop 0
    buffer_load_dwordx4 v4, s[4:7], s70 offen lds
    s_add_u32 s39, s70, 16384
    s_add_u32 s40, s71, 458752
    s_add_u32 m0, s37, 49152
    s_nop 0
    buffer_load_dwordx4 v5, s[4:7], s70 offen lds
    s_add_u32 m0, s37, 53248
    s_nop 0
    buffer_load_dwordx4 v6, s[4:7], s70 offen lds
    s_add_u32 m0, s37, 57344
    s_nop 0
    buffer_load_dwordx4 v7, s[4:7], s70 offen lds
    s_add_u32 m0, s37, 61440
    s_nop 0
    buffer_load_dwordx4 v8, s[8:11], s71 offen lds
    s_add_u32 m0, s37, 65536
    s_nop 0
    buffer_load_dwordx4 v9, s[8:11], s71 offen lds
    s_add_u32 m0, s37, 69632
    s_nop 0
    buffer_load_dwordx4 v10, s[8:11], s71 offen lds
    s_add_u32 m0, s37, 73728
    s_nop 0
    buffer_load_dwordx4 v11, s[8:11], s71 offen lds
    s_add_u32 m0, s37, 77824
    s_nop 0
    buffer_load_dwordx4 v12, s[8:11], s71 offen lds
    s_add_u32 m0, s37, 81920
    s_nop 0
    buffer_load_dwordx4 v13, s[8:11], s71 offen lds
    s_add_u32 m0, s37, 86016
    s_nop 0
    buffer_load_dwordx4 v14, s[8:11], s71 offen lds
    s_waitcnt vmcnt(11)
    s_barrier
    s_lshl_b32 s97, s98, 2
    s_add_u32 s97, s97, 4
    s_add_u32 s98, s98, 1
    s_cmp_ge_u32 s96, s97
    s_cbranch_scc1 pe_5028_ok
    s_mov_b32 s79, 40000
    s_cmp_lg_u32 s41, 0
    s_cbranch_scc1 pe_5028_w
pe_5028_p:
    buffer_load_dword v32, v30, s[24:27], 0 offen sc0 sc1
    s_waitcnt vmcnt(0)
    v_cmp_ne_u32 vcc, s65, v32
    s_nop 2
    s_ff1_i32_b64 s96, vcc
    v_mov_b32 v32, s96
    ds_write_b32 v31, v32
    s_waitcnt lgkmcnt(0)
    s_cmp_ge_u32 s96, s97
    s_cbranch_scc1 pe_5028_ok
    s_sleep 6
    s_sub_u32 s79, s79, 1
    s_cmp_lg_u32 s79, 0
    s_cbranch_scc1 pe_5028_p
    s_branch pe_5028_ok
pe_5028_w:
    s_mov_b32 s79, 640000
pe_5028_l:
    ds_read_b32 v32, v31
    s_waitcnt lgkmcnt(0)
    v_readfirstlane_b32 s96, v32
    s_nop 2
    s_cmp_ge_u32 s96, s97
    s_cbranch_scc1 pe_5028_ok
    s_sleep 1
    s_sub_u32 s79, s79, 1
    s_cmp_lg_u32 s79, 0
    s_cbranch_scc1 pe_5028_l
pe_5028_ok:
    s_add_u32 m0, s37, 90112
    s_nop 0
    buffer_load_dwordx4 v4, s[4:7], s39 offen lds
    s_add_u32 s70, s39, 16384
    s_add_u32 s71, s40, 458752
    s_add_u32 m0, s37, 94208
    s_nop 0
    buffer_load_dwordx4 v5, s[4:7], s39 offen lds
    s_add_u32 m0, s37, 98304
    s_nop 0
    buffer_load_dwordx4 v6, s[4:7], s39 offen lds
    s_add_u32 m0, s37, 102400
    s_nop 0
    buffer_load_dwordx4 v7, s[4:7], s39 offen lds
    s_add_u32 m0, s37, 106496
    s_nop 0
    buffer_load_dwordx4 v8, s[8:11], s40 offen lds
    s_add_u32 m0, s37, 110592
    s_nop 0
    buffer_load_dwordx4 v9, s[8:11], s40 offen lds
    s_add_u32 m0, s37, 114688
    s_nop 0
    buffer_load_dwordx4 v10, s[8:11], s40 offen lds
    s_add_u32 m0, s37, 118784
    s_nop 0
    buffer_load_dwordx4 v11, s[8:11], s40 offen lds
    s_add_u32 m0, s37, 122880
    s_nop 0
    buffer_load_dwordx4 v12, s[8:11], s40 offen lds
    s_add_u32 m0, s37, 126976
    s_nop 0
    buffer_load_dwordx4 v13, s[8:11], s40 offen lds
    s_add_u32 m0, s37, 131072
    s_nop 0
    buffer_load_dwordx4 v14, s[8:11], s40 offen lds
    s_waitcnt vmcnt(11)
    s_barrier
    s_lshl_b32 s97, s98, 2
    s_add_u32 s97, s97, 4
    s_add_u32 s98, s98, 1
    s_cmp_ge_u32 s96, s97
    s_cbranch_scc1 pe_5029_ok
    s_mov_b32 s79, 40000
    s_cmp_lg_u32 s41, 0
    s_cbranch_scc1 pe_5029_w
pe_5029_p:
    buffer_load_dword v32, v30, s[24:27], 0 offen sc0 sc1
    s_waitcnt vmcnt(0)
    v_cmp_ne_u32 vcc, s65, v32
    s_nop 2
    s_ff1_i32_b64 s96, vcc
    v_mov_b32 v32, s96
    ds_write_b32 v31, v32
    s_waitcnt lgkmcnt(0)
    s_cmp_ge_u32 s96, s97
    s_cbranch_scc1 pe_5029_ok
    s_sleep 6
    s_sub_u32 s79, s79, 1
    s_cmp_lg_u32 s79, 0
    s_cbranch_scc1 pe_5029_p
    s_branch pe_5029_ok
pe_5029_w:
    s_mov_b32 s79, 640000
pe_5029_l:
    ds_read_b32 v32, v31
    s_waitcnt lgkmcnt(0)
    v_readfirstlane_b32 s96, v32
    s_nop 2
    s_cmp_ge_u32 s96, s97
    s_cbranch_scc1 pe_5029_ok
    s_sleep 1
    s_sub_u32 s79, s79, 1
    s_cmp_lg_u32 s79, 0
    s_cbranch_scc1 pe_5029_l
pe_5029_ok:
    s_add_u32 m0, s37, 0
    s_nop 0
    buffer_load_dwordx4 v4, s[4:7], s70 offen lds
    s_add_u32 s39, s70, 16384
    s_add_u32 s40, s71, 458752
    s_add_u32 m0, s37, 4096
    s_nop 0
    buffer_load_dwordx4 v5, s[4:7], s70 offen lds
    s_add_u32 m0, s37, 8192
    s_nop 0
    buffer_load_dwordx4 v6, s[4:7], s70 offen lds
    s_add_u32 m0, s37, 12288
    s_nop 0
    buffer_load_dwordx4 v7, s[4:7], s70 offen lds
    s_add_u32 m0, s37, 16384
    s_nop 0
    buffer_load_dwordx4 v8, s[8:11], s71 offen lds
    s_add_u32 m0, s37, 20480
    s_nop 0
    buffer_load_dwordx4 v9, s[8:11], s71 offen lds
    s_add_u32 m0, s37, 24576
    s_nop 0
    buffer_load_dwordx4 v10, s[8:11], s71 offen lds
    s_add_u32 m0, s37, 28672
    s_nop 0
    buffer_load_dwordx4 v11, s[8:11], s71 offen lds
    s_add_u32 m0, s37, 32768
    s_nop 0
    buffer_load_dwordx4 v12, s[8:11], s71 offen lds
    s_add_u32 m0, s37, 36864
    s_nop 0
    buffer_load_dwordx4 v13, s[8:11], s71 offen lds
    s_add_u32 m0, s37, 40960
    s_nop 0
    buffer_load_dwordx4 v14, s[8:11], s71 offen lds
    s_sub_u32 s38, s38, 1
    s_cmp_lg_u32 s38, 0
    s_cbranch_scc1 p3_lloop
    s_waitcnt vmcnt(11)
    s_barrier
    s_lshl_b32 s31, s29, 7
    s_lshl_b32 s32, s41, 6
    s_add_u32 s31, s31, s32
    v_add_u32 v102, s31, v0
    v_lshlrev_b32 v102, 3, v102
    v_add_u32 v102, 32636928, v102
    s_cmp_ge_u32 s41, 2
    s_cbranch_scc1 nostat_5030
    s_mov_b32 s31, 0
    buffer_load_dwordx2 v[104:105], v102, s[24:27], s31 offen sc0 sc1
    s_mov_b32 s31, 16384
    buffer_load_dwordx2 v[106:107], v102, s[24:27], s31 offen sc0 sc1
    s_mov_b32 s31, 32768
    buffer_load_dwordx2 v[108:109], v102, s[24:27], s31 offen sc0 sc1
    s_mov_b32 s31, 49152
    buffer_load_dwordx2 v[110:111], v102, s[24:27], s31 offen sc0 sc1
    s_mov_b32 s31, 65536
    buffer_load_dwordx2 v[112:113], v102, s[24:27], s31 offen sc0 sc1
    s_mov_b32 s31, 81920
    buffer_load_dwordx2 v[114:115], v102, s[24:27], s31 offen sc0 sc1
    s_mov_b32 s31, 98304
    buffer_load_dwordx2 v[116:117], v102, s[24:27], s31 offen sc0 sc1
    s_mov_b32 s31, 114688
    buffer_load_dwordx2 v[118:119], v102, s[24:27], s31 offen sc0 sc1
    s_mov_b32 s31, 131072
    buffer_load_dwordx2 v[120:121], v102, s[24:27], s31 offen sc0 sc1
    s_mov_b32 s31, 147456
    buffer_load_dwordx2 v[122:123], v102, s[24:27], s31 offen sc0 sc1
    s_mov_b32 s31, 163840
    buffer_load_dwordx2 v[124:125], v102, s[24:27], s31 offen sc0 sc1
    s_mov_b32 s31, 180224
    buffer_load_dwordx2 v[126:127], v102, s[24:27], s31 offen sc0 sc1
    s_mov_b32 s31, 196608
    buffer_load_dwordx2 v[128:129], v102, s[24:27], s31 offen sc0 sc1
    s_mov_b32 s31, 212992
    buffer_load_dwordx2 v[130:131], v102, s[24:27], s31 offen sc0 sc1
    s_mov_b32 s31, 229376
    buffer_load_dwordx2 v[132:133], v102, s[24:27], s31 offen sc0 sc1
    s_mov_b32 s31, 245760
    buffer_load_dwordx2 v[134:135], v102, s[24:27], s31 offen sc0 sc1
    s_waitcnt vmcnt(0)
    v_add_f32 v103, v104, v106
    v_add_f32 v103, v103, v108
    v_add_f32 v103, v103, v110
    v_add_f32 v103, v103, v112
    v_add_f32 v103, v103, v114
    v_add_f32 v103, v103, v116
    v_add_f32 v103, v103, v118
    v_add_f32 v103, v103, v120
    v_add_f32 v103, v103, v122
    v_add_f32 v103, v103, v124
    v_add_f32 v103, v103, v126
    v_add_f32 v103, v103, v128
    v_add_f32 v103, v103, v130
    v_add_f32 v103, v103, v132
    v_add_f32 v103, v103, v134
    v_mul_f32 v103, 0x3a800000, v103
    v_mov_b32 v101, 0
    v_mul_f32 v100, 0x3c800000, v104
    v_sub_f32 v100, v100, v103
    v_mul_f32 v100, v100, v100
    v_mul_f32 v100, 0x42800000, v100
    v_add_f32 v100, v100, v105
    v_add_f32 v101, v101, v100
    v_mul_f32 v100, 0x3c800000, v106
    v_sub_f32 v100, v100, v103
    v_mul_f32 v100, v100, v100
    v_mul_f32 v100, 0x42800000, v100
    v_add_f32 v100, v100, v107
    v_add_f32 v101, v101, v100
    v_mul_f32 v100, 0x3c800000, v108
    v_sub_f32 v100, v100, v103
    v_mul_f32 v100, v100, v100
    v_mul_f32 v100, 0x42800000, v100
    v_add_f32 v100, v100, v109
    v_add_f32 v101, v101, v100
    v_mul_f32 v100, 0x3c800000, v110
    v_sub_f32 v100, v100, v103
    v_mul_f32 v100, v100, v100
    v_mul_f32 v100, 0x42800000, v100
    v_add_f32 v100, v100, v111
    v_add_f32 v101, v101, v100
    v_mul_f32 v100, 0x3c800000, v112
    v_sub_f32 v100, v100, v103
    v_mul_f32 v100, v100, v100
    v_mul_f32 v100, 0x42800000, v100
    v_add_f32 v100, v100, v113
    v_add_f32 v101, v101, v100
    v_mul_f32 v100, 0x3c800000, v114
    v_sub_f32 v100, v100, v103
    v_mul_f32 v100, v100, v100
    v_mul_f32 v100, 0x42800000, v100
    v_add_f32 v100, v100, v115
    v_add_f32 v101, v101, v100
    v_mul_f32 v100, 0x3c800000, v116
    v_sub_f32 v100, v100, v103
    v_mul_f32 v100, v100, v100
    v_mul_f32 v100, 0x42800000, v100
    v_add_f32 v100, v100, v117
    v_add_f32 v101, v101, v100
    v_mul_f32 v100, 0x3c800000, v118
    v_sub_f32 v100, v100, v103
    v_mul_f32 v100, v100, v100
    v_mul_f32 v100, 0x42800000, v100
    v_add_f32 v100, v100, v119
    v_add_f32 v101, v101, v100
    v_mul_f32 v100, 0x3c800000, v120
    v_sub_f32 v100, v100, v103
    v_mul_f32 v100, v100, v100
    v_mul_f32 v100, 0x42800000, v100
    v_add_f32 v100, v100, v121
    v_add_f32 v101, v101, v100
    v_mul_f32 v100, 0x3c800000, v122
    v_sub_f32 v100, v100, v103
    v_mul_f32 v100, v100, v100
    v_mul_f32 v100, 0x42800000, v100
    v_add_f32 v100, v100, v123
    v_add_f32 v101, v101, v100
    v_mul_f32 v100, 0x3c800000, v124
    v_sub_f32 v100, v100, v103
    v_mul_f32 v100, v100, v100
    v_mul_f32 v100, 0x42800000, v100
    v_add_f32 v100, v100, v125
    v_add_f32 v101, v101, v100
    v_mul_f32 v100, 0x3c800000, v126
    v_sub_f32 v100, v100, v103
    v_mul_f32 v100, v100, v100
    v_mul_f32 v100, 0x42800000, v100
    v_add_f32 v100, v100, v127
    v_add_f32 v101, v101, v100
    v_mul_f32 v100, 0x3c800000, v128
    v_sub_f32 v100, v100, v103
    v_mul_f32 v100, v100, v100
    v_mul_f32 v100, 0x42800000, v100
    v_add_f32 v100, v100, v129
    v_add_f32 v101, v101, v100
    v_mul_f32 v100, 0x3c800000, v130
    v_sub_f32 v100, v100, v103
    v_mul_f32 v100, v100, v100
    v_mul_f32 v100, 0x42800000, v100
    v_add_f32 v100, v100, v131
    v_add_f32 v101, v101, v100
    v_mul_f32 v100, 0x3c800000, v132
    v_sub_f32 v100, v100, v103
    v_mul_f32 v100, v100, v100
    v_mul_f32 v100, 0x42800000, v100
    v_add_f32 v100, v100, v133
    v_add_f32 v101, v101, v100
    v_mul_f32 v100, 0x3c800000, v134
    v_sub_f32 v100, v100, v103
    v_mul_f32 v100, v100, v100
    v_mul_f32 v100, 0x42800000, v100
    v_add_f32 v100, v100, v135
    v_add_f32 v101, v101, v100
    v_mul_f32 v101, 0x3a800000, v101
    v_cvt_pk_bf16_f32 v103, v103, v103
    v_lshlrev_b32 v103, 16, v103
    v_cvt_pk_bf16_f32 v101, v101, v101
    v_lshlrev_b32 v101, 16, v101
    v_add_f32 v101, 0x3727c5ac, v101
    v_cvt_pk_bf16_f32 v101, v101, v101
    v_lshlrev_b32 v101, 16, v101
    v_sqrt_f32 v101, v101
    s_nop 0
    v_cvt_pk_bf16_f32 v101, v101, v101
    v_lshlrev_b32 v101, 16, v101
    v_rcp_f32 v101, v101
    v_mov_b32 v104, v103
    v_mov_b32 v105, v101
    s_lshl_b32 s31, s41, 9
    s_add_u32 s31, s31, 135168
    v_lshl_add_u32 v102, v0, 3, s31
    ds_write_b64 v102, v[104:105]
nostat_5030:
    s_waitcnt lgkmcnt(0)
    s_waitcnt vmcnt(0)
    s_barrier
    s_barrier
    s_barrier
    s_and_b32 s31, s2, 7
    s_lshr_b32 s32, s2, 3
    s_lshr_b32 s68, s31, 2
    s_bfe_u32 s33, s31, 0x10001
    s_lshl_b32 s33, s33, 3
    s_lshr_b32 s29, s32, 2
    s_add_u32 s29, s29, s33
    s_and_b32 s33, s31, 1
    s_lshl_b32 s33, s33, 2
    s_and_b32 s30, s32, 3
    s_add_u32 s30, s30, s33
    s_mul_i32 s35, s29, 917504
    s_mul_i32 s36, s68, 458752
    s_add_u32 s35, s35, s36
    s_add_u32 s4, s62, s35
    s_addc_u32 s5, s63, 0
    s_add_u32 s4, s4, 12582912
    s_addc_u32 s5, s5, 0
    s_sub_u32 s6, 14680064, s35
    s_mov_b32 s7, 0x20000
    s_mul_i32 s35, s68, 3670016
    s_lshl_b32 s36, s30, 8
    s_add_u32 s35, s35, s36
    s_add_u32 s8, s56, s35
    s_addc_u32 s9, s57, 0
    s_sub_u32 s10, 7340032, s35
    s_mov_b32 s11, 0x20000
    s_sub_u32 s41, s28, 4
    v_lshrrev_b32 v1, 3, v0
    s_lshl_b32 s31, s41, 3
    v_add_u32 v1, s31, v1
    s_mov_b32 s31, 64
    v_mul_lo_u32 v1, v1, s31
    v_bfe_u32 v2, v0, 4, 2
    s_and_b32 s32, s41, 1
    s_lshl_b32 s33, s32, 2
    v_add_u32 v2, s33, v2
    v_and_b32 v3, 7, v0
    v_xor_b32 v2, v2, v3
    v_and_b32 v3, 3, v2
    v_lshl_add_u32 v1, v3, 4, v1
    v_lshrrev_b32 v2, 2, v2
    v_mul_u32_u24 v2, 8192, v2
    v_add_u32 v4, v2, v1
    v_add_u32 v5, 2048, v4
    v_add_u32 v6, 4096, v4
    v_add_u32 v7, 6144, v4
    s_mov_b32 s31, 2048
    v_lshrrev_b32 v1, 5, v0
    v_lshlrev_b32 v1, 2, v1
    v_bfe_u32 v2, v0, 2, 2
    v_add_u32 v1, v1, v2
    s_lshl_b32 s33, s41, 3
    v_add_u32 v1, s33, v1
    v_mul_lo_u32 v1, v1, s31
    v_and_b32 v2, 3, v0
    s_lshl_b32 s33, s32, 1
    v_xor_b32 v2, s33, v2
    v_lshlrev_b32 v2, 4, v2
    v_bfe_u32 v3, v0, 4, 1
    v_lshl_add_u32 v2, v3, 6, v2
    v_add_u32 v12, v1, v2
    v_add_u32 v8, 0, v12
    v_add_u32 v9, 65536, v12
    v_add_u32 v10, 128, v12
    v_add_u32 v11, 65664, v12
    s_mov_b32 s39, 0
    s_mov_b32 s40, 0
    s_lshl_b32 s37, s41, 10
    s_mov_b32 s31, 0
    s_add_u32 m0, s37, 16384
    s_nop 0
    buffer_load_dwordx4 v8, s[8:11], s31 offen lds
    s_add_u32 m0, s37, 20480
    s_nop 0
    buffer_load_dwordx4 v9, s[8:11], s31 offen lds
    s_add_u32 m0, s37, 24576
    s_nop 0
    buffer_load_dwordx4 v10, s[8:11], s31 offen lds
    s_add_u32 m0, s37, 28672
    s_nop 0
    buffer_load_dwordx4 v11, s[8:11], s31 offen lds
    s_mov_b32 s31, 131072
    s_add_u32 m0, s37, 49152
    s_nop 0
    buffer_load_dwordx4 v8, s[8:11], s31 offen lds
    s_add_u32 m0, s37, 53248
    s_nop 0
    buffer_load_dwordx4 v9, s[8:11], s31 offen lds
    s_add_u32 m0, s37, 57344
    s_nop 0
    buffer_load_dwordx4 v10, s[8:11], s31 offen lds
    s_add_u32 m0, s37, 61440
    s_nop 0
    buffer_load_dwordx4 v11, s[8:11], s31 offen lds
    s_mov_b32 s31, 262144
    s_add_u32 m0, s37, 81920
    s_nop 0
    buffer_load_dwordx4 v8, s[8:11], s31 offen lds
    s_add_u32 m0, s37, 86016
    s_nop 0
    buffer_load_dwordx4 v9, s[8:11], s31 offen lds
    s_add_u32 m0, s37, 90112
    s_nop 0
    buffer_load_dwordx4 v10, s[8:11], s31 offen lds
    s_add_u32 m0, s37, 94208
    s_nop 0
    buffer_load_dwordx4 v11, s[8:11], s31 offen lds
    s_lshl_b32 s32, s29, 8
    s_lshl_b32 s33, s68, 7
    s_add_u32 s32, s32, s33
    s_add_u32 s32, s32, 32518144
    s_mov_b32 s99, s32
    s_mov_b32 s96, 0
    s_mov_b32 s98, 0
    v_and_b32 v30, 31, v0
    v_lshl_add_u32 v30, v30, 2, s99
    v_mov_b32 v31, 161840
    s_waitcnt vmcnt(0)
    s_lshl_b32 s97, s98, 1
    s_add_u32 s97, s97, 1
    s_mul_i32 s97, s97, 9363
    s_lshr_b32 s97, s97, 16
    s_lshl_b32 s97, s97, 2
    s_add_u32 s97, s97, 4
    s_add_u32 s98, s98, 1
    s_cmp_ge_u32 s96, s97
    s_cbranch_scc1 pe_5031_ok
    s_mov_b32 s79, 40000
    s_cmp_lg_u32 s41, 0
    s_cbranch_scc1 pe_5031_w
pe_5031_p:
    buffer_load_dword v32, v30, s[24:27], 0 offen sc0 sc1
    s_waitcnt vmcnt(0)
    v_cmp_ne_u32 vcc, s65, v32
    s_nop 2
    s_ff1_i32_b64 s96, vcc
    v_mov_b32 v32, s96
    ds_write_b32 v31, v32
    s_waitcnt lgkmcnt(0)
    s_cmp_ge_u32 s96, s97
    s_cbranch_scc1 pe_5031_ok
    s_sleep 6
    s_sub_u32 s79, s79, 1
    s_cmp_lg_u32 s79, 0
    s_cbranch_scc1 pe_5031_p
    s_branch pe_5031_ok
pe_5031_w:
    s_mov_b32 s79, 640000
pe_5031_l:
    ds_read_b32 v32, v31
    s_waitcnt lgkmcnt(0)
    v_readfirstlane_b32 s96, v32
    s_nop 2
    s_cmp_ge_u32 s96, s97
    s_cbranch_scc1 pe_5031_ok
    s_sleep 1
    s_sub_u32 s79, s79, 1
    s_cmp_lg_u32 s79, 0
    s_cbranch_scc1 pe_5031_l
pe_5031_ok:
    s_mov_b32 s31, 0
    s_add_u32 m0, s37, 0
    s_nop 0
    buffer_load_dwordx4 v4, s[4:7], s31 offen lds
    s_add_u32 m0, s37, 4096
    s_nop 0
    buffer_load_dwordx4 v5, s[4:7], s31 offen lds
    s_add_u32 m0, s37, 8192
    s_nop 0
    buffer_load_dwordx4 v6, s[4:7], s31 offen lds
    s_add_u32 m0, s37, 12288
    s_nop 0
    buffer_load_dwordx4 v7, s[4:7], s31 offen lds
    s_lshl_b32 s97, s98, 1
    s_add_u32 s97, s97, 1
    s_mul_i32 s97, s97, 9363
    s_lshr_b32 s97, s97, 16
    s_lshl_b32 s97, s97, 2
    s_add_u32 s97, s97, 4
    s_add_u32 s98, s98, 1
    s_cmp_ge_u32 s96, s97
    s_cbranch_scc1 pe_5032_ok
    s_mov_b32 s79, 40000
    s_cmp_lg_u32 s41, 0
    s_cbranch_scc1 pe_5032_w
pe_5032_p:
    buffer_load_dword v32, v30, s[24:27], 0 offen sc0 sc1
    s_waitcnt vmcnt(0)
    v_cmp_ne_u32 vcc, s65, v32
    s_nop 2
    s_ff1_i32_b64 s96, vcc
    v_mov_b32 v32, s96
    ds_write_b32 v31, v32
    s_waitcnt lgkmcnt(0)
    s_cmp_ge_u32 s96, s97
    s_cbranch_scc1 pe_5032_ok
    s_sleep 6
    s_sub_u32 s79, s79, 1
    s_cmp_lg_u32 s79, 0
    s_cbranch_scc1 pe_5032_p
    s_branch pe_5032_ok
pe_5032_w:
    s_mov_b32 s79, 640000
pe_5032_l:
    ds_read_b32 v32, v31
    s_waitcnt lgkmcnt(0)
    v_readfirstlane_b32 s96, v32
    s_nop 2
    s_cmp_ge_u32 s96, s97
    s_cbranch_scc1 pe_5032_ok
    s_sleep 1
    s_sub_u32 s79, s79, 1
    s_cmp_lg_u32 s79, 0
    s_cbranch_scc1 pe_5032_l
pe_5032_ok:
    s_mov_b32 s31, 16384
    s_add_u32 m0, s37, 32768
    s_nop 0
    buffer_load_dwordx4 v4, s[4:7], s31 offen lds
    s_add_u32 m0, s37, 36864
    s_nop 0
    buffer_load_dwordx4 v5, s[4:7], s31 offen lds
    s_add_u32 m0, s37, 40960
    s_nop 0
    buffer_load_dwordx4 v6, s[4:7], s31 offen lds
    s_add_u32 m0, s37, 45056
    s_nop 0
    buffer_load_dwordx4 v7, s[4:7], s31 offen lds
    s_lshl_b32 s97, s98, 1
    s_add_u32 s97, s97, 1
    s_mul_i32 s97, s97, 9363
    s_lshr_b32 s97, s97, 16
    s_lshl_b32 s97, s97, 2
    s_add_u32 s97, s97, 4
    s_add_u32 s98, s98, 1
    s_cmp_ge_u32 s96, s97
    s_cbranch_scc1 pe_5033_ok
    s_mov_b32 s79, 40000
    s_cmp_lg_u32 s41, 0
    s_cbranch_scc1 pe_5033_w
pe_5033_p:
    buffer_load_dword v32, v30, s[24:27], 0 offen sc0 sc1
    s_waitcnt vmcnt(0)
    v_cmp_ne_u32 vcc, s65, v32
    s_nop 2
    s_ff1_i32_b64 s96, vcc
    v_mov_b32 v32, s96
    ds_write_b32 v31, v32
    s_waitcnt lgkmcnt(0)
    s_cmp_ge_u32 s96, s97
    s_cbranch_scc1 pe_5033_ok
    s_sleep 6
    s_sub_u32 s79, s79, 1
    s_cmp_lg_u32 s79, 0
    s_cbranch_scc1 pe_5033_p
    s_branch pe_5033_ok
pe_5033_w:
    s_mov_b32 s79, 640000
pe_5033_l:
    ds_read_b32 v32, v31
    s_waitcnt lgkmcnt(0)
    v_readfirstlane_b32 s96, v32
    s_nop 2
    s_cmp_ge_u32 s96, s97
    s_cbranch_scc1 pe_5033_ok
    s_sleep 1
    s_sub_u32 s79, s79, 1
    s_cmp_lg_u32 s79, 0
    s_cbranch_scc1 pe_5033_l
pe_5033_ok:
    s_mov_b32 s31, 32768
    s_add_u32 m0, s37, 65536
    s_nop 0
    buffer_load_dwordx4 v4, s[4:7], s31 offen lds
    s_add_u32 m0, s37, 69632
    s_nop 0
    buffer_load_dwordx4 v5, s[4:7], s31 offen lds
    s_add_u32 m0, s37, 73728
    s_nop 0
    buffer_load_dwordx4 v6, s[4:7], s31 offen lds
    s_add_u32 m0, s37, 77824
    s_nop 0
    buffer_load_dwordx4 v7, s[4:7], s31 offen lds
    s_mov_b32 s39, 49152
    s_mov_b32 s40, 393216
    s_waitcnt vmcnt(8)
    s_barrier
    s_lshl_b32 s97, s98, 1
    s_add_u32 s97, s97, 1
    s_mul_i32 s97, s97, 9363
    s_lshr_b32 s97, s97, 16
    s_lshl_b32 s97, s97, 2
    s_add_u32 s97, s97, 4
    s_add_u32 s98, s98, 1
    s_cmp_ge_u32 s96, s97
    s_cbranch_scc1 pe_5034_ok
    s_mov_b32 s79, 40000
    s_cmp_lg_u32 s41, 0
    s_cbranch_scc1 pe_5034_w
pe_5034_p:
    buffer_load_dword v32, v30, s[24:27], 0 offen sc0 sc1
    s_waitcnt vmcnt(0)
    v_cmp_ne_u32 vcc, s65, v32
    s_nop 2
    s_ff1_i32_b64 s96, vcc
    v_mov_b32 v32, s96
    ds_write_b32 v31, v32
    s_waitcnt lgkmcnt(0)
    s_cmp_ge_u32 s96, s97
    s_cbranch_scc1 pe_5034_ok
    s_sleep 6
    s_sub_u32 s79, s79, 1
    s_cmp_lg_u32 s79, 0
    s_cbranch_scc1 pe_5034_p
    s_branch pe_5034_ok
pe_5034_w:
    s_mov_b32 s79, 640000
pe_5034_l:
    ds_read_b32 v32, v31
    s_waitcnt lgkmcnt(0)
    v_readfirstlane_b32 s96, v32
    s_nop 2
    s_cmp_ge_u32 s96, s97
    s_cbranch_scc1 pe_5034_ok
    s_sleep 1
    s_sub_u32 s79, s79, 1
    s_cmp_lg_u32 s79, 0
    s_cbranch_scc1 pe_5034_l
pe_5034_ok:
    s_add_u32 m0, s37, 98304
    s_nop 0
    buffer_load_dwordx4 v4, s[4:7], s39 offen lds
    s_add_u32 s70, s39, 16384
    s_add_u32 s71, s40, 131072
    s_add_u32 m0, s37, 102400
    s_nop 0
    buffer_load_dwordx4 v5, s[4:7], s39 offen lds
    s_add_u32 m0, s37, 106496
    s_nop 0
    buffer_load_dwordx4 v6, s[4:7], s39 offen lds
    s_add_u32 m0, s37, 110592
    s_nop 0
    buffer_load_dwordx4 v7, s[4:7], s39 offen lds
    s_add_u32 m0, s37, 114688
    s_nop 0
    buffer_load_dwordx4 v8, s[8:11], s40 offen lds
    s_add_u32 m0, s37, 118784
    s_nop 0
    buffer_load_dwordx4 v9, s[8:11], s40 offen lds
    s_add_u32 m0, s37, 122880
    s_nop 0
    buffer_load_dwordx4 v10, s[8:11], s40 offen lds
    s_add_u32 m0, s37, 126976
    s_nop 0
    buffer_load_dwordx4 v11, s[8:11], s40 offen lds
    s_waitcnt vmcnt(12)
    s_barrier
    s_lshl_b32 s97, s98, 1
    s_add_u32 s97, s97, 1
    s_mul_i32 s97, s97, 9363
    s_lshr_b32 s97, s97, 16
    s_lshl_b32 s97, s97, 2
    s_add_u32 s97, s97, 4
    s_add_u32 s98, s98, 1
    s_cmp_ge_u32 s96, s97
    s_cbranch_scc1 pe_5035_ok
    s_mov_b32 s79, 40000
    s_cmp_lg_u32 s41, 0
    s_cbranch_scc1 pe_5035_w
pe_5035_p:
    buffer_load_dword v32, v30, s[24:27], 0 offen sc0 sc1
    s_waitcnt vmcnt(0)
    v_cmp_ne_u32 vcc, s65, v32
    s_nop 2
    s_ff1_i32_b64 s96, vcc
    v_mov_b32 v32, s96
    ds_write_b32 v31, v32
    s_waitcnt lgkmcnt(0)
    s_cmp_ge_u32 s96, s97
    s_cbranch_scc1 pe_5035_ok
    s_sleep 6
    s_sub_u32 s79, s79, 1
    s_cmp_lg_u32 s79, 0
    s_cbranch_scc1 pe_5035_p
    s_branch pe_5035_ok
pe_5035_w:
    s_mov_b32 s79, 640000
pe_5035_l:
    ds_read_b32 v32, v31
    s_waitcnt lgkmcnt(0)
    v_readfirstlane_b32 s96, v32
    s_nop 2
    s_cmp_ge_u32 s96, s97
    s_cbranch_scc1 pe_5035_ok
    s_sleep 1
    s_sub_u32 s79, s79, 1
    s_cmp_lg_u32 s79, 0
    s_cbranch_scc1 pe_5035_l
pe_5035_ok:
    s_add_u32 m0, s37, 0
    s_nop 0
    buffer_load_dwordx4 v4, s[4:7], s70 offen lds
    s_add_u32 s39, s70, 16384
    s_add_u32 s40, s71, 131072
    s_add_u32 m0, s37, 4096
    s_nop 0
    buffer_load_dwordx4 v5, s[4:7], s70 offen lds
    s_add_u32 m0, s37, 8192
    s_nop 0
    buffer_load_dwordx4 v6, s[4:7], s70 offen lds
    s_add_u32 m0, s37, 12288
    s_nop 0
    buffer_load_dwordx4 v7, s[4:7], s70 offen lds
    s_add_u32 m0, s37, 16384
    s_nop 0
    buffer_load_dwordx4 v8, s[8:11], s71 offen lds
    s_add_u32 m0, s37, 20480
    s_nop 0
    buffer_load_dwordx4 v9, s[8:11], s71 offen lds
    s_add_u32 m0, s37, 24576
    s_nop 0
    buffer_load_dwordx4 v10, s[8:11], s71 offen lds
    s_add_u32 m0, s37, 28672
    s_nop 0
    buffer_load_dwordx4 v11, s[8:11], s71 offen lds
    s_waitcnt vmcnt(16)
    s_barrier
    s_lshl_b32 s97, s98, 1
    s_add_u32 s97, s97, 1
    s_mul_i32 s97, s97, 9363
    s_lshr_b32 s97, s97, 16
    s_lshl_b32 s97, s97, 2
    s_add_u32 s97, s97, 4
    s_add_u32 s98, s98, 1
    s_cmp_ge_u32 s96, s97
    s_cbranch_scc1 pe_5036_ok
    s_mov_b32 s79, 40000
    s_cmp_lg_u32 s41, 0
    s_cbranch_scc1 pe_5036_w
pe_5036_p:
    buffer_load_dword v32, v30, s[24:27], 0 offen sc0 sc1
    s_waitcnt vmcnt(0)
    v_cmp_ne_u32 vcc, s65, v32
    s_nop 2
    s_ff1_i32_b64 s96, vcc
    v_mov_b32 v32, s96
    ds_write_b32 v31, v32
    s_waitcnt lgkmcnt(0)
    s_cmp_ge_u32 s96, s97
    s_cbranch_scc1 pe_5036_ok
    s_sleep 6
    s_sub_u32 s79, s79, 1
    s_cmp_lg_u32 s79, 0
    s_cbranch_scc1 pe_5036_p
    s_branch pe_5036_ok
pe_5036_w:
    s_mov_b32 s79, 640000
pe_5036_l:
    ds_read_b32 v32, v31
    s_waitcnt lgkmcnt(0)
    v_readfirstlane_b32 s96, v32
    s_nop 2
    s_cmp_ge_u32 s96, s97
    s_cbranch_scc1 pe_5036_ok
    s_sleep 1
    s_sub_u32 s79, s79, 1
    s_cmp_lg_u32 s79, 0
    s_cbranch_scc1 pe_5036_l
pe_5036_ok:
    s_add_u32 m0, s37, 32768
    s_nop 0
    buffer_load_dwordx4 v4, s[4:7], s39 offen lds
    s_add_u32 s70, s39, 16384
    s_add_u32 s71, s40, 131072
    s_add_u32 m0, s37, 36864
    s_nop 0
    buffer_load_dwordx4 v5, s[4:7], s39 offen lds
    s_add_u32 m0, s37, 40960
    s_nop 0
    buffer_load_dwordx4 v6, s[4:7], s39 offen lds
    s_add_u32 m0, s37, 45056
    s_nop 0
    buffer_load_dwordx4 v7, s[4:7], s39 offen lds
    s_add_u32 m0, s37, 49152
    s_nop 0
    buffer_load_dwordx4 v8, s[8:11], s40 offen lds
    s_add_u32 m0, s37, 53248
    s_nop 0
    buffer_load_dwordx4 v9, s[8:11], s40 offen lds
    s_add_u32 m0, s37, 57344
    s_nop 0
    buffer_load_dwordx4 v10, s[8:11], s40 offen lds
    s_add_u32 m0, s37, 61440
    s_nop 0
    buffer_load_dwordx4 v11, s[8:11], s40 offen lds
    s_mov_b32 s38, 5
p4_lloop:
    s_waitcnt vmcnt(16)
    s_barrier
    s_lshl_b32 s97, s98, 1
    s_add_u32 s97, s97, 1
    s_mul_i32 s97, s97, 9363
    s_lshr_b32 s97, s97, 16
    s_lshl_b32 s97, s97, 2
    s_add_u32 s97, s97, 4
    s_add_u32 s98, s98, 1
    s_cmp_ge_u32 s96, s97
    s_cbranch_scc1 pe_5037_ok
    s_mov_b32 s79, 40000
    s_cmp_lg_u32 s41, 0
    s_cbranch_scc1 pe_5037_w
pe_5037_p:
    buffer_load_dword v32, v30, s[24:27], 0 offen sc0 sc1
    s_waitcnt vmcnt(0)
    v_cmp_ne_u32 vcc, s65, v32
    s_nop 2
    s_ff1_i32_b64 s96, vcc
    v_mov_b32 v32, s96
    ds_write_b32 v31, v32
    s_waitcnt lgkmcnt(0)
    s_cmp_ge_u32 s96, s97
    s_cbranch_scc1 pe_5037_ok
    s_sleep 6
    s_sub_u32 s79, s79, 1
    s_cmp_lg_u32 s79, 0
    s_cbranch_scc1 pe_5037_p
    s_branch pe_5037_ok
pe_5037_w:
    s_mov_b32 s79, 640000
pe_5037_l:
    ds_read_b32 v32, v31
    s_waitcnt lgkmcnt(0)
    v_readfirstlane_b32 s96, v32
    s_nop 2
    s_cmp_ge_u32 s96, s97
    s_cbranch_scc1 pe_5037_ok
    s_sleep 1
    s_sub_u32 s79, s79, 1
    s_cmp_lg_u32 s79, 0
    s_cbranch_scc1 pe_5037_l
pe_5037_ok:
    s_add_u32 m0, s37, 65536
    s_nop 0
    buffer_load_dwordx4 v4, s[4:7], s70 offen lds
    s_add_u32 s39, s70, 16384
    s_add_u32 s40, s71, 131072
    s_add_u32 m0, s37, 69632
    s_nop 0
    buffer_load_dwordx4 v5, s[4:7], s70 offen lds
    s_add_u32 m0, s37, 73728
    s_nop 0
    buffer_load_dwordx4 v6, s[4:7], s70 offen lds
    s_add_u32 m0, s37, 77824
    s_nop 0
    buffer_load_dwordx4 v7, s[4:7], s70 offen lds
    s_add_u32 m0, s37, 81920
    s_nop 0
    buffer_load_dwordx4 v8, s[8:11], s71 offen lds
    s_add_u32 m0, s37, 86016
    s_nop 0
    buffer_load_dwordx4 v9, s[8:11], s71 offen lds
    s_add_u32 m0, s37, 90112
    s_nop 0
    buffer_load_dwordx4 v10, s[8:11], s71 offen lds
    s_add_u32 m0, s37, 94208
    s_nop 0
    buffer_load_dwordx4 v11, s[8:11], s71 offen lds
    s_waitcnt vmcnt(16)
    s_barrier
    s_lshl_b32 s97, s98, 1
    s_add_u32 s97, s97, 1
    s_mul_i32 s97, s97, 9363
    s_lshr_b32 s97, s97, 16
    s_lshl_b32 s97, s97, 2
    s_add_u32 s97, s97, 4
    s_add_u32 s98, s98, 1
    s_cmp_ge_u32 s96, s97
    s_cbranch_scc1 pe_5038_ok
    s_mov_b32 s79, 40000
    s_cmp_lg_u32 s41, 0
    s_cbranch_scc1 pe_5038_w
pe_5038_p:
    buffer_load_dword v32, v30, s[24:27], 0 offen sc0 sc1
    s_waitcnt vmcnt(0)
    v_cmp_ne_u32 vcc, s65, v32
    s_nop 2
    s_ff1_i32_b64 s96, vcc
    v_mov_b32 v32, s96
    ds_write_b32 v31, v32
    s_waitcnt lgkmcnt(0)
    s_cmp_ge_u32 s96, s97
    s_cbranch_scc1 pe_5038_ok
    s_sleep 6
    s_sub_u32 s79, s79, 1
    s_cmp_lg_u32 s79, 0
    s_cbranch_scc1 pe_5038_p
    s_branch pe_5038_ok
pe_5038_w:
    s_mov_b32 s79, 640000
pe_5038_l:
    ds_read_b32 v32, v31
    s_waitcnt lgkmcnt(0)
    v_readfirstlane_b32 s96, v32
    s_nop 2
    s_cmp_ge_u32 s96, s97
    s_cbranch_scc1 pe_5038_ok
    s_sleep 1
    s_sub_u32 s79, s79, 1
    s_cmp_lg_u32 s79, 0
    s_cbranch_scc1 pe_5038_l
pe_5038_ok:
    s_add_u32 m0, s37, 98304
    s_nop 0
    buffer_load_dwordx4 v4, s[4:7], s39 offen lds
    s_add_u32 s70, s39, 16384
    s_add_u32 s71, s40, 131072
    s_add_u32 m0, s37, 102400
    s_nop 0
    buffer_load_dwordx4 v5, s[4:7], s39 offen lds
    s_add_u32 m0, s37, 106496
    s_nop 0
    buffer_load_dwordx4 v6, s[4:7], s39 offen lds
    s_add_u32 m0, s37, 110592
    s_nop 0
    buffer_load_dwordx4 v7, s[4:7], s39 offen lds
    s_add_u32 m0, s37, 114688
    s_nop 0
    buffer_load_dwordx4 v8, s[8:11], s40 offen lds
    s_add_u32 m0, s37, 118784
    s_nop 0
    buffer_load_dwordx4 v9, s[8:11], s40 offen lds
    s_add_u32 m0, s37, 122880
    s_nop 0
    buffer_load_dwordx4 v10, s[8:11], s40 offen lds
    s_add_u32 m0, s37, 126976
    s_nop 0
    buffer_load_dwordx4 v11, s[8:11], s40 offen lds
    s_waitcnt vmcnt(16)
    s_barrier
    s_lshl_b32 s97, s98, 1
    s_add_u32 s97, s97, 1
    s_mul_i32 s97, s97, 9363
    s_lshr_b32 s97, s97, 16
    s_lshl_b32 s97, s97, 2
    s_add_u32 s97, s97, 4
    s_add_u32 s98, s98, 1
    s_cmp_ge_u32 s96, s97
    s_cbranch_scc1 pe_5039_ok
    s_mov_b32 s79, 40000
    s_cmp_lg_u32 s41, 0
    s_cbranch_scc1 pe_5039_w
pe_5039_p:
    buffer_load_dword v32, v30, s[24:27], 0 offen sc0 sc1
    s_waitcnt vmcnt(0)
    v_cmp_ne_u32 vcc, s65, v32
    s_nop 2
    s_ff1_i32_b64 s96, vcc
    v_mov_b32 v32, s96
    ds_write_b32 v31, v32
    s_waitcnt lgkmcnt(0)
    s_cmp_ge_u32 s96, s97
    s_cbranch_scc1 pe_5039_ok
    s_sleep 6
    s_sub_u32 s79, s79, 1
    s_cmp_lg_u32 s79, 0
    s_cbranch_scc1 pe_5039_p
    s_branch pe_5039_ok
pe_5039_w:
    s_mov_b32 s79, 640000
pe_5039_l:
    ds_read_b32 v32, v31
    s_waitcnt lgkmcnt(0)
    v_readfirstlane_b32 s96, v32
    s_nop 2
    s_cmp_ge_u32 s96, s97
    s_cbranch_scc1 pe_5039_ok
    s_sleep 1
    s_sub_u32 s79, s79, 1
    s_cmp_lg_u32 s79, 0
    s_cbranch_scc1 pe_5039_l
pe_5039_ok:
    s_add_u32 m0, s37, 0
    s_nop 0
    buffer_load_dwordx4 v4, s[4:7], s70 offen lds
    s_add_u32 s39, s70, 16384
    s_add_u32 s40, s71, 131072
    s_add_u32 m0, s37, 4096
    s_nop 0
    buffer_load_dwordx4 v5, s[4:7], s70 offen lds
    s_add_u32 m0, s37, 8192
    s_nop 0
    buffer_load_dwordx4 v6, s[4:7], s70 offen lds
    s_add_u32 m0, s37, 12288
    s_nop 0
    buffer_load_dwordx4 v7, s[4:7], s70 offen lds
    s_add_u32 m0, s37, 16384
    s_nop 0
    buffer_load_dwordx4 v8, s[8:11], s71 offen lds
    s_add_u32 m0, s37, 20480
    s_nop 0
    buffer_load_dwordx4 v9, s[8:11], s71 offen lds
    s_add_u32 m0, s37, 24576
    s_nop 0
    buffer_load_dwordx4 v10, s[8:11], s71 offen lds
    s_add_u32 m0, s37, 28672
    s_nop 0
    buffer_load_dwordx4 v11, s[8:11], s71 offen lds
    s_waitcnt vmcnt(16)
    s_barrier
    s_lshl_b32 s97, s98, 1
    s_add_u32 s97, s97, 1
    s_mul_i32 s97, s97, 9363
    s_lshr_b32 s97, s97, 16
    s_lshl_b32 s97, s97, 2
    s_add_u32 s97, s97, 4
    s_add_u32 s98, s98, 1
    s_cmp_ge_u32 s96, s97
    s_cbranch_scc1 pe_5040_ok
    s_mov_b32 s79, 40000
    s_cmp_lg_u32 s41, 0
    s_cbranch_scc1 pe_5040_w
pe_5040_p:
    buffer_load_dword v32, v30, s[24:27], 0 offen sc0 sc1
    s_waitcnt vmcnt(0)
    v_cmp_ne_u32 vcc, s65, v32
    s_nop 2
    s_ff1_i32_b64 s96, vcc
    v_mov_b32 v32, s96
    ds_write_b32 v31, v32
    s_waitcnt lgkmcnt(0)
    s_cmp_ge_u32 s96, s97
    s_cbranch_scc1 pe_5040_ok
    s_sleep 6
    s_sub_u32 s79, s79, 1
    s_cmp_lg_u32 s79, 0
    s_cbranch_scc1 pe_5040_p
    s_branch pe_5040_ok
pe_5040_w:
    s_mov_b32 s79, 640000
pe_5040_l:
    ds_read_b32 v32, v31
    s_waitcnt lgkmcnt(0)
    v_readfirstlane_b32 s96, v32
    s_nop 2
    s_cmp_ge_u32 s96, s97
    s_cbranch_scc1 pe_5040_ok
    s_sleep 1
    s_sub_u32 s79, s79, 1
    s_cmp_lg_u32 s79, 0
    s_cbranch_scc1 pe_5040_l
pe_5040_ok:
    s_add_u32 m0, s37, 32768
    s_nop 0
    buffer_load_dwordx4 v4, s[4:7], s39 offen lds
    s_add_u32 s70, s39, 16384
    s_add_u32 s71, s40, 131072
    s_add_u32 m0, s37, 36864
    s_nop 0
    buffer_load_dwordx4 v5, s[4:7], s39 offen lds
    s_add_u32 m0, s37, 40960
    s_nop 0
    buffer_load_dwordx4 v6, s[4:7], s39 offen lds
    s_add_u32 m0, s37, 45056
    s_nop 0
    buffer_load_dwordx4 v7, s[4:7], s39 offen lds
    s_add_u32 m0, s37, 49152
    s_nop 0
    buffer_load_dwordx4 v8, s[8:11], s40 offen lds
    s_add_u32 m0, s37, 53248
    s_nop 0
    buffer_load_dwordx4 v9, s[8:11], s40 offen lds
    s_add_u32 m0, s37, 57344
    s_nop 0
    buffer_load_dwordx4 v10, s[8:11], s40 offen lds
    s_add_u32 m0, s37, 61440
    s_nop 0
    buffer_load_dwordx4 v11, s[8:11], s40 offen lds
    s_sub_u32 s38, s38, 1
    s_cmp_lg_u32 s38, 0
    s_cbranch_scc1 p4_lloop
    s_waitcnt vmcnt(16)
    s_barrier
    s_lshl_b32 s97, s98, 1
    s_add_u32 s97, s97, 1
    s_mul_i32 s97, s97, 9363
    s_lshr_b32 s97, s97, 16
    s_lshl_b32 s97, s97, 2
    s_add_u32 s97, s97, 4
    s_add_u32 s98, s98, 1
    s_cmp_ge_u32 s96, s97
    s_cbranch_scc1 pe_5041_ok
    s_mov_b32 s79, 40000
    s_cmp_lg_u32 s41, 0
    s_cbranch_scc1 pe_5041_w
pe_5041_p:
    buffer_load_dword v32, v30, s[24:27], 0 offen sc0 sc1
    s_waitcnt vmcnt(0)
    v_cmp_ne_u32 vcc, s65, v32
    s_nop 2
    s_ff1_i32_b64 s96, vcc
    v_mov_b32 v32, s96
    ds_write_b32 v31, v32
    s_waitcnt lgkmcnt(0)
    s_cmp_ge_u32 s96, s97
    s_cbranch_scc1 pe_5041_ok
    s_sleep 6
    s_sub_u32 s79, s79, 1
    s_cmp_lg_u32 s79, 0
    s_cbranch_scc1 pe_5041_p
    s_branch pe_5041_ok
pe_5041_w:
    s_mov_b32 s79, 640000
pe_5041_l:
    ds_read_b32 v32, v31
    s_waitcnt lgkmcnt(0)
    v_readfirstlane_b32 s96, v32
    s_nop 2
    s_cmp_ge_u32 s96, s97
    s_cbranch_scc1 pe_5041_ok
    s_sleep 1
    s_sub_u32 s79, s79, 1
    s_cmp_lg_u32 s79, 0
    s_cbranch_scc1 pe_5041_l
pe_5041_ok:
    s_add_u32 m0, s37, 65536
    s_nop 0
    buffer_load_dwordx4 v4, s[4:7], s70 offen lds
    s_add_u32 s39, s70, 16384
    s_add_u32 s40, s71, 131072
    s_add_u32 m0, s37, 69632
    s_nop 0
    buffer_load_dwordx4 v5, s[4:7], s70 offen lds
    s_add_u32 m0, s37, 73728
    s_nop 0
    buffer_load_dwordx4 v6, s[4:7], s70 offen lds
    s_add_u32 m0, s37, 77824
    s_nop 0
    buffer_load_dwordx4 v7, s[4:7], s70 offen lds
    s_add_u32 m0, s37, 81920
    s_nop 0
    buffer_load_dwordx4 v8, s[8:11], s71 offen lds
    s_add_u32 m0, s37, 86016
    s_nop 0
    buffer_load_dwordx4 v9, s[8:11], s71 offen lds
    s_add_u32 m0, s37, 90112
    s_nop 0
    buffer_load_dwordx4 v10, s[8:11], s71 offen lds
    s_add_u32 m0, s37, 94208
    s_nop 0
    buffer_load_dwordx4 v11, s[8:11], s71 offen lds
    s_waitcnt vmcnt(16)
    s_barrier
    s_lshl_b32 s97, s98, 1
    s_add_u32 s97, s97, 1
    s_mul_i32 s97, s97, 9363
    s_lshr_b32 s97, s97, 16
    s_lshl_b32 s97, s97, 2
    s_add_u32 s97, s97, 4
    s_add_u32 s98, s98, 1
    s_cmp_ge_u32 s96, s97
    s_cbranch_scc1 pe_5042_ok
    s_mov_b32 s79, 40000
    s_cmp_lg_u32 s41, 0
    s_cbranch_scc1 pe_5042_w
pe_5042_p:
    buffer_load_dword v32, v30, s[24:27], 0 offen sc0 sc1
    s_waitcnt vmcnt(0)
    v_cmp_ne_u32 vcc, s65, v32
    s_nop 2
    s_ff1_i32_b64 s96, vcc
    v_mov_b32 v32, s96
    ds_write_b32 v31, v32
    s_waitcnt lgkmcnt(0)
    s_cmp_ge_u32 s96, s97
    s_cbranch_scc1 pe_5042_ok
    s_sleep 6
    s_sub_u32 s79, s79, 1
    s_cmp_lg_u32 s79, 0
    s_cbranch_scc1 pe_5042_p
    s_branch pe_5042_ok
pe_5042_w:
    s_mov_b32 s79, 640000
pe_5042_l:
    ds_read_b32 v32, v31
    s_waitcnt lgkmcnt(0)
    v_readfirstlane_b32 s96, v32
    s_nop 2
    s_cmp_ge_u32 s96, s97
    s_cbranch_scc1 pe_5042_ok
    s_sleep 1
    s_sub_u32 s79, s79, 1
    s_cmp_lg_u32 s79, 0
    s_cbranch_scc1 pe_5042_l
pe_5042_ok:
    s_add_u32 m0, s37, 98304
    s_nop 0
    buffer_load_dwordx4 v4, s[4:7], s39 offen lds
    s_add_u32 s70, s39, 16384
    s_add_u32 s71, s40, 131072
    s_add_u32 m0, s37, 102400
    s_nop 0
    buffer_load_dwordx4 v5, s[4:7], s39 offen lds
    s_add_u32 m0, s37, 106496
    s_nop 0
    buffer_load_dwordx4 v6, s[4:7], s39 offen lds
    s_add_u32 m0, s37, 110592
    s_nop 0
    buffer_load_dwordx4 v7, s[4:7], s39 offen lds
    s_add_u32 m0, s37, 114688
    s_nop 0
    buffer_load_dwordx4 v8, s[8:11], s40 offen lds
    s_add_u32 m0, s37, 118784
    s_nop 0
    buffer_load_dwordx4 v9, s[8:11], s40 offen lds
    s_add_u32 m0, s37, 122880
    s_nop 0
    buffer_load_dwordx4 v10, s[8:11], s40 offen lds
    s_add_u32 m0, s37, 126976
    s_nop 0
    buffer_load_dwordx4 v11, s[8:11], s40 offen lds
    s_waitcnt vmcnt(16)
    s_barrier
    s_waitcnt vmcnt(8)
    s_barrier
    s_waitcnt vmcnt(0)
    s_barrier
sequential_preLN__linear_kernel_hedgehog__dense_activation_relu__prompt_kernel_done:
    s_endpgm
feat_sub:
    s_nop 1
    v_mfma_f32_16x16x32_bf16 v[212:215], v[200:203], v[208:211], 0
    v_mfma_f32_16x16x32_bf16 v[216:219], v[204:207], v[208:211], 0
    s_nop 6
    v_cvt_pk_bf16_f32 v220, v212, v213
    v_cvt_pk_bf16_f32 v221, v214, v215
    v_cvt_pk_bf16_f32 v222, v216, v217
    v_cvt_pk_bf16_f32 v223, v218, v219
    v_lshlrev_b32 v212, 16, v220
    v_and_b32 v213, 0xffff0000, v220
    v_lshlrev_b32 v214, 16, v221
    v_and_b32 v215, 0xffff0000, v221
    v_lshlrev_b32 v216, 16, v222
    v_and_b32 v217, 0xffff0000, v222
    v_lshlrev_b32 v218, 16, v223
    v_and_b32 v219, 0xffff0000, v223
    v_max3_f32 v220, v212, v213, v214
    v_min3_f32 v221, v212, v213, v214
    v_max3_f32 v220, v220, v215, v216
    v_min3_f32 v221, v221, v215, v216
    v_max3_f32 v220, v220, v217, v218
    v_min3_f32 v221, v221, v217, v218
    v_max_f32 v220, v220, v219
    v_min_f32 v221, v221, v219
    v_mov_b32 v222, v220
    v_mov_b32 v223, v221
    s_nop 0
    v_permlane16_swap_b32 v220, v222
    v_permlane16_swap_b32 v221, v223
    v_max_f32 v220, v220, v222
    v_min_f32 v221, v221, v223
    v_mov_b32 v222, v220
    v_mov_b32 v223, v221
    s_nop 0
    v_permlane32_swap_b32 v220, v222
    v_permlane32_swap_b32 v221, v223
    v_max_f32 v220, v220, v222
    v_min_f32 v221, v221, v223
    v_mul_f32 v220, s64, v220
    v_mul_f32 v221, s64, v221
    v_fma_f32 v224, v212, s64, -v220
    v_fma_f32 v232, -v212, s64, v221
    v_fma_f32 v225, v213, s64, -v220
    v_fma_f32 v233, -v213, s64, v221
    v_fma_f32 v226, v214, s64, -v220
    v_fma_f32 v234, -v214, s64, v221
    v_fma_f32 v227, v215, s64, -v220
    v_fma_f32 v235, -v215, s64, v221
    v_fma_f32 v228, v216, s64, -v220
    v_fma_f32 v236, -v216, s64, v221
    v_fma_f32 v229, v217, s64, -v220
    v_fma_f32 v237, -v217, s64, v221
    v_fma_f32 v230, v218, s64, -v220
    v_fma_f32 v238, -v218, s64, v221
    v_fma_f32 v231, v219, s64, -v220
    v_fma_f32 v239, -v219, s64, v221
    v_exp_f32 v224, v224
    v_exp_f32 v232, v232
    v_exp_f32 v225, v225
    v_exp_f32 v233, v233
    v_exp_f32 v226, v226
    v_exp_f32 v234, v234
    v_exp_f32 v227, v227
    v_exp_f32 v235, v235
    v_exp_f32 v228, v228
    v_exp_f32 v236, v236
    v_exp_f32 v229, v229
    v_exp_f32 v237, v237
    v_exp_f32 v230, v230
    v_exp_f32 v238, v238
    v_exp_f32 v231, v231
    v_exp_f32 v239, v239
    v_add_f32 v220, v224, v225
    v_add_f32 v221, v232, v233
    v_add_f32 v220, v220, v226
    v_add_f32 v221, v221, v234
    v_add_f32 v220, v220, v227
    v_add_f32 v221, v221, v235
    v_add_f32 v220, v220, v228
    v_add_f32 v221, v221, v236
    v_add_f32 v220, v220, v229
    v_add_f32 v221, v221, v237
    v_add_f32 v220, v220, v230
    v_add_f32 v221, v221, v238
    v_add_f32 v220, v220, v231
    v_add_f32 v221, v221, v239
    v_mov_b32 v222, v220
    v_mov_b32 v223, v221
    s_nop 0
    v_permlane16_swap_b32 v220, v222
    v_permlane16_swap_b32 v221, v223
    v_add_f32 v220, v220, v222
    v_add_f32 v221, v221, v223
    v_mov_b32 v222, v220
    v_mov_b32 v223, v221
    s_nop 0
    v_permlane32_swap_b32 v220, v222
    v_permlane32_swap_b32 v221, v223
    v_add_f32 v220, v220, v222
    v_add_f32 v221, v221, v223
    v_rcp_f32 v220, v220
    v_rcp_f32 v221, v221
    v_mul_f32 v224, v224, v220
    v_mul_f32 v232, v232, v221
    v_mul_f32 v225, v225, v220
    v_mul_f32 v233, v233, v221
    v_mul_f32 v226, v226, v220
    v_mul_f32 v234, v234, v221
    v_mul_f32 v227, v227, v220
    v_mul_f32 v235, v235, v221
    v_mul_f32 v228, v228, v220
    v_mul_f32 v236, v236, v221
    v_mul_f32 v229, v229, v220
    v_mul_f32 v237, v237, v221
    v_mul_f32 v230, v230, v220
    v_mul_f32 v238, v238, v221
    v_mul_f32 v231, v231, v220
    v_mul_f32 v239, v239, v221
    v_cvt_pk_bf16_f32 v244, v224, v225
    v_cvt_pk_bf16_f32 v248, v232, v233
    v_cvt_pk_bf16_f32 v245, v226, v227
    v_cvt_pk_bf16_f32 v249, v234, v235
    v_cvt_pk_bf16_f32 v246, v228, v229
    v_cvt_pk_bf16_f32 v250, v236, v237
    v_cvt_pk_bf16_f32 v247, v230, v231
    v_cvt_pk_bf16_f32 v251, v238, v239
    s_nop 1
    s_setpc_b64 s[72:73]
.section .rodata,"a"
.p2align 6
.amdhsa_kernel sequential_preLN__linear_kernel_hedgehog__dense_activation_relu__prompt_kernel
  .amdhsa_next_free_vgpr 256
  .amdhsa_next_free_sgpr 102
  .amdhsa_accum_offset 256
  .amdhsa_group_segment_fixed_size 0
  .amdhsa_kernarg_size 80
  .amdhsa_user_sgpr_count 2
  .amdhsa_user_sgpr_kernarg_segment_ptr 1
  .amdhsa_system_sgpr_workgroup_id_x 1
.end_amdhsa_kernel
```
